```python
import torch

def _softmax(x, axis=-1):
    return torch.softmax(x, dim=axis)
def _gelu(x):
    return torch.nn.functional.gelu(x, approximate="tanh")
def _silu(x):
    return torch.nn.functional.silu(x)
def _sigmoid(x):
    return torch.sigmoid(x)
def _layernorm(x, axis=-1, eps=1e-5):
    m = x.mean(dim=axis, keepdim=True)
    v = x.var(dim=axis, keepdim=True, unbiased=False)
    return (x - m) / torch.sqrt(v + eps)
def _scatter_add(tgt, idx, src, axis=0):
    return tgt.clone().index_add_(axis, idx, src)
def _segment_sum(src, seg, n):
    out = torch.zeros((n,) + src.shape[1:], dtype=src.dtype)
    return out.index_add_(0, seg, src)
def _pad(x, pw):
    flat = tuple(v for pair in reversed(pw) for v in pair)
    return torch.nn.functional.pad(x, flat)

kernel_name = 'standalone__gqa_softmax__near_ridge'

def setup_inputs():

    _w = (lambda a: (lambda t: t.to(torch.bfloat16) if t.is_floating_point() else t)(torch.as_tensor(a)))
    B, Hq, Hkv, Sq, Sk, D = 8, 32, 32, 512, 1024, 128
    return {
        "q": _w((lambda *s: torch.randn(*s, dtype=torch.bfloat16) * 0.8)(B, Hq, Sq, D)),
        "k": _w((lambda *s: torch.randn(*s, dtype=torch.bfloat16) * 0.8)(B, Hkv, Sk, D)),
        "v": _w((lambda *s: torch.randn(*s, dtype=torch.bfloat16) * 0.05)(B, Hkv, Sk, D)),
    }

def reference(q, k, v):
    B, Hq, Sq, D = q.shape
    Hkv = k.shape[1]
    rep = Hq // Hkv
    k = (lambda x, n, axis: torch.repeat_interleave(x, n, dim=axis))(k, rep, axis=1)
    v = (lambda x, n, axis: torch.repeat_interleave(x, n, dim=axis))(v, rep, axis=1)
    scale = D ** -0.5
    scores = torch.einsum("bhqd,bhkd->bhqk", q, k) * scale
    p = _softmax(scores, axis=-1)
    return torch.einsum("bhqk,bhkd->bhqd", p, v)
```

```asm
; @launch grid=(256,1,1) block=(256,1,1) lds=142464
.amdgcn_target "amdgcn-amd-amdhsa--gfx950"
.text
.globl standalone__gqa_softmax__near_ridge_kernel
.p2align 12
.p2align 8
.type standalone__gqa_softmax__near_ridge_kernel,@function
standalone__gqa_softmax__near_ridge_kernel:
    s_cmp_ge_u32 s2, 256
    s_cbranch_scc1 L_end
    s_load_dwordx4 s[4:7], s[0:1], 0
    s_load_dwordx4 s[12:15], s[0:1], 16
    v_lshrrev_b32 v12, 6, v0
    v_and_b32 v13, 63, v0
    v_readfirstlane_b32 s3, v12
    v_and_b32 v14, 15, v13
    v_lshrrev_b32 v15, 4, v13
    s_lshl_b32 s28, s2, 17
    s_lshl_b32 s29, s2, 18
    s_mov_b32 s22, 0x3e0293ee
    s_mov_b32 s23, 0x3e0293ee
    s_mul_i32 s21, s3, 1056
    s_mul_i32 s39, s3, 1088
    s_mov_b32 s40, 33792
    s_mov_b32 s41, 34880
    s_mov_b64 s[26:27], 0
    s_mov_b32 s36, 0x37800000
    s_mov_b32 s37, 0x28000000
    s_lshr_b32 s43, s2, 0
    s_mul_i32 s43, s43, 0
    s_mul_i32 s38, s3, 8192
    s_add_u32 s43, s43, s38
    v_lshrrev_b32 v16, 1, v15
    v_lshlrev_b32 v16, 4, v16
    v_and_b32 v17, 1, v15
    v_lshlrev_b32 v17, 2, v17
    v_add3_u32 v16, v16, v17, v12
    v_lshlrev_b32 v16, 8, v16
    v_lshl_add_u32 v2, v14, 4, v16
    v_lshl_add_u32 v16, v15, 3, v12
    v_lshlrev_b32 v16, 8, v16
    v_lshl_add_u32 v3, v14, 4, v16
    v_lshl_add_u32 v16, v12, 7, v14
    v_lshlrev_b32 v16, 8, v16
    v_lshl_add_u32 v11, v15, 4, v16
    s_getpc_b64 s[30:31]
L_pc:
    s_lshr_b32 s38, s2, 3
    s_lshl_b32 s38, s38, 12
    v_lshl_add_u32 v18, v0, 4, s38
    v_min_u32 v18, L_fin-L_pc-16, v18
    v_mov_b32 v19, s31
    v_add_co_u32 v18, vcc, s30, v18
    v_addc_co_u32 v19, vcc, 0, v19, vcc
    global_load_dwordx4 v[236:239], v[18:19], off
    s_waitcnt lgkmcnt(0)
    s_add_u32 s8, s6, s29
    s_addc_u32 s9, s7, 0
    s_mov_b32 s10, 262144
    s_mov_b32 s11, 0x00020000
    s_add_u32 s16, s14, s28
    s_addc_u32 s17, s15, 0
    s_mov_b32 s18, 131072
    s_mov_b32 s19, 0x00020000
    s_add_u32 s12, s12, s29
    s_addc_u32 s13, s13, 0
    s_mov_b32 s14, 262144
    s_mov_b32 s15, 0x00020000
    s_add_u32 s4, s4, s28
    s_addc_u32 s5, s5, 0
    s_mov_b32 s6, 131072
    s_mov_b32 s7, 0x00020000
    s_add_u32 m0, s21, 0
    s_mov_b32 s20, 0
    buffer_load_dwordx4 v2, s[8:11], s20 offen nt lds
    s_add_u32 m0, s21, 2176
    s_nop 0
    buffer_load_dwordx4 v2, s[8:11], s20 offen offset:2048 nt lds
    s_add_u32 s24, s43, 0
    s_and_b32 s24, s24, 0x7fff
    buffer_load_dwordx4 v[64:67], v11, s[4:7], s24 offen offset:0 nt
    buffer_load_dwordx4 v[68:71], v11, s[4:7], s24 offen offset:64 nt
    buffer_load_dwordx4 v[72:75], v11, s[4:7], s24 offen offset:128 nt
    buffer_load_dwordx4 v[76:79], v11, s[4:7], s24 offen offset:192 nt
    s_add_u32 m0, s39, 67584
    s_mov_b32 s25, 0
    buffer_load_dwordx4 v3, s[12:15], s25 offen nt lds
    s_add_u32 m0, s39, 70920
    s_nop 0
    buffer_load_dwordx4 v3, s[12:15], s25 offen offset:1024 nt lds
    v_and_b32 v16, 3, v14
    v_lshrrev_b32 v17, 3, v14
    v_lshl_add_u32 v16, v17, 2, v16
    v_mul_u32_u24 v16, 1056, v16
    v_lshrrev_b32 v17, 2, v14
    v_and_b32 v17, 1, v17
    v_lshl_add_u32 v16, v17, 8, v16
    v_lshl_add_u32 v0, v15, 4, v16
    v_and_b32 v16, 1, v15
    v_lshrrev_b32 v17, 2, v14
    v_mul_u32_u24 v16, 4360, v16
    v_mul_u32_u24 v17, 1088, v17
    v_add_u32 v16, v16, v17
    v_lshrrev_b32 v17, 1, v15
    v_lshl_add_u32 v16, v17, 8, v16
    v_and_b32 v17, 3, v14
    v_lshlrev_b32 v17, 4, v17
    v_add_u32 v16, v16, v17
    v_add_u32 v1, 67584, v16
    s_mov_b32 s30, 0xffff0000
    s_waitcnt vmcnt(6)
    s_barrier
    s_add_u32 s24, s43, 4096
    s_and_b32 s24, s24, 0x7fff
    buffer_load_dwordx4 v[96:99], v11, s[4:7], s24 offen offset:0 nt
    buffer_load_dwordx4 v[100:103], v11, s[4:7], s24 offen offset:64 nt
    ds_read_b128 a[100:103], v0 offset:0
    ds_read_b128 a[104:107], v0 offset:64
    ds_read_b128 a[108:111], v0 offset:128
    ds_read_b128 a[112:115], v0 offset:192
    ds_read_b128 a[116:119], v0 offset:512
    ds_read_b128 a[120:123], v0 offset:576
    ds_read_b128 a[124:127], v0 offset:640
    ds_read_b128 a[192:195], v0 offset:704
    s_waitcnt vmcnt(7)
    v_lshlrev_b32 v20, 16, v64
    buffer_load_dwordx4 v[104:107], v11, s[4:7], s24 offen offset:128 nt
    v_lshlrev_b32 v21, 16, v65
    v_and_b32 v64, s30, v64
    v_and_b32 v65, s30, v65
    v_pk_mul_f32 v[20:21], v[20:21], s[22:23]
    v_pk_mul_f32 v[64:65], v[64:65], s[22:23]
    v_cvt_pk_bf16_f32 v64, v20, v64
    v_cvt_pk_bf16_f32 v65, v21, v65
    v_accvgpr_write_b32 a0, v64
    v_accvgpr_write_b32 a1, v65
    v_lshlrev_b32 v22, 16, v66
    v_lshlrev_b32 v23, 16, v67
    v_and_b32 v66, s30, v66
    v_and_b32 v67, s30, v67
    v_pk_mul_f32 v[22:23], v[22:23], s[22:23]
    v_pk_mul_f32 v[66:67], v[66:67], s[22:23]
    v_cvt_pk_bf16_f32 v66, v22, v66
    v_cvt_pk_bf16_f32 v67, v23, v67
    v_accvgpr_write_b32 a2, v66
    v_accvgpr_write_b32 a3, v67
    s_waitcnt vmcnt(7)
    v_lshlrev_b32 v20, 16, v68
    buffer_load_dwordx4 v[108:111], v11, s[4:7], s24 offen offset:192 nt
    v_lshlrev_b32 v21, 16, v69
    v_and_b32 v68, s30, v68
    v_and_b32 v69, s30, v69
    v_pk_mul_f32 v[20:21], v[20:21], s[22:23]
    v_pk_mul_f32 v[68:69], v[68:69], s[22:23]
    v_cvt_pk_bf16_f32 v68, v20, v68
    v_cvt_pk_bf16_f32 v69, v21, v69
    v_accvgpr_write_b32 a4, v68
    v_accvgpr_write_b32 a5, v69
    v_lshlrev_b32 v22, 16, v70
    v_lshlrev_b32 v23, 16, v71
    v_and_b32 v70, s30, v70
    v_and_b32 v71, s30, v71
    v_pk_mul_f32 v[22:23], v[22:23], s[22:23]
    v_pk_mul_f32 v[70:71], v[70:71], s[22:23]
    v_cvt_pk_bf16_f32 v70, v22, v70
    v_cvt_pk_bf16_f32 v71, v23, v71
    v_accvgpr_write_b32 a6, v70
    v_accvgpr_write_b32 a7, v71
    s_waitcnt vmcnt(7)
    v_lshlrev_b32 v20, 16, v72
    s_add_u32 m0, s21, 8448
    s_mov_b32 s20, 8192
    buffer_load_dwordx4 v2, s[8:11], s20 offen nt lds
    v_lshlrev_b32 v21, 16, v73
    v_and_b32 v72, s30, v72
    v_and_b32 v73, s30, v73
    v_pk_mul_f32 v[20:21], v[20:21], s[22:23]
    v_pk_mul_f32 v[72:73], v[72:73], s[22:23]
    v_cvt_pk_bf16_f32 v72, v20, v72
    v_cvt_pk_bf16_f32 v73, v21, v73
    v_accvgpr_write_b32 a8, v72
    v_accvgpr_write_b32 a9, v73
    v_lshlrev_b32 v22, 16, v74
    v_lshlrev_b32 v23, 16, v75
    v_and_b32 v74, s30, v74
    v_and_b32 v75, s30, v75
    v_pk_mul_f32 v[22:23], v[22:23], s[22:23]
    v_pk_mul_f32 v[74:75], v[74:75], s[22:23]
    v_cvt_pk_bf16_f32 v74, v22, v74
    v_cvt_pk_bf16_f32 v75, v23, v75
    v_accvgpr_write_b32 a10, v74
    v_accvgpr_write_b32 a11, v75
    s_waitcnt vmcnt(7)
    v_lshlrev_b32 v20, 16, v76
    s_add_u32 m0, s21, 10624
    s_nop 0
    buffer_load_dwordx4 v2, s[8:11], s20 offen offset:2048 nt lds
    v_lshlrev_b32 v21, 16, v77
    v_and_b32 v76, s30, v76
    v_and_b32 v77, s30, v77
    v_pk_mul_f32 v[20:21], v[20:21], s[22:23]
    v_pk_mul_f32 v[76:77], v[76:77], s[22:23]
    v_cvt_pk_bf16_f32 v76, v20, v76
    v_cvt_pk_bf16_f32 v77, v21, v77
    v_accvgpr_write_b32 a12, v76
    v_accvgpr_write_b32 a13, v77
    v_lshlrev_b32 v22, 16, v78
    v_lshlrev_b32 v23, 16, v79
    v_and_b32 v78, s30, v78
    v_and_b32 v79, s30, v79
    v_pk_mul_f32 v[22:23], v[22:23], s[22:23]
    v_pk_mul_f32 v[78:79], v[78:79], s[22:23]
    v_cvt_pk_bf16_f32 v78, v22, v78
    v_cvt_pk_bf16_f32 v79, v23, v79
    v_accvgpr_write_b32 a14, v78
    v_accvgpr_write_b32 a15, v79
    s_waitcnt lgkmcnt(7)
    v_mfma_f32_16x16x32_bf16 v[20:23], a[100:103], a[0:3], 0
    s_waitcnt lgkmcnt(6)
    v_mfma_f32_16x16x32_bf16 v[20:23], a[104:107], a[4:7], v[20:23]
    s_waitcnt lgkmcnt(5)
    v_mfma_f32_16x16x32_bf16 v[20:23], a[108:111], a[8:11], v[20:23]
    s_waitcnt lgkmcnt(4)
    v_mfma_f32_16x16x32_bf16 v[20:23], a[112:115], a[12:15], v[20:23]
    s_waitcnt lgkmcnt(3)
    v_mfma_f32_16x16x32_bf16 v[24:27], a[116:119], a[0:3], 0
    s_waitcnt lgkmcnt(2)
    v_mfma_f32_16x16x32_bf16 v[24:27], a[120:123], a[4:7], v[24:27]
    s_waitcnt lgkmcnt(1)
    v_mfma_f32_16x16x32_bf16 v[24:27], a[124:127], a[8:11], v[24:27]
    s_waitcnt lgkmcnt(0)
    v_mfma_f32_16x16x32_bf16 v[24:27], a[192:195], a[12:15], v[24:27]
    s_waitcnt vmcnt(5)
    v_lshlrev_b32 v28, 16, v96
    s_add_u32 m0, s39, 76304
    s_mov_b32 s25, 8192
    buffer_load_dwordx4 v3, s[12:15], s25 offen nt lds
    s_add_u32 m0, s39, 79640
    s_nop 0
    buffer_load_dwordx4 v3, s[12:15], s25 offen offset:1024 nt lds
    s_add_u32 s24, s43, 8192
    s_and_b32 s24, s24, 0x7fff
    buffer_load_dwordx4 v[208:211], v11, s[4:7], s24 offen offset:0 nt
    v_lshlrev_b32 v29, 16, v97
    v_and_b32 v96, s30, v96
    v_and_b32 v97, s30, v97
    v_pk_mul_f32 v[28:29], v[28:29], s[22:23]
    v_pk_mul_f32 v[96:97], v[96:97], s[22:23]
    v_cvt_pk_bf16_f32 v96, v28, v96
    v_cvt_pk_bf16_f32 v97, v29, v97
    v_accvgpr_write_b32 a16, v96
    v_accvgpr_write_b32 a17, v97
    v_lshlrev_b32 v30, 16, v98
    v_lshlrev_b32 v31, 16, v99
    v_and_b32 v98, s30, v98
    v_and_b32 v99, s30, v99
    v_pk_mul_f32 v[30:31], v[30:31], s[22:23]
    v_pk_mul_f32 v[98:99], v[98:99], s[22:23]
    v_cvt_pk_bf16_f32 v98, v30, v98
    v_cvt_pk_bf16_f32 v99, v31, v99
    v_accvgpr_write_b32 a18, v98
    v_accvgpr_write_b32 a19, v99
    s_waitcnt vmcnt(7)
    v_lshlrev_b32 v28, 16, v100
    buffer_load_dwordx4 v[212:215], v11, s[4:7], s24 offen offset:64 nt
    v_lshlrev_b32 v29, 16, v101
    v_and_b32 v100, s30, v100
    v_and_b32 v101, s30, v101
    v_pk_mul_f32 v[28:29], v[28:29], s[22:23]
    v_pk_mul_f32 v[100:101], v[100:101], s[22:23]
    v_cvt_pk_bf16_f32 v100, v28, v100
    v_cvt_pk_bf16_f32 v101, v29, v101
    v_accvgpr_write_b32 a20, v100
    v_accvgpr_write_b32 a21, v101
    v_lshlrev_b32 v30, 16, v102
    v_lshlrev_b32 v31, 16, v103
    v_and_b32 v102, s30, v102
    v_and_b32 v103, s30, v103
    v_pk_mul_f32 v[30:31], v[30:31], s[22:23]
    v_pk_mul_f32 v[102:103], v[102:103], s[22:23]
    v_cvt_pk_bf16_f32 v102, v30, v102
    v_cvt_pk_bf16_f32 v103, v31, v103
    v_accvgpr_write_b32 a22, v102
    v_accvgpr_write_b32 a23, v103
    s_waitcnt vmcnt(7)
    v_lshlrev_b32 v28, 16, v104
    buffer_load_dwordx4 v[216:219], v11, s[4:7], s24 offen offset:128 nt
    v_lshlrev_b32 v29, 16, v105
    v_and_b32 v104, s30, v104
    v_and_b32 v105, s30, v105
    v_pk_mul_f32 v[28:29], v[28:29], s[22:23]
    v_pk_mul_f32 v[104:105], v[104:105], s[22:23]
    v_cvt_pk_bf16_f32 v104, v28, v104
    v_cvt_pk_bf16_f32 v105, v29, v105
    v_accvgpr_write_b32 a24, v104
    v_accvgpr_write_b32 a25, v105
    v_lshlrev_b32 v30, 16, v106
    v_lshlrev_b32 v31, 16, v107
    v_and_b32 v106, s30, v106
    v_and_b32 v107, s30, v107
    v_pk_mul_f32 v[30:31], v[30:31], s[22:23]
    v_pk_mul_f32 v[106:107], v[106:107], s[22:23]
    v_cvt_pk_bf16_f32 v106, v30, v106
    v_cvt_pk_bf16_f32 v107, v31, v107
    v_accvgpr_write_b32 a26, v106
    v_accvgpr_write_b32 a27, v107
    s_waitcnt vmcnt(7)
    v_lshlrev_b32 v28, 16, v108
    buffer_load_dwordx4 v[220:223], v11, s[4:7], s24 offen offset:192 nt
    v_lshlrev_b32 v29, 16, v109
    v_and_b32 v108, s30, v108
    v_and_b32 v109, s30, v109
    v_pk_mul_f32 v[28:29], v[28:29], s[22:23]
    v_pk_mul_f32 v[108:109], v[108:109], s[22:23]
    v_cvt_pk_bf16_f32 v108, v28, v108
    v_cvt_pk_bf16_f32 v109, v29, v109
    v_accvgpr_write_b32 a28, v108
    v_accvgpr_write_b32 a29, v109
    v_lshlrev_b32 v30, 16, v110
    v_lshlrev_b32 v31, 16, v111
    v_and_b32 v110, s30, v110
    v_and_b32 v111, s30, v111
    v_pk_mul_f32 v[30:31], v[30:31], s[22:23]
    v_pk_mul_f32 v[110:111], v[110:111], s[22:23]
    v_cvt_pk_bf16_f32 v110, v30, v110
    v_cvt_pk_bf16_f32 v111, v31, v111
    v_accvgpr_write_b32 a30, v110
    v_accvgpr_write_b32 a31, v111
    v_mfma_f32_16x16x32_bf16 v[28:31], a[100:103], a[16:19], 0
    v_exp_f32 v20, v20
    v_mfma_f32_16x16x32_bf16 v[28:31], a[104:107], a[20:23], v[28:31]
    v_mfma_f32_16x16x32_bf16 v[28:31], a[108:111], a[24:27], v[28:31]
    v_exp_f32 v21, v21
    v_mfma_f32_16x16x32_bf16 v[28:31], a[112:115], a[28:31], v[28:31]
    v_mov_b32 v4, v20
    v_mfma_f32_16x16x32_bf16 v[32:35], a[116:119], a[16:19], 0
    s_waitcnt vmcnt(6)
    s_barrier
    s_add_u32 s24, s43, 12288
    s_and_b32 s24, s24, 0x7fff
    buffer_load_dwordx4 v[240:243], v11, s[4:7], s24 offen offset:0 nt
    buffer_load_dwordx4 v[244:247], v11, s[4:7], s24 offen offset:64 nt
    v_exp_f32 v22, v22
    v_mfma_f32_16x16x32_bf16 v[32:35], a[120:123], a[20:23], v[32:35]
    ds_read_b128 a[196:199], v0 offset:8448
    v_add_f32 v4, v4, v21
    v_mfma_f32_16x16x32_bf16 v[32:35], a[124:127], a[24:27], v[32:35]
    v_exp_f32 v23, v23
    v_mfma_f32_16x16x32_bf16 v[32:35], a[192:195], a[28:31], v[32:35]
    s_waitcnt lgkmcnt(0)
    v_add_f32 v4, v4, v22
    v_cvt_pk_bf16_f32 v12, v20, v21
    ds_read_b128 a[200:203], v0 offset:8512
    ds_read_b128 a[204:207], v0 offset:8576
    ds_read_b128 a[208:211], v0 offset:8640
    ds_read_b128 a[212:215], v0 offset:8960
    ds_read_b128 a[216:219], v0 offset:9024
    ds_read_b128 a[220:223], v0 offset:9088
    ds_read_b128 a[224:227], v0 offset:9152
    ds_read_b64_tr_b16 a[228:229], v1 offset:0
    ds_read_b64_tr_b16 a[230:231], v1 offset:512
    ds_read_b64_tr_b16 a[232:233], v1 offset:8
    ds_read_b64_tr_b16 a[234:235], v1 offset:520
    ds_read_b64_tr_b16 a[236:237], v1 offset:64
    ds_read_b64_tr_b16 a[238:239], v1 offset:576
    ds_read_b64_tr_b16 a[240:241], v1 offset:72
    ds_read_b64_tr_b16 a[242:243], v1 offset:584
    ds_read_b64_tr_b16 a[244:245], v1 offset:128
    ds_read_b64_tr_b16 a[246:247], v1 offset:640
    ds_read_b64_tr_b16 a[248:249], v1 offset:136
    ds_read_b64_tr_b16 a[250:251], v1 offset:648
    ds_read_b64_tr_b16 a[252:253], v1 offset:192
    ds_read_b64_tr_b16 a[254:255], v1 offset:704
    ds_read_b64_tr_b16 a[100:101], v1 offset:200
    ds_read_b64_tr_b16 a[102:103], v1 offset:712
    v_exp_f32 v24, v24
    v_add_f32 v4, v4, v23
    v_exp_f32 v25, v25
    v_add_f32 v4, v4, v24
    v_cvt_pk_bf16_f32 v13, v22, v23
    v_exp_f32 v26, v26
    v_add_f32 v4, v4, v25
    v_exp_f32 v27, v27
    v_add_f32 v4, v4, v26
    v_cvt_pk_bf16_f32 v14, v24, v25
    v_mfma_f32_16x16x32_bf16 v[20:23], a[196:199], a[0:3], 0
    s_waitcnt lgkmcnt(15)
    v_exp_f32 v28, v28
    v_mfma_f32_16x16x32_bf16 v[20:23], a[200:203], a[4:7], v[20:23]
    v_add_f32 v4, v4, v27
    v_mfma_f32_16x16x32_bf16 v[20:23], a[204:207], a[8:11], v[20:23]
    v_exp_f32 v29, v29
    v_mfma_f32_16x16x32_bf16 v[20:23], a[208:211], a[12:15], v[20:23]
    v_cvt_pk_bf16_f32 v15, v26, v27
    v_mov_b32 v5, v28
    v_mfma_f32_16x16x32_bf16 v[24:27], a[212:215], a[0:3], 0
    v_exp_f32 v30, v30
    v_mfma_f32_16x16x32_bf16 v[24:27], a[216:219], a[4:7], v[24:27]
    buffer_load_dwordx4 v[248:251], v11, s[4:7], s24 offen offset:128 nt
    v_add_f32 v5, v5, v29
    v_mfma_f32_16x16x32_bf16 v[24:27], a[220:223], a[8:11], v[24:27]
    v_exp_f32 v31, v31
    v_mfma_f32_16x16x32_bf16 v[24:27], a[224:227], a[12:15], v[24:27]
    s_waitcnt lgkmcnt(0)
    v_add_f32 v5, v5, v30
    v_cvt_pk_bf16_f32 v16, v28, v29
    v_mfma_f32_16x16x32_bf16 v[64:67], a[228:231], v[12:15], 0
    v_exp_f32 v32, v32
    v_mfma_f32_16x16x32_bf16 v[68:71], a[232:235], v[12:15], 0
    v_add_f32 v5, v5, v31
    v_mfma_f32_16x16x32_bf16 v[72:75], a[236:239], v[12:15], 0
    v_exp_f32 v33, v33
    v_mfma_f32_16x16x32_bf16 v[76:79], a[240:243], v[12:15], 0
    v_add_f32 v5, v5, v32
    v_cvt_pk_bf16_f32 v17, v30, v31
    v_mfma_f32_16x16x32_bf16 v[80:83], a[244:247], v[12:15], 0
    v_exp_f32 v34, v34
    v_mfma_f32_16x16x32_bf16 v[84:87], a[248:251], v[12:15], 0
    v_add_f32 v5, v5, v33
    v_mfma_f32_16x16x32_bf16 v[88:91], a[252:255], v[12:15], 0
    v_exp_f32 v35, v35
    v_mfma_f32_16x16x32_bf16 v[92:95], a[100:103], v[12:15], 0
    v_add_f32 v5, v5, v34
    v_cvt_pk_bf16_f32 v18, v32, v33
    v_mfma_f32_16x16x32_bf16 v[28:31], a[196:199], a[16:19], 0
    v_exp_f32 v20, v20
    v_mfma_f32_16x16x32_bf16 v[28:31], a[200:203], a[20:23], v[28:31]
    v_add_f32 v5, v5, v35
    v_mfma_f32_16x16x32_bf16 v[28:31], a[204:207], a[24:27], v[28:31]
    v_exp_f32 v21, v21
    v_mfma_f32_16x16x32_bf16 v[28:31], a[208:211], a[28:31], v[28:31]
    v_cvt_pk_bf16_f32 v19, v34, v35
    v_add_f32 v4, v4, v20
    v_mfma_f32_16x16x32_bf16 v[32:35], a[212:215], a[16:19], 0
    v_exp_f32 v22, v22
    v_mfma_f32_16x16x32_bf16 v[32:35], a[216:219], a[20:23], v[32:35]
    buffer_load_dwordx4 v[252:255], v11, s[4:7], s24 offen offset:192 nt
    v_add_f32 v4, v4, v21
    v_mfma_f32_16x16x32_bf16 v[32:35], a[220:223], a[24:27], v[32:35]
    v_exp_f32 v23, v23
    v_mfma_f32_16x16x32_bf16 v[32:35], a[224:227], a[28:31], v[32:35]
    v_add_f32 v4, v4, v22
    v_cvt_pk_bf16_f32 v12, v20, v21
    v_mfma_f32_16x16x32_bf16 v[96:99], a[228:231], v[16:19], 0
    v_exp_f32 v24, v24
    v_mfma_f32_16x16x32_bf16 v[100:103], a[232:235], v[16:19], 0
    v_add_f32 v4, v4, v23
    v_mfma_f32_16x16x32_bf16 v[104:107], a[236:239], v[16:19], 0
    v_exp_f32 v25, v25
    v_mfma_f32_16x16x32_bf16 v[108:111], a[240:243], v[16:19], 0
    v_add_f32 v4, v4, v24
    v_cvt_pk_bf16_f32 v13, v22, v23
    v_mfma_f32_16x16x32_bf16 v[112:115], a[244:247], v[16:19], 0
    s_waitcnt vmcnt(8)
    s_barrier
    v_exp_f32 v26, v26
    v_mfma_f32_16x16x32_bf16 v[116:119], a[248:251], v[16:19], 0
    ds_read_b64_tr_b16 a[104:105], v1 offset:8720
    ds_read_b64_tr_b16 a[106:107], v1 offset:9232
    ds_read_b64_tr_b16 a[108:109], v1 offset:8728
    v_add_f32 v4, v4, v25
    v_mfma_f32_16x16x32_bf16 v[120:123], a[252:255], v[16:19], 0
    v_exp_f32 v27, v27
    v_mfma_f32_16x16x32_bf16 v[124:127], a[100:103], v[16:19], 0
    ds_read_b64_tr_b16 a[110:111], v1 offset:9240
    ds_read_b64_tr_b16 a[112:113], v1 offset:8784
    ds_read_b64_tr_b16 a[114:115], v1 offset:9296
    v_add_f32 v4, v4, v26
    v_cvt_pk_bf16_f32 v14, v24, v25
    s_waitcnt vmcnt(7)
    v_lshlrev_b32 v20, 16, v208
    s_add_u32 m0, s21, 16896
    s_mov_b32 s20, 16384
    buffer_load_dwordx4 v2, s[8:11], s20 offen nt lds
    v_lshlrev_b32 v21, 16, v209
    v_and_b32 v208, s30, v208
    v_and_b32 v209, s30, v209
    v_pk_mul_f32 v[20:21], v[20:21], s[22:23]
    v_pk_mul_f32 v[208:209], v[208:209], s[22:23]
    v_cvt_pk_bf16_f32 v208, v20, v208
    v_cvt_pk_bf16_f32 v209, v21, v209
    v_accvgpr_write_b32 a32, v208
    v_accvgpr_write_b32 a33, v209
    v_lshlrev_b32 v22, 16, v210
    v_lshlrev_b32 v23, 16, v211
    v_and_b32 v210, s30, v210
    v_and_b32 v211, s30, v211
    v_pk_mul_f32 v[22:23], v[22:23], s[22:23]
    v_pk_mul_f32 v[210:211], v[210:211], s[22:23]
    v_cvt_pk_bf16_f32 v210, v22, v210
    v_cvt_pk_bf16_f32 v211, v23, v211
    v_accvgpr_write_b32 a34, v210
    v_accvgpr_write_b32 a35, v211
    s_waitcnt vmcnt(7)
    v_lshlrev_b32 v20, 16, v212
    s_add_u32 m0, s21, 19072
    s_nop 0
    buffer_load_dwordx4 v2, s[8:11], s20 offen offset:2048 nt lds
    v_lshlrev_b32 v21, 16, v213
    v_and_b32 v212, s30, v212
    v_and_b32 v213, s30, v213
    v_pk_mul_f32 v[20:21], v[20:21], s[22:23]
    v_pk_mul_f32 v[212:213], v[212:213], s[22:23]
    v_cvt_pk_bf16_f32 v212, v20, v212
    v_cvt_pk_bf16_f32 v213, v21, v213
    v_accvgpr_write_b32 a36, v212
    v_accvgpr_write_b32 a37, v213
    v_lshlrev_b32 v22, 16, v214
    v_lshlrev_b32 v23, 16, v215
    v_and_b32 v214, s30, v214
    v_and_b32 v215, s30, v215
    v_pk_mul_f32 v[22:23], v[22:23], s[22:23]
    v_pk_mul_f32 v[214:215], v[214:215], s[22:23]
    v_cvt_pk_bf16_f32 v214, v22, v214
    v_cvt_pk_bf16_f32 v215, v23, v215
    v_accvgpr_write_b32 a38, v214
    v_accvgpr_write_b32 a39, v215
    s_waitcnt vmcnt(7)
    v_lshlrev_b32 v20, 16, v216
    s_add_u32 m0, s39, 85024
    s_mov_b32 s25, 16384
    buffer_load_dwordx4 v3, s[12:15], s25 offen nt lds
    v_lshlrev_b32 v21, 16, v217
    v_and_b32 v216, s30, v216
    v_and_b32 v217, s30, v217
    v_pk_mul_f32 v[20:21], v[20:21], s[22:23]
    v_pk_mul_f32 v[216:217], v[216:217], s[22:23]
    v_cvt_pk_bf16_f32 v216, v20, v216
    v_cvt_pk_bf16_f32 v217, v21, v217
    v_accvgpr_write_b32 a40, v216
    v_accvgpr_write_b32 a41, v217
    v_lshlrev_b32 v22, 16, v218
    v_lshlrev_b32 v23, 16, v219
    v_and_b32 v218, s30, v218
    v_and_b32 v219, s30, v219
    v_pk_mul_f32 v[22:23], v[22:23], s[22:23]
    v_pk_mul_f32 v[218:219], v[218:219], s[22:23]
    v_cvt_pk_bf16_f32 v218, v22, v218
    v_cvt_pk_bf16_f32 v219, v23, v219
    v_accvgpr_write_b32 a42, v218
    v_accvgpr_write_b32 a43, v219
    s_waitcnt vmcnt(7)
    v_lshlrev_b32 v20, 16, v220
    s_add_u32 m0, s39, 88360
    s_nop 0
    buffer_load_dwordx4 v3, s[12:15], s25 offen offset:1024 nt lds
    v_lshlrev_b32 v21, 16, v221
    v_and_b32 v220, s30, v220
    v_and_b32 v221, s30, v221
    v_pk_mul_f32 v[20:21], v[20:21], s[22:23]
    v_pk_mul_f32 v[220:221], v[220:221], s[22:23]
    v_cvt_pk_bf16_f32 v220, v20, v220
    v_cvt_pk_bf16_f32 v221, v21, v221
    v_accvgpr_write_b32 a44, v220
    v_accvgpr_write_b32 a45, v221
    v_lshlrev_b32 v22, 16, v222
    v_lshlrev_b32 v23, 16, v223
    v_and_b32 v222, s30, v222
    v_and_b32 v223, s30, v223
    v_pk_mul_f32 v[22:23], v[22:23], s[22:23]
    v_pk_mul_f32 v[222:223], v[222:223], s[22:23]
    v_cvt_pk_bf16_f32 v222, v22, v222
    v_cvt_pk_bf16_f32 v223, v23, v223
    v_accvgpr_write_b32 a46, v222
    v_accvgpr_write_b32 a47, v223
    v_mfma_f32_16x16x32_bf16 v[20:23], a[196:199], a[32:35], 0
    v_exp_f32 v28, v28
    v_mfma_f32_16x16x32_bf16 v[20:23], a[200:203], a[36:39], v[20:23]
    ds_read_b64_tr_b16 a[116:117], v1 offset:8792
    ds_read_b64_tr_b16 a[118:119], v1 offset:9304
    ds_read_b64_tr_b16 a[120:121], v1 offset:8848
    v_add_f32 v4, v4, v27
    v_mfma_f32_16x16x32_bf16 v[20:23], a[204:207], a[40:43], v[20:23]
    v_exp_f32 v29, v29
    v_mfma_f32_16x16x32_bf16 v[20:23], a[208:211], a[44:47], v[20:23]
    ds_read_b64_tr_b16 a[122:123], v1 offset:9360
    ds_read_b64_tr_b16 a[124:125], v1 offset:8856
    v_cvt_pk_bf16_f32 v15, v26, v27
    v_add_f32 v5, v5, v28
    v_mfma_f32_16x16x32_bf16 v[24:27], a[212:215], a[32:35], 0
    v_exp_f32 v30, v30
    v_mfma_f32_16x16x32_bf16 v[24:27], a[216:219], a[36:39], v[24:27]
    ds_read_b64_tr_b16 a[126:127], v1 offset:9368
    ds_read_b64_tr_b16 a[192:193], v1 offset:8912
    ds_read_b64_tr_b16 a[194:195], v1 offset:9424
    v_add_f32 v5, v5, v29
    v_mfma_f32_16x16x32_bf16 v[24:27], a[220:223], a[40:43], v[24:27]
    s_waitcnt lgkmcnt(11)
    v_exp_f32 v31, v31
    v_mfma_f32_16x16x32_bf16 v[24:27], a[224:227], a[44:47], v[24:27]
    ds_read_b64_tr_b16 a[228:229], v1 offset:8920
    ds_read_b64_tr_b16 a[230:231], v1 offset:9432
    v_add_f32 v5, v5, v30
    v_cvt_pk_bf16_f32 v16, v28, v29
    v_mfma_f32_16x16x32_bf16 v[64:67], a[104:107], v[12:15], v[64:67]
    s_waitcnt lgkmcnt(10)
    v_exp_f32 v32, v32
    v_mfma_f32_16x16x32_bf16 v[68:71], a[108:111], v[12:15], v[68:71]
    ds_read_b128 a[232:235], v0 offset:0
    v_add_f32 v5, v5, v31
    v_mfma_f32_16x16x32_bf16 v[72:75], a[112:115], v[12:15], v[72:75]
    s_waitcnt lgkmcnt(8)
    v_exp_f32 v33, v33
    v_mfma_f32_16x16x32_bf16 v[76:79], a[116:119], v[12:15], v[76:79]
    s_waitcnt lgkmcnt(6)
    v_add_f32 v5, v5, v32
    v_cvt_pk_bf16_f32 v17, v30, v31
    v_mfma_f32_16x16x32_bf16 v[80:83], a[120:123], v[12:15], v[80:83]
    s_waitcnt lgkmcnt(3)
    v_exp_f32 v34, v34
    v_mfma_f32_16x16x32_bf16 v[84:87], a[124:127], v[12:15], v[84:87]
    ds_read_b128 a[236:239], v0 offset:64
    v_add_f32 v5, v5, v33
    v_mfma_f32_16x16x32_bf16 v[88:91], a[192:195], v[12:15], v[88:91]
    s_waitcnt lgkmcnt(2)
    v_exp_f32 v35, v35
    v_mfma_f32_16x16x32_bf16 v[92:95], a[228:231], v[12:15], v[92:95]
    v_add_f32 v5, v5, v34
    v_cvt_pk_bf16_f32 v18, v32, v33
    s_waitcnt vmcnt(7)
    v_lshlrev_b32 v28, 16, v240
    s_add_u32 s24, s43, 16384
    s_and_b32 s24, s24, 0x7fff
    buffer_load_dwordx4 v[128:131], v11, s[4:7], s24 offen offset:0 nt
    v_lshlrev_b32 v29, 16, v241
    v_and_b32 v240, s30, v240
    v_and_b32 v241, s30, v241
    v_pk_mul_f32 v[28:29], v[28:29], s[22:23]
    v_pk_mul_f32 v[240:241], v[240:241], s[22:23]
    v_cvt_pk_bf16_f32 v240, v28, v240
    v_cvt_pk_bf16_f32 v241, v29, v241
    v_accvgpr_write_b32 a48, v240
    v_accvgpr_write_b32 a49, v241
    v_lshlrev_b32 v30, 16, v242
    v_lshlrev_b32 v31, 16, v243
    v_and_b32 v242, s30, v242
    v_and_b32 v243, s30, v243
    v_pk_mul_f32 v[30:31], v[30:31], s[22:23]
    v_pk_mul_f32 v[242:243], v[242:243], s[22:23]
    v_cvt_pk_bf16_f32 v242, v30, v242
    v_cvt_pk_bf16_f32 v243, v31, v243
    v_accvgpr_write_b32 a50, v242
    v_accvgpr_write_b32 a51, v243
    s_waitcnt vmcnt(7)
    v_lshlrev_b32 v28, 16, v244
    buffer_load_dwordx4 v[132:135], v11, s[4:7], s24 offen offset:64 nt
    v_lshlrev_b32 v29, 16, v245
    v_and_b32 v244, s30, v244
    v_and_b32 v245, s30, v245
    v_pk_mul_f32 v[28:29], v[28:29], s[22:23]
    v_pk_mul_f32 v[244:245], v[244:245], s[22:23]
    v_cvt_pk_bf16_f32 v244, v28, v244
    v_cvt_pk_bf16_f32 v245, v29, v245
    v_accvgpr_write_b32 a52, v244
    v_accvgpr_write_b32 a53, v245
    v_lshlrev_b32 v30, 16, v246
    v_lshlrev_b32 v31, 16, v247
    v_and_b32 v246, s30, v246
    v_and_b32 v247, s30, v247
    v_pk_mul_f32 v[30:31], v[30:31], s[22:23]
    v_pk_mul_f32 v[246:247], v[246:247], s[22:23]
    v_cvt_pk_bf16_f32 v246, v30, v246
    v_cvt_pk_bf16_f32 v247, v31, v247
    v_accvgpr_write_b32 a54, v246
    v_accvgpr_write_b32 a55, v247
    s_waitcnt vmcnt(7)
    v_lshlrev_b32 v28, 16, v248
    buffer_load_dwordx4 v[136:139], v11, s[4:7], s24 offen offset:128 nt
    v_lshlrev_b32 v29, 16, v249
    v_and_b32 v248, s30, v248
    v_and_b32 v249, s30, v249
    v_pk_mul_f32 v[28:29], v[28:29], s[22:23]
    v_pk_mul_f32 v[248:249], v[248:249], s[22:23]
    v_cvt_pk_bf16_f32 v248, v28, v248
    v_cvt_pk_bf16_f32 v249, v29, v249
    v_accvgpr_write_b32 a56, v248
    v_accvgpr_write_b32 a57, v249
    v_lshlrev_b32 v30, 16, v250
    v_lshlrev_b32 v31, 16, v251
    v_and_b32 v250, s30, v250
    v_and_b32 v251, s30, v251
    v_pk_mul_f32 v[30:31], v[30:31], s[22:23]
    v_pk_mul_f32 v[250:251], v[250:251], s[22:23]
    v_cvt_pk_bf16_f32 v250, v30, v250
    v_cvt_pk_bf16_f32 v251, v31, v251
    v_accvgpr_write_b32 a58, v250
    v_accvgpr_write_b32 a59, v251
    s_waitcnt vmcnt(7)
    v_lshlrev_b32 v28, 16, v252
    buffer_load_dwordx4 v[140:143], v11, s[4:7], s24 offen offset:192 nt
    v_lshlrev_b32 v29, 16, v253
    v_and_b32 v252, s30, v252
    v_and_b32 v253, s30, v253
    v_pk_mul_f32 v[28:29], v[28:29], s[22:23]
    v_pk_mul_f32 v[252:253], v[252:253], s[22:23]
    v_cvt_pk_bf16_f32 v252, v28, v252
    v_cvt_pk_bf16_f32 v253, v29, v253
    v_accvgpr_write_b32 a60, v252
    v_accvgpr_write_b32 a61, v253
    v_lshlrev_b32 v30, 16, v254
    v_lshlrev_b32 v31, 16, v255
    v_and_b32 v254, s30, v254
    v_and_b32 v255, s30, v255
    v_pk_mul_f32 v[30:31], v[30:31], s[22:23]
    v_pk_mul_f32 v[254:255], v[254:255], s[22:23]
    v_cvt_pk_bf16_f32 v254, v30, v254
    v_cvt_pk_bf16_f32 v255, v31, v255
    v_accvgpr_write_b32 a62, v254
    v_accvgpr_write_b32 a63, v255
    v_mfma_f32_16x16x32_bf16 v[28:31], a[196:199], a[48:51], 0
    v_exp_f32 v20, v20
    v_mfma_f32_16x16x32_bf16 v[28:31], a[200:203], a[52:55], v[28:31]
    ds_read_b128 a[240:243], v0 offset:128
    v_add_f32 v5, v5, v35
    v_mfma_f32_16x16x32_bf16 v[28:31], a[204:207], a[56:59], v[28:31]
    v_exp_f32 v21, v21
    v_mfma_f32_16x16x32_bf16 v[28:31], a[208:211], a[60:63], v[28:31]
    v_cvt_pk_bf16_f32 v19, v34, v35
    v_mov_b32 v6, v20
    v_mfma_f32_16x16x32_bf16 v[32:35], a[212:215], a[48:51], 0
    v_exp_f32 v22, v22
    v_mfma_f32_16x16x32_bf16 v[32:35], a[216:219], a[52:55], v[32:35]
    ds_read_b128 a[244:247], v0 offset:192
    v_add_f32 v6, v6, v21
    v_mfma_f32_16x16x32_bf16 v[32:35], a[220:223], a[56:59], v[32:35]
    v_exp_f32 v23, v23
    v_mfma_f32_16x16x32_bf16 v[32:35], a[224:227], a[60:63], v[32:35]
    v_add_f32 v6, v6, v22
    v_cvt_pk_bf16_f32 v12, v20, v21
    v_mfma_f32_16x16x32_bf16 v[96:99], a[104:107], v[16:19], v[96:99]
    v_exp_f32 v24, v24
    v_mfma_f32_16x16x32_bf16 v[100:103], a[108:111], v[16:19], v[100:103]
    ds_read_b128 a[248:251], v0 offset:512
    v_add_f32 v6, v6, v23
    v_mfma_f32_16x16x32_bf16 v[104:107], a[112:115], v[16:19], v[104:107]
    v_exp_f32 v25, v25
    v_mfma_f32_16x16x32_bf16 v[108:111], a[116:119], v[16:19], v[108:111]
    v_add_f32 v6, v6, v24
    v_cvt_pk_bf16_f32 v13, v22, v23
    v_mfma_f32_16x16x32_bf16 v[112:115], a[120:123], v[16:19], v[112:115]
    v_exp_f32 v26, v26
    v_mfma_f32_16x16x32_bf16 v[116:119], a[124:127], v[16:19], v[116:119]
    ds_read_b128 a[252:255], v0 offset:576
    ds_read_b128 a[100:103], v0 offset:640
    v_add_f32 v6, v6, v25
    v_mfma_f32_16x16x32_bf16 v[120:123], a[192:195], v[16:19], v[120:123]
    s_waitcnt lgkmcnt(3)
    v_exp_f32 v27, v27
    v_mfma_f32_16x16x32_bf16 v[124:127], a[228:231], v[16:19], v[124:127]
    ds_read_b128 a[196:199], v0 offset:704
    v_add_f32 v6, v6, v26
    v_cvt_pk_bf16_f32 v14, v24, v25
    v_mfma_f32_16x16x32_bf16 v[20:23], a[232:235], a[32:35], 0
    v_exp_f32 v28, v28
    v_mfma_f32_16x16x32_bf16 v[20:23], a[236:239], a[36:39], v[20:23]
    ds_read_b64_tr_b16 a[200:201], v1 offset:0
    v_add_f32 v6, v6, v27
    v_mfma_f32_16x16x32_bf16 v[20:23], a[240:243], a[40:43], v[20:23]
    s_waitcnt lgkmcnt(4)
    s_add_u32 s24, s43, 20480
    s_and_b32 s24, s24, 0x7fff
    v_exp_f32 v29, v29
    v_mfma_f32_16x16x32_bf16 v[20:23], a[244:247], a[44:47], v[20:23]
    buffer_load_dwordx4 v[160:163], v11, s[4:7], s24 offen offset:0 nt
    v_cvt_pk_bf16_f32 v15, v26, v27
    v_mov_b32 v7, v28
    v_mfma_f32_16x16x32_bf16 v[24:27], a[248:251], a[32:35], 0
    s_waitcnt lgkmcnt(2)
    v_exp_f32 v30, v30
    v_mfma_f32_16x16x32_bf16 v[24:27], a[252:255], a[36:39], v[24:27]
    ds_read_b64_tr_b16 a[202:203], v1 offset:512
    v_add_f32 v7, v7, v29
    v_mfma_f32_16x16x32_bf16 v[24:27], a[100:103], a[40:43], v[24:27]
    s_waitcnt lgkmcnt(2)
    v_exp_f32 v31, v31
    v_mfma_f32_16x16x32_bf16 v[24:27], a[196:199], a[44:47], v[24:27]
    v_add_f32 v7, v7, v30
    v_cvt_pk_bf16_f32 v16, v28, v29
    v_mfma_f32_16x16x32_bf16 a[128:131], a[104:107], v[12:15], 0
    v_exp_f32 v32, v32
    v_mfma_f32_16x16x32_bf16 a[132:135], a[108:111], v[12:15], 0
    ds_read_b64_tr_b16 a[204:205], v1 offset:8
    v_add_f32 v7, v7, v31
    v_mfma_f32_16x16x32_bf16 a[136:139], a[112:115], v[12:15], 0
    v_exp_f32 v33, v33
    v_mfma_f32_16x16x32_bf16 a[140:143], a[116:119], v[12:15], 0
    v_add_f32 v7, v7, v32
    v_cvt_pk_bf16_f32 v17, v30, v31
    v_mfma_f32_16x16x32_bf16 a[144:147], a[120:123], v[12:15], 0
    v_exp_f32 v34, v34
    v_mfma_f32_16x16x32_bf16 a[148:151], a[124:127], v[12:15], 0
    ds_read_b64_tr_b16 a[206:207], v1 offset:520
    v_add_f32 v7, v7, v33
    v_mfma_f32_16x16x32_bf16 a[152:155], a[192:195], v[12:15], 0
    v_exp_f32 v35, v35
    v_mfma_f32_16x16x32_bf16 a[156:159], a[228:231], v[12:15], 0
    v_add_f32 v7, v7, v34
    v_cvt_pk_bf16_f32 v18, v32, v33
    v_mfma_f32_16x16x32_bf16 v[28:31], a[232:235], a[48:51], 0
    v_exp_f32 v20, v20
    v_mfma_f32_16x16x32_bf16 v[28:31], a[236:239], a[52:55], v[28:31]
    ds_read_b64_tr_b16 a[208:209], v1 offset:64
    v_add_f32 v7, v7, v35
    v_mfma_f32_16x16x32_bf16 v[28:31], a[240:243], a[56:59], v[28:31]
    v_exp_f32 v21, v21
    v_mfma_f32_16x16x32_bf16 v[28:31], a[244:247], a[60:63], v[28:31]
    v_cvt_pk_bf16_f32 v19, v34, v35
    v_add_f32 v6, v6, v20
    v_mfma_f32_16x16x32_bf16 v[32:35], a[248:251], a[48:51], 0
    s_waitcnt vmcnt(5)
    s_barrier
    buffer_load_dwordx4 v[164:167], v11, s[4:7], s24 offen offset:64 nt
    buffer_load_dwordx4 v[168:171], v11, s[4:7], s24 offen offset:128 nt
    buffer_load_dwordx4 v[172:175], v11, s[4:7], s24 offen offset:192 nt
    v_exp_f32 v22, v22
    v_mfma_f32_16x16x32_bf16 v[32:35], a[252:255], a[52:55], v[32:35]
    ds_read_b128 a[212:215], v0 offset:16896
    v_add_f32 v6, v6, v21
    v_mfma_f32_16x16x32_bf16 v[32:35], a[100:103], a[56:59], v[32:35]
    v_exp_f32 v23, v23
    v_mfma_f32_16x16x32_bf16 v[32:35], a[196:199], a[60:63], v[32:35]
    v_add_f32 v6, v6, v22
    v_cvt_pk_bf16_f32 v12, v20, v21
    v_mfma_f32_16x16x32_bf16 a[160:163], a[104:107], v[16:19], 0
    v_exp_f32 v24, v24
    v_mfma_f32_16x16x32_bf16 a[164:167], a[108:111], v[16:19], 0
    ds_read_b128 a[216:219], v0 offset:16960
    ds_read_b128 a[220:223], v0 offset:17024
    v_add_f32 v6, v6, v23
    v_mfma_f32_16x16x32_bf16 a[168:171], a[112:115], v[16:19], 0
    v_exp_f32 v25, v25
    v_mfma_f32_16x16x32_bf16 a[172:175], a[116:119], v[16:19], 0
    ds_read_b128 a[224:227], v0 offset:17088
    ds_read_b128 a[232:235], v0 offset:17408
    v_add_f32 v6, v6, v24
    v_cvt_pk_bf16_f32 v13, v22, v23
    v_mfma_f32_16x16x32_bf16 a[176:179], a[120:123], v[16:19], 0
    v_exp_f32 v26, v26
    v_mfma_f32_16x16x32_bf16 a[180:183], a[124:127], v[16:19], 0
    ds_read_b128 a[236:239], v0 offset:17472
    ds_read_b128 a[240:243], v0 offset:17536
    v_add_f32 v6, v6, v25
    v_mfma_f32_16x16x32_bf16 a[184:187], a[192:195], v[16:19], 0
    s_waitcnt lgkmcnt(6)
    v_exp_f32 v27, v27
    v_mfma_f32_16x16x32_bf16 a[188:191], a[228:231], v[16:19], 0
    ds_read_b128 a[244:247], v0 offset:17600
    ds_read_b64_tr_b16 a[210:211], v1 offset:576
    v_add_f32 v6, v6, v26
    v_cvt_pk_bf16_f32 v14, v24, v25
    v_mfma_f32_16x16x32_bf16 v[20:23], a[212:215], a[0:3], 0
    s_waitcnt lgkmcnt(6)
    v_exp_f32 v28, v28
    v_mfma_f32_16x16x32_bf16 v[20:23], a[216:219], a[4:7], v[20:23]
    ds_read_b64_tr_b16 a[248:249], v1 offset:72
    ds_read_b64_tr_b16 a[250:251], v1 offset:584
    ds_read_b64_tr_b16 a[252:253], v1 offset:128
    v_add_f32 v6, v6, v27
    v_mfma_f32_16x16x32_bf16 v[20:23], a[220:223], a[8:11], v[20:23]
    s_waitcnt lgkmcnt(7)
    v_exp_f32 v29, v29
    v_mfma_f32_16x16x32_bf16 v[20:23], a[224:227], a[12:15], v[20:23]
    ds_read_b64_tr_b16 a[254:255], v1 offset:640
    ds_read_b64_tr_b16 a[100:101], v1 offset:136
    v_cvt_pk_bf16_f32 v15, v26, v27
    v_add_f32 v7, v7, v28
    v_mfma_f32_16x16x32_bf16 v[24:27], a[232:235], a[0:3], 0
    s_waitcnt lgkmcnt(7)
    v_exp_f32 v30, v30
    v_mfma_f32_16x16x32_bf16 v[24:27], a[236:239], a[4:7], v[24:27]
    ds_read_b64_tr_b16 a[102:103], v1 offset:648
    ds_read_b64_tr_b16 a[196:197], v1 offset:192
    ds_read_b64_tr_b16 a[198:199], v1 offset:704
    v_add_f32 v7, v7, v29
    v_mfma_f32_16x16x32_bf16 v[24:27], a[240:243], a[8:11], v[24:27]
    s_waitcnt lgkmcnt(9)
    s_add_u32 m0, s21, 25344
    s_mov_b32 s20, 24576
    v_exp_f32 v31, v31
    v_mfma_f32_16x16x32_bf16 v[24:27], a[244:247], a[12:15], v[24:27]
    ds_read_b64_tr_b16 a[104:105], v1 offset:200
    ds_read_b64_tr_b16 a[106:107], v1 offset:712
    buffer_load_dwordx4 v2, s[8:11], s20 offen nt lds
    v_add_f32 v7, v7, v30
    v_cvt_pk_bf16_f32 v16, v28, v29
    v_mfma_f32_16x16x32_bf16 a[128:131], a[200:203], v[12:15], a[128:131]
    s_waitcnt lgkmcnt(10)
    v_exp_f32 v32, v32
    v_mfma_f32_16x16x32_bf16 a[132:135], a[204:207], v[12:15], a[132:135]
    ds_read_b64_tr_b16 a[108:109], v1 offset:17440
    v_add_f32 v7, v7, v31
    v_mfma_f32_16x16x32_bf16 a[136:139], a[208:211], v[12:15], a[136:139]
    s_waitcnt lgkmcnt(8)
    v_exp_f32 v33, v33
    v_mfma_f32_16x16x32_bf16 a[140:143], a[248:251], v[12:15], a[140:143]
    s_waitcnt lgkmcnt(6)
    v_add_f32 v7, v7, v32
    v_cvt_pk_bf16_f32 v17, v30, v31
    v_mfma_f32_16x16x32_bf16 a[144:147], a[252:255], v[12:15], a[144:147]
    s_waitcnt lgkmcnt(3)
    v_exp_f32 v34, v34
    v_mfma_f32_16x16x32_bf16 a[148:151], a[100:103], v[12:15], a[148:151]
    ds_read_b64_tr_b16 a[110:111], v1 offset:17952
    v_add_f32 v7, v7, v33
    v_mfma_f32_16x16x32_bf16 a[152:155], a[196:199], v[12:15], a[152:155]
    s_waitcnt lgkmcnt(2)
    v_exp_f32 v35, v35
    v_mfma_f32_16x16x32_bf16 a[156:159], a[104:107], v[12:15], a[156:159]
    v_add_f32 v7, v7, v34
    v_cvt_pk_bf16_f32 v18, v32, v33
    v_mfma_f32_16x16x32_bf16 v[28:31], a[212:215], a[16:19], 0
    v_exp_f32 v20, v20
    v_mfma_f32_16x16x32_bf16 v[28:31], a[216:219], a[20:23], v[28:31]
    ds_read_b64_tr_b16 a[112:113], v1 offset:17448
    v_add_f32 v7, v7, v35
    v_mfma_f32_16x16x32_bf16 v[28:31], a[220:223], a[24:27], v[28:31]
    v_exp_f32 v21, v21
    v_mfma_f32_16x16x32_bf16 v[28:31], a[224:227], a[28:31], v[28:31]
    v_cvt_pk_bf16_f32 v19, v34, v35
    v_add_f32 v4, v4, v20
    v_mfma_f32_16x16x32_bf16 v[32:35], a[232:235], a[16:19], 0
    v_exp_f32 v22, v22
    v_mfma_f32_16x16x32_bf16 v[32:35], a[236:239], a[20:23], v[32:35]
    ds_read_b64_tr_b16 a[114:115], v1 offset:17960
    v_add_f32 v4, v4, v21
    v_mfma_f32_16x16x32_bf16 v[32:35], a[240:243], a[24:27], v[32:35]
    v_exp_f32 v23, v23
    v_mfma_f32_16x16x32_bf16 v[32:35], a[244:247], a[28:31], v[32:35]
    v_add_f32 v4, v4, v22
    v_cvt_pk_bf16_f32 v12, v20, v21
    v_mfma_f32_16x16x32_bf16 a[160:163], a[200:203], v[16:19], a[160:163]
    v_exp_f32 v24, v24
    v_mfma_f32_16x16x32_bf16 a[164:167], a[204:207], v[16:19], a[164:167]
    s_add_u32 m0, s21, 27520
    ds_read_b64_tr_b16 a[116:117], v1 offset:17504
    v_add_f32 v4, v4, v23
    v_mfma_f32_16x16x32_bf16 a[168:171], a[208:211], v[16:19], a[168:171]
    buffer_load_dwordx4 v2, s[8:11], s20 offen offset:2048 nt lds
    v_exp_f32 v25, v25
    v_mfma_f32_16x16x32_bf16 a[172:175], a[248:251], v[16:19], a[172:175]
    v_add_f32 v4, v4, v24
    v_cvt_pk_bf16_f32 v13, v22, v23
    v_mfma_f32_16x16x32_bf16 a[176:179], a[252:255], v[16:19], a[176:179]
    v_exp_f32 v26, v26
    v_mfma_f32_16x16x32_bf16 a[180:183], a[100:103], v[16:19], a[180:183]
    ds_read_b64_tr_b16 a[118:119], v1 offset:18016
    v_add_f32 v4, v4, v25
    v_mfma_f32_16x16x32_bf16 a[184:187], a[196:199], v[16:19], a[184:187]
    v_exp_f32 v27, v27
    v_mfma_f32_16x16x32_bf16 a[188:191], a[104:107], v[16:19], a[188:191]
    v_add_f32 v4, v4, v26
    v_cvt_pk_bf16_f32 v14, v24, v25
    v_mfma_f32_16x16x32_bf16 v[20:23], a[212:215], a[32:35], 0
    v_exp_f32 v28, v28
    v_mfma_f32_16x16x32_bf16 v[20:23], a[216:219], a[36:39], v[20:23]
    ds_read_b64_tr_b16 a[120:121], v1 offset:17512
    ds_read_b64_tr_b16 a[122:123], v1 offset:18024
    ds_read_b64_tr_b16 a[124:125], v1 offset:17568
    v_add_f32 v4, v4, v27
    v_mfma_f32_16x16x32_bf16 v[20:23], a[220:223], a[40:43], v[20:23]
    v_exp_f32 v29, v29
    v_mfma_f32_16x16x32_bf16 v[20:23], a[224:227], a[44:47], v[20:23]
    ds_read_b64_tr_b16 a[126:127], v1 offset:18080
    ds_read_b64_tr_b16 a[192:193], v1 offset:17576
    v_cvt_pk_bf16_f32 v15, v26, v27
    v_add_f32 v5, v5, v28
    v_mfma_f32_16x16x32_bf16 v[24:27], a[232:235], a[32:35], 0
    v_exp_f32 v30, v30
    v_mfma_f32_16x16x32_bf16 v[24:27], a[236:239], a[36:39], v[24:27]
    ds_read_b64_tr_b16 a[194:195], v1 offset:18088
    ds_read_b64_tr_b16 a[228:229], v1 offset:17632
    ds_read_b64_tr_b16 a[230:231], v1 offset:18144
    v_add_f32 v5, v5, v29
    v_mfma_f32_16x16x32_bf16 v[24:27], a[240:243], a[40:43], v[24:27]
    s_waitcnt lgkmcnt(8)
    v_exp_f32 v31, v31
    v_mfma_f32_16x16x32_bf16 v[24:27], a[244:247], a[44:47], v[24:27]
    ds_read_b64_tr_b16 a[200:201], v1 offset:17640
    ds_read_b64_tr_b16 a[202:203], v1 offset:18152
    v_add_f32 v5, v5, v30
    v_cvt_pk_bf16_f32 v16, v28, v29
    v_mfma_f32_16x16x32_bf16 v[64:67], a[108:111], v[12:15], v[64:67]
    v_exp_f32 v32, v32
    v_mfma_f32_16x16x32_bf16 v[68:71], a[112:115], v[12:15], v[68:71]
    ds_read_b128 a[204:207], v0 offset:8448
    v_add_f32 v5, v5, v31
    v_mfma_f32_16x16x32_bf16 v[72:75], a[116:119], v[12:15], v[72:75]
    s_waitcnt lgkmcnt(8)
    v_exp_f32 v33, v33
    v_mfma_f32_16x16x32_bf16 v[76:79], a[120:123], v[12:15], v[76:79]
    s_waitcnt lgkmcnt(6)
    v_add_f32 v5, v5, v32
    v_cvt_pk_bf16_f32 v17, v30, v31
    v_mfma_f32_16x16x32_bf16 v[80:83], a[124:127], v[12:15], v[80:83]
    s_waitcnt lgkmcnt(3)
    s_add_u32 m0, s39, 93744
    s_mov_b32 s25, 24576
    v_exp_f32 v34, v34
    v_mfma_f32_16x16x32_bf16 v[84:87], a[192:195], v[12:15], v[84:87]
    ds_read_b128 a[208:211], v0 offset:8512
    buffer_load_dwordx4 v3, s[12:15], s25 offen nt lds
    v_add_f32 v5, v5, v33
    v_mfma_f32_16x16x32_bf16 v[88:91], a[228:231], v[12:15], v[88:91]
    s_waitcnt lgkmcnt(2)
    v_exp_f32 v35, v35
    v_mfma_f32_16x16x32_bf16 v[92:95], a[200:203], v[12:15], v[92:95]
    v_add_f32 v5, v5, v34
    v_cvt_pk_bf16_f32 v18, v32, v33
    v_mfma_f32_16x16x32_bf16 v[28:31], a[212:215], a[48:51], 0
    v_exp_f32 v20, v20
    v_mfma_f32_16x16x32_bf16 v[28:31], a[216:219], a[52:55], v[28:31]
    ds_read_b128 a[248:251], v0 offset:8576
    v_add_f32 v5, v5, v35
    v_mfma_f32_16x16x32_bf16 v[28:31], a[220:223], a[56:59], v[28:31]
    v_exp_f32 v21, v21
    v_mfma_f32_16x16x32_bf16 v[28:31], a[224:227], a[60:63], v[28:31]
    v_cvt_pk_bf16_f32 v19, v34, v35
    v_add_f32 v6, v6, v20
    v_mfma_f32_16x16x32_bf16 v[32:35], a[232:235], a[48:51], 0
    v_exp_f32 v22, v22
    v_mfma_f32_16x16x32_bf16 v[32:35], a[236:239], a[52:55], v[32:35]
    ds_read_b128 a[252:255], v0 offset:8640
    v_add_f32 v6, v6, v21
    v_mfma_f32_16x16x32_bf16 v[32:35], a[240:243], a[56:59], v[32:35]
    v_exp_f32 v23, v23
    v_mfma_f32_16x16x32_bf16 v[32:35], a[244:247], a[60:63], v[32:35]
    v_add_f32 v6, v6, v22
    v_cvt_pk_bf16_f32 v12, v20, v21
    v_mfma_f32_16x16x32_bf16 v[96:99], a[108:111], v[16:19], v[96:99]
    v_exp_f32 v24, v24
    v_mfma_f32_16x16x32_bf16 v[100:103], a[112:115], v[16:19], v[100:103]
    ds_read_b128 a[100:103], v0 offset:8960
    v_add_f32 v6, v6, v23
    v_mfma_f32_16x16x32_bf16 v[104:107], a[116:119], v[16:19], v[104:107]
    v_exp_f32 v25, v25
    v_mfma_f32_16x16x32_bf16 v[108:111], a[120:123], v[16:19], v[108:111]
    v_add_f32 v6, v6, v24
    v_cvt_pk_bf16_f32 v13, v22, v23
    v_mfma_f32_16x16x32_bf16 v[112:115], a[124:127], v[16:19], v[112:115]
    v_exp_f32 v26, v26
    v_mfma_f32_16x16x32_bf16 v[116:119], a[192:195], v[16:19], v[116:119]
    ds_read_b128 a[196:199], v0 offset:9024
    v_add_f32 v6, v6, v25
    v_mfma_f32_16x16x32_bf16 v[120:123], a[228:231], v[16:19], v[120:123]
    v_exp_f32 v27, v27
    v_mfma_f32_16x16x32_bf16 v[124:127], a[200:203], v[16:19], v[124:127]
    v_add_f32 v6, v6, v26
    v_cvt_pk_bf16_f32 v14, v24, v25
    s_waitcnt vmcnt(10)
    v_lshlrev_b32 v20, 16, v128
    v_lshlrev_b32 v21, 16, v129
    v_and_b32 v128, s30, v128
    v_and_b32 v129, s30, v129
    v_pk_mul_f32 v[20:21], v[20:21], s[22:23]
    v_pk_mul_f32 v[128:129], v[128:129], s[22:23]
    v_cvt_pk_bf16_f32 v128, v20, v128
    v_cvt_pk_bf16_f32 v129, v21, v129
    v_accvgpr_write_b32 a64, v128
    v_accvgpr_write_b32 a65, v129
    v_lshlrev_b32 v22, 16, v130
    v_lshlrev_b32 v23, 16, v131
    v_and_b32 v130, s30, v130
    v_and_b32 v131, s30, v131
    v_pk_mul_f32 v[22:23], v[22:23], s[22:23]
    v_pk_mul_f32 v[130:131], v[130:131], s[22:23]
    v_cvt_pk_bf16_f32 v130, v22, v130
    v_cvt_pk_bf16_f32 v131, v23, v131
    v_accvgpr_write_b32 a66, v130
    v_accvgpr_write_b32 a67, v131
    s_waitcnt vmcnt(9)
    v_lshlrev_b32 v20, 16, v132
    v_lshlrev_b32 v21, 16, v133
    v_and_b32 v132, s30, v132
    v_and_b32 v133, s30, v133
    v_pk_mul_f32 v[20:21], v[20:21], s[22:23]
    v_pk_mul_f32 v[132:133], v[132:133], s[22:23]
    v_cvt_pk_bf16_f32 v132, v20, v132
    v_cvt_pk_bf16_f32 v133, v21, v133
    v_accvgpr_write_b32 a68, v132
    v_accvgpr_write_b32 a69, v133
    v_lshlrev_b32 v22, 16, v134
    v_lshlrev_b32 v23, 16, v135
    v_and_b32 v134, s30, v134
    v_and_b32 v135, s30, v135
    v_pk_mul_f32 v[22:23], v[22:23], s[22:23]
    v_pk_mul_f32 v[134:135], v[134:135], s[22:23]
    v_cvt_pk_bf16_f32 v134, v22, v134
    v_cvt_pk_bf16_f32 v135, v23, v135
    v_accvgpr_write_b32 a70, v134
    v_accvgpr_write_b32 a71, v135
    s_waitcnt vmcnt(8)
    v_lshlrev_b32 v20, 16, v136
    v_lshlrev_b32 v21, 16, v137
    v_and_b32 v136, s30, v136
    v_and_b32 v137, s30, v137
    v_pk_mul_f32 v[20:21], v[20:21], s[22:23]
    v_pk_mul_f32 v[136:137], v[136:137], s[22:23]
    v_cvt_pk_bf16_f32 v136, v20, v136
    v_cvt_pk_bf16_f32 v137, v21, v137
    v_accvgpr_write_b32 a72, v136
    v_accvgpr_write_b32 a73, v137
    v_lshlrev_b32 v22, 16, v138
    v_lshlrev_b32 v23, 16, v139
    v_and_b32 v138, s30, v138
    v_and_b32 v139, s30, v139
    v_pk_mul_f32 v[22:23], v[22:23], s[22:23]
    v_pk_mul_f32 v[138:139], v[138:139], s[22:23]
    v_cvt_pk_bf16_f32 v138, v22, v138
    v_cvt_pk_bf16_f32 v139, v23, v139
    v_accvgpr_write_b32 a74, v138
    v_accvgpr_write_b32 a75, v139
    s_waitcnt vmcnt(7)
    v_lshlrev_b32 v20, 16, v140
    s_add_u32 m0, s39, 97080
    s_nop 0
    buffer_load_dwordx4 v3, s[12:15], s25 offen offset:1024 nt lds
    v_lshlrev_b32 v21, 16, v141
    v_and_b32 v140, s30, v140
    v_and_b32 v141, s30, v141
    v_pk_mul_f32 v[20:21], v[20:21], s[22:23]
    v_pk_mul_f32 v[140:141], v[140:141], s[22:23]
    v_cvt_pk_bf16_f32 v140, v20, v140
    v_cvt_pk_bf16_f32 v141, v21, v141
    v_accvgpr_write_b32 a76, v140
    v_accvgpr_write_b32 a77, v141
    v_lshlrev_b32 v22, 16, v142
    v_lshlrev_b32 v23, 16, v143
    v_and_b32 v142, s30, v142
    v_and_b32 v143, s30, v143
    v_pk_mul_f32 v[22:23], v[22:23], s[22:23]
    v_pk_mul_f32 v[142:143], v[142:143], s[22:23]
    v_cvt_pk_bf16_f32 v142, v22, v142
    v_cvt_pk_bf16_f32 v143, v23, v143
    v_accvgpr_write_b32 a78, v142
    v_accvgpr_write_b32 a79, v143
    v_mfma_f32_16x16x32_bf16 v[20:23], a[212:215], a[64:67], 0
    v_exp_f32 v28, v28
    v_mfma_f32_16x16x32_bf16 v[20:23], a[216:219], a[68:71], v[20:23]
    ds_read_b128 a[104:107], v0 offset:9088
    v_add_f32 v6, v6, v27
    v_mfma_f32_16x16x32_bf16 v[20:23], a[220:223], a[72:75], v[20:23]
    v_exp_f32 v29, v29
    v_mfma_f32_16x16x32_bf16 v[20:23], a[224:227], a[76:79], v[20:23]
    v_cvt_pk_bf16_f32 v15, v26, v27
    v_add_f32 v7, v7, v28
    v_mfma_f32_16x16x32_bf16 v[24:27], a[232:235], a[64:67], 0
    v_exp_f32 v30, v30
    v_mfma_f32_16x16x32_bf16 v[24:27], a[236:239], a[68:71], v[24:27]
    v_add_f32 v7, v7, v29
    v_mfma_f32_16x16x32_bf16 v[24:27], a[240:243], a[72:75], v[24:27]
    v_exp_f32 v31, v31
    v_mfma_f32_16x16x32_bf16 v[24:27], a[244:247], a[76:79], v[24:27]
    v_add_f32 v7, v7, v30
    v_cvt_pk_bf16_f32 v16, v28, v29
    v_mfma_f32_16x16x32_bf16 a[128:131], a[108:111], v[12:15], a[128:131]
    v_exp_f32 v32, v32
    v_mfma_f32_16x16x32_bf16 a[132:135], a[112:115], v[12:15], a[132:135]
    v_add_f32 v7, v7, v31
    v_mfma_f32_16x16x32_bf16 a[136:139], a[116:119], v[12:15], a[136:139]
    v_exp_f32 v33, v33
    v_mfma_f32_16x16x32_bf16 a[140:143], a[120:123], v[12:15], a[140:143]
    v_add_f32 v7, v7, v32
    v_cvt_pk_bf16_f32 v17, v30, v31
    v_mfma_f32_16x16x32_bf16 a[144:147], a[124:127], v[12:15], a[144:147]
    v_exp_f32 v34, v34
    v_mfma_f32_16x16x32_bf16 a[148:151], a[192:195], v[12:15], a[148:151]
    v_add_f32 v7, v7, v33
    v_mfma_f32_16x16x32_bf16 a[152:155], a[228:231], v[12:15], a[152:155]
    v_exp_f32 v35, v35
    v_mfma_f32_16x16x32_bf16 a[156:159], a[200:203], v[12:15], a[156:159]
    v_add_f32 v7, v7, v34
    v_cvt_pk_bf16_f32 v18, v32, v33
    s_waitcnt vmcnt(7)
    v_lshlrev_b32 v28, 16, v160
    s_add_u32 s24, s43, 24576
    s_and_b32 s24, s24, 0x7fff
    buffer_load_dwordx4 v[192:195], v11, s[4:7], s24 offen offset:0 nt
    v_lshlrev_b32 v29, 16, v161
    v_and_b32 v160, s30, v160
    v_and_b32 v161, s30, v161
    v_pk_mul_f32 v[28:29], v[28:29], s[22:23]
    v_pk_mul_f32 v[160:161], v[160:161], s[22:23]
    v_cvt_pk_bf16_f32 v160, v28, v160
    v_cvt_pk_bf16_f32 v161, v29, v161
    v_accvgpr_write_b32 a80, v160
    v_accvgpr_write_b32 a81, v161
    v_lshlrev_b32 v30, 16, v162
    v_lshlrev_b32 v31, 16, v163
    v_and_b32 v162, s30, v162
    v_and_b32 v163, s30, v163
    v_pk_mul_f32 v[30:31], v[30:31], s[22:23]
    v_pk_mul_f32 v[162:163], v[162:163], s[22:23]
    v_cvt_pk_bf16_f32 v162, v30, v162
    v_cvt_pk_bf16_f32 v163, v31, v163
    v_accvgpr_write_b32 a82, v162
    v_accvgpr_write_b32 a83, v163
    s_waitcnt vmcnt(7)
    v_lshlrev_b32 v28, 16, v164
    buffer_load_dwordx4 v[196:199], v11, s[4:7], s24 offen offset:64 nt
    v_lshlrev_b32 v29, 16, v165
    v_and_b32 v164, s30, v164
    v_and_b32 v165, s30, v165
    v_pk_mul_f32 v[28:29], v[28:29], s[22:23]
    v_pk_mul_f32 v[164:165], v[164:165], s[22:23]
    v_cvt_pk_bf16_f32 v164, v28, v164
    v_cvt_pk_bf16_f32 v165, v29, v165
    v_accvgpr_write_b32 a84, v164
    v_accvgpr_write_b32 a85, v165
    v_lshlrev_b32 v30, 16, v166
    v_lshlrev_b32 v31, 16, v167
    v_and_b32 v166, s30, v166
    v_and_b32 v167, s30, v167
    v_pk_mul_f32 v[30:31], v[30:31], s[22:23]
    v_pk_mul_f32 v[166:167], v[166:167], s[22:23]
    v_cvt_pk_bf16_f32 v166, v30, v166
    v_cvt_pk_bf16_f32 v167, v31, v167
    v_accvgpr_write_b32 a86, v166
    v_accvgpr_write_b32 a87, v167
    s_waitcnt vmcnt(7)
    v_lshlrev_b32 v28, 16, v168
    buffer_load_dwordx4 v[200:203], v11, s[4:7], s24 offen offset:128 nt
    v_lshlrev_b32 v29, 16, v169
    v_and_b32 v168, s30, v168
    v_and_b32 v169, s30, v169
    v_pk_mul_f32 v[28:29], v[28:29], s[22:23]
    v_pk_mul_f32 v[168:169], v[168:169], s[22:23]
    v_cvt_pk_bf16_f32 v168, v28, v168
    v_cvt_pk_bf16_f32 v169, v29, v169
    v_accvgpr_write_b32 a88, v168
    v_accvgpr_write_b32 a89, v169
    v_lshlrev_b32 v30, 16, v170
    v_lshlrev_b32 v31, 16, v171
    v_and_b32 v170, s30, v170
    v_and_b32 v171, s30, v171
    v_pk_mul_f32 v[30:31], v[30:31], s[22:23]
    v_pk_mul_f32 v[170:171], v[170:171], s[22:23]
    v_cvt_pk_bf16_f32 v170, v30, v170
    v_cvt_pk_bf16_f32 v171, v31, v171
    v_accvgpr_write_b32 a90, v170
    v_accvgpr_write_b32 a91, v171
    s_waitcnt vmcnt(7)
    v_lshlrev_b32 v28, 16, v172
    buffer_load_dwordx4 v[204:207], v11, s[4:7], s24 offen offset:192 nt
    v_lshlrev_b32 v29, 16, v173
    v_and_b32 v172, s30, v172
    v_and_b32 v173, s30, v173
    v_pk_mul_f32 v[28:29], v[28:29], s[22:23]
    v_pk_mul_f32 v[172:173], v[172:173], s[22:23]
    v_cvt_pk_bf16_f32 v172, v28, v172
    v_cvt_pk_bf16_f32 v173, v29, v173
    v_accvgpr_write_b32 a92, v172
    v_accvgpr_write_b32 a93, v173
    v_lshlrev_b32 v30, 16, v174
    v_lshlrev_b32 v31, 16, v175
    v_and_b32 v174, s30, v174
    v_and_b32 v175, s30, v175
    v_pk_mul_f32 v[30:31], v[30:31], s[22:23]
    v_pk_mul_f32 v[174:175], v[174:175], s[22:23]
    v_cvt_pk_bf16_f32 v174, v30, v174
    v_cvt_pk_bf16_f32 v175, v31, v175
    v_accvgpr_write_b32 a94, v174
    v_accvgpr_write_b32 a95, v175
    v_mfma_f32_16x16x32_bf16 v[28:31], a[212:215], a[80:83], 0
    v_exp_f32 v20, v20
    v_mfma_f32_16x16x32_bf16 v[28:31], a[216:219], a[84:87], v[28:31]
    ds_read_b128 a[212:215], v0 offset:9152
    v_add_f32 v7, v7, v35
    v_mfma_f32_16x16x32_bf16 v[28:31], a[220:223], a[88:91], v[28:31]
    v_exp_f32 v21, v21
    v_mfma_f32_16x16x32_bf16 v[28:31], a[224:227], a[92:95], v[28:31]
    v_cvt_pk_bf16_f32 v19, v34, v35
    v_mov_b32 v8, v20
    v_mfma_f32_16x16x32_bf16 v[32:35], a[232:235], a[80:83], 0
    v_exp_f32 v22, v22
    v_mfma_f32_16x16x32_bf16 v[32:35], a[236:239], a[84:87], v[32:35]
    ds_read_b128 a[216:219], v0 offset:0
    v_add_f32 v8, v8, v21
    v_mfma_f32_16x16x32_bf16 v[32:35], a[240:243], a[88:91], v[32:35]
    v_exp_f32 v23, v23
    v_mfma_f32_16x16x32_bf16 v[32:35], a[244:247], a[92:95], v[32:35]
    v_add_f32 v8, v8, v22
    v_cvt_pk_bf16_f32 v12, v20, v21
    v_mfma_f32_16x16x32_bf16 a[160:163], a[108:111], v[16:19], a[160:163]
    v_exp_f32 v24, v24
    v_mfma_f32_16x16x32_bf16 a[164:167], a[112:115], v[16:19], a[164:167]
    ds_read_b128 a[220:223], v0 offset:64
    v_add_f32 v8, v8, v23
    v_mfma_f32_16x16x32_bf16 a[168:171], a[116:119], v[16:19], a[168:171]
    v_exp_f32 v25, v25
    v_mfma_f32_16x16x32_bf16 a[172:175], a[120:123], v[16:19], a[172:175]
    v_add_f32 v8, v8, v24
    v_cvt_pk_bf16_f32 v13, v22, v23
    v_mfma_f32_16x16x32_bf16 a[176:179], a[124:127], v[16:19], a[176:179]
    v_exp_f32 v26, v26
    v_mfma_f32_16x16x32_bf16 a[180:183], a[192:195], v[16:19], a[180:183]
    ds_read_b128 a[224:227], v0 offset:128
    v_add_f32 v8, v8, v25
    v_mfma_f32_16x16x32_bf16 a[184:187], a[228:231], v[16:19], a[184:187]
    v_exp_f32 v27, v27
    v_mfma_f32_16x16x32_bf16 a[188:191], a[200:203], v[16:19], a[188:191]
    s_waitcnt lgkmcnt(2)
    v_add_f32 v8, v8, v26
    v_cvt_pk_bf16_f32 v14, v24, v25
    v_mfma_f32_16x16x32_bf16 v[20:23], a[204:207], a[64:67], 0
    v_exp_f32 v28, v28
    v_mfma_f32_16x16x32_bf16 v[20:23], a[208:211], a[68:71], v[20:23]
    ds_read_b128 a[232:235], v0 offset:192
    v_add_f32 v8, v8, v27
    v_mfma_f32_16x16x32_bf16 v[20:23], a[248:251], a[72:75], v[20:23]
    s_add_u32 s24, s43, 28672
    s_and_b32 s24, s24, 0x7fff
    v_exp_f32 v29, v29
    v_mfma_f32_16x16x32_bf16 v[20:23], a[252:255], a[76:79], v[20:23]
    buffer_load_dwordx4 v[224:227], v11, s[4:7], s24 offen offset:0 nt
    v_cvt_pk_bf16_f32 v15, v26, v27
    v_mov_b32 v9, v28
    v_mfma_f32_16x16x32_bf16 v[24:27], a[100:103], a[64:67], 0
    v_exp_f32 v30, v30
    v_mfma_f32_16x16x32_bf16 v[24:27], a[196:199], a[68:71], v[24:27]
    ds_read_b128 a[236:239], v0 offset:512
    v_add_f32 v9, v9, v29
    v_mfma_f32_16x16x32_bf16 v[24:27], a[104:107], a[72:75], v[24:27]
    v_exp_f32 v31, v31
    v_mfma_f32_16x16x32_bf16 v[24:27], a[212:215], a[76:79], v[24:27]
    v_add_f32 v9, v9, v30
    v_cvt_pk_bf16_f32 v16, v28, v29
    v_mfma_f32_16x16x32_bf16 v[128:131], a[108:111], v[12:15], 0
    v_exp_f32 v32, v32
    v_mfma_f32_16x16x32_bf16 v[132:135], a[112:115], v[12:15], 0
    ds_read_b128 a[240:243], v0 offset:576
    v_add_f32 v9, v9, v31
    v_mfma_f32_16x16x32_bf16 v[136:139], a[116:119], v[12:15], 0
    v_exp_f32 v33, v33
    v_mfma_f32_16x16x32_bf16 v[140:143], a[120:123], v[12:15], 0
    v_add_f32 v9, v9, v32
    v_cvt_pk_bf16_f32 v17, v30, v31
    v_mfma_f32_16x16x32_bf16 v[144:147], a[124:127], v[12:15], 0
    v_exp_f32 v34, v34
    v_mfma_f32_16x16x32_bf16 v[148:151], a[192:195], v[12:15], 0
    ds_read_b128 a[244:247], v0 offset:640
    v_add_f32 v9, v9, v33
    v_mfma_f32_16x16x32_bf16 v[152:155], a[228:231], v[12:15], 0
    v_exp_f32 v35, v35
    v_mfma_f32_16x16x32_bf16 v[156:159], a[200:203], v[12:15], 0
    v_add_f32 v9, v9, v34
    v_cvt_pk_bf16_f32 v18, v32, v33
    v_mfma_f32_16x16x32_bf16 v[28:31], a[204:207], a[80:83], 0
    v_exp_f32 v20, v20
    v_mfma_f32_16x16x32_bf16 v[28:31], a[208:211], a[84:87], v[28:31]
    ds_read_b128 a[204:207], v0 offset:704
    v_add_f32 v9, v9, v35
    v_mfma_f32_16x16x32_bf16 v[28:31], a[248:251], a[88:91], v[28:31]
    v_exp_f32 v21, v21
    v_mfma_f32_16x16x32_bf16 v[28:31], a[252:255], a[92:95], v[28:31]
    v_cvt_pk_bf16_f32 v19, v34, v35
    v_add_f32 v8, v8, v20
    v_mfma_f32_16x16x32_bf16 v[32:35], a[100:103], a[80:83], 0
    v_exp_f32 v22, v22
    v_mfma_f32_16x16x32_bf16 v[32:35], a[196:199], a[84:87], v[32:35]
    ds_read_b64_tr_b16 a[208:209], v1 offset:8720
    v_add_f32 v8, v8, v21
    v_mfma_f32_16x16x32_bf16 v[32:35], a[104:107], a[88:91], v[32:35]
    buffer_load_dwordx4 v[228:231], v11, s[4:7], s24 offen offset:64 nt
    v_exp_f32 v23, v23
    v_mfma_f32_16x16x32_bf16 v[32:35], a[212:215], a[92:95], v[32:35]
    v_add_f32 v8, v8, v22
    v_cvt_pk_bf16_f32 v12, v20, v21
    v_mfma_f32_16x16x32_bf16 v[160:163], a[108:111], v[16:19], 0
    v_exp_f32 v24, v24
    v_mfma_f32_16x16x32_bf16 v[164:167], a[112:115], v[16:19], 0
    ds_read_b64_tr_b16 a[210:211], v1 offset:9232
    v_add_f32 v8, v8, v23
    v_mfma_f32_16x16x32_bf16 v[168:171], a[116:119], v[16:19], 0
    v_exp_f32 v25, v25
    v_mfma_f32_16x16x32_bf16 v[172:175], a[120:123], v[16:19], 0
    v_add_f32 v8, v8, v24
    v_cvt_pk_bf16_f32 v13, v22, v23
    v_mfma_f32_16x16x32_bf16 v[176:179], a[124:127], v[16:19], 0
    v_exp_f32 v26, v26
    v_mfma_f32_16x16x32_bf16 v[180:183], a[192:195], v[16:19], 0
    ds_read_b64_tr_b16 a[248:249], v1 offset:8728
    ds_read_b64_tr_b16 a[250:251], v1 offset:9240
    v_add_f32 v8, v8, v25
    v_mfma_f32_16x16x32_bf16 v[184:187], a[228:231], v[16:19], 0
    v_exp_f32 v27, v27
    v_mfma_f32_16x16x32_bf16 v[188:191], a[200:203], v[16:19], 0
    ds_read_b64_tr_b16 a[252:253], v1 offset:8784
    ds_read_b64_tr_b16 a[254:255], v1 offset:9296
    v_add_f32 v8, v8, v26
    v_cvt_pk_bf16_f32 v14, v24, v25
    v_mfma_f32_16x16x32_bf16 v[20:23], a[216:219], a[64:67], 0
    s_waitcnt lgkmcnt(5)
    v_exp_f32 v28, v28
    v_mfma_f32_16x16x32_bf16 v[20:23], a[220:223], a[68:71], v[20:23]
    ds_read_b64_tr_b16 a[100:101], v1 offset:8792
    ds_read_b64_tr_b16 a[102:103], v1 offset:9304
    ds_read_b64_tr_b16 a[196:197], v1 offset:8848
    v_add_f32 v8, v8, v27
    v_mfma_f32_16x16x32_bf16 v[20:23], a[224:227], a[72:75], v[20:23]
    v_exp_f32 v29, v29
    v_mfma_f32_16x16x32_bf16 v[20:23], a[232:235], a[76:79], v[20:23]
    ds_read_b64_tr_b16 a[198:199], v1 offset:9360
    ds_read_b64_tr_b16 a[104:105], v1 offset:8856
    v_cvt_pk_bf16_f32 v15, v26, v27
    v_add_f32 v9, v9, v28
    v_mfma_f32_16x16x32_bf16 v[24:27], a[236:239], a[64:67], 0
    v_exp_f32 v30, v30
    v_mfma_f32_16x16x32_bf16 v[24:27], a[240:243], a[68:71], v[24:27]
    ds_read_b64_tr_b16 a[106:107], v1 offset:9368
    ds_read_b64_tr_b16 a[212:213], v1 offset:8912
    ds_read_b64_tr_b16 a[214:215], v1 offset:9424
    v_add_f32 v9, v9, v29
    v_mfma_f32_16x16x32_bf16 v[24:27], a[244:247], a[72:75], v[24:27]
    s_waitcnt lgkmcnt(10)
    v_exp_f32 v31, v31
    v_mfma_f32_16x16x32_bf16 v[24:27], a[204:207], a[76:79], v[24:27]
    ds_read_b64_tr_b16 a[108:109], v1 offset:8920
    ds_read_b64_tr_b16 a[110:111], v1 offset:9432
    v_add_f32 v9, v9, v30
    v_cvt_pk_bf16_f32 v16, v28, v29
    v_mfma_f32_16x16x32_bf16 v[128:131], a[208:211], v[12:15], v[128:131]
    s_waitcnt lgkmcnt(10)
    v_exp_f32 v32, v32
    v_mfma_f32_16x16x32_bf16 v[132:135], a[248:251], v[12:15], v[132:135]
    ds_read_b64_tr_b16 a[112:113], v1 offset:0
    buffer_load_dwordx4 v[232:235], v11, s[4:7], s24 offen offset:128 nt
    v_add_f32 v9, v9, v31
    v_mfma_f32_16x16x32_bf16 v[136:139], a[252:255], v[12:15], v[136:139]
    s_waitcnt lgkmcnt(8)
    v_exp_f32 v33, v33
    v_mfma_f32_16x16x32_bf16 v[140:143], a[100:103], v[12:15], v[140:143]
    s_waitcnt lgkmcnt(6)
    v_add_f32 v9, v9, v32
    v_cvt_pk_bf16_f32 v17, v30, v31
    v_mfma_f32_16x16x32_bf16 v[144:147], a[196:199], v[12:15], v[144:147]
    s_waitcnt lgkmcnt(3)
    v_exp_f32 v34, v34
    v_mfma_f32_16x16x32_bf16 v[148:151], a[104:107], v[12:15], v[148:151]
    ds_read_b64_tr_b16 a[114:115], v1 offset:512
    v_add_f32 v9, v9, v33
    v_mfma_f32_16x16x32_bf16 v[152:155], a[212:215], v[12:15], v[152:155]
    s_waitcnt lgkmcnt(2)
    v_exp_f32 v35, v35
    v_mfma_f32_16x16x32_bf16 v[156:159], a[108:111], v[12:15], v[156:159]
    v_add_f32 v9, v9, v34
    v_cvt_pk_bf16_f32 v18, v32, v33
    v_mfma_f32_16x16x32_bf16 v[28:31], a[216:219], a[80:83], 0
    v_exp_f32 v20, v20
    v_mfma_f32_16x16x32_bf16 v[28:31], a[220:223], a[84:87], v[28:31]
    ds_read_b64_tr_b16 a[116:117], v1 offset:8
    v_add_f32 v9, v9, v35
    v_mfma_f32_16x16x32_bf16 v[28:31], a[224:227], a[88:91], v[28:31]
    v_exp_f32 v21, v21
    v_mfma_f32_16x16x32_bf16 v[28:31], a[232:235], a[92:95], v[28:31]
    v_cvt_pk_bf16_f32 v19, v34, v35
    v_add_f32 v8, v8, v20
    v_mfma_f32_16x16x32_bf16 v[32:35], a[236:239], a[80:83], 0
    s_waitcnt vmcnt(7)
    s_barrier
    buffer_load_dwordx4 v[236:239], v11, s[4:7], s24 offen offset:192 nt
    v_exp_f32 v22, v22
    v_mfma_f32_16x16x32_bf16 v[32:35], a[240:243], a[84:87], v[32:35]
    ds_read_b128 a[120:123], v0 offset:25344
    v_add_f32 v8, v8, v21
    v_mfma_f32_16x16x32_bf16 v[32:35], a[244:247], a[88:91], v[32:35]
    v_exp_f32 v23, v23
    v_mfma_f32_16x16x32_bf16 v[32:35], a[204:207], a[92:95], v[32:35]
    v_add_f32 v8, v8, v22
    v_cvt_pk_bf16_f32 v12, v20, v21
    v_mfma_f32_16x16x32_bf16 v[160:163], a[208:211], v[16:19], v[160:163]
    v_exp_f32 v24, v24
    v_mfma_f32_16x16x32_bf16 v[164:167], a[248:251], v[16:19], v[164:167]
    ds_read_b128 a[124:127], v0 offset:25408
    ds_read_b128 a[192:195], v0 offset:25472
    ds_read_b128 a[228:231], v0 offset:25536
    v_add_f32 v8, v8, v23
    v_mfma_f32_16x16x32_bf16 v[168:171], a[252:255], v[16:19], v[168:171]
    v_exp_f32 v25, v25
    v_mfma_f32_16x16x32_bf16 v[172:175], a[100:103], v[16:19], v[172:175]
    ds_read_b128 a[200:203], v0 offset:25856
    ds_read_b128 a[216:219], v0 offset:25920
    v_add_f32 v8, v8, v24
    v_cvt_pk_bf16_f32 v13, v22, v23
    v_mfma_f32_16x16x32_bf16 v[176:179], a[196:199], v[16:19], v[176:179]
    v_exp_f32 v26, v26
    v_mfma_f32_16x16x32_bf16 v[180:183], a[104:107], v[16:19], v[180:183]
    ds_read_b128 a[220:223], v0 offset:25984
    ds_read_b128 a[224:227], v0 offset:26048
    ds_read_b64_tr_b16 a[118:119], v1 offset:520
    v_add_f32 v8, v8, v25
    v_mfma_f32_16x16x32_bf16 v[184:187], a[212:215], v[16:19], v[184:187]
    s_waitcnt lgkmcnt(8)
    v_exp_f32 v27, v27
    v_mfma_f32_16x16x32_bf16 v[188:191], a[108:111], v[16:19], v[188:191]
    ds_read_b64_tr_b16 a[232:233], v1 offset:64
    ds_read_b64_tr_b16 a[234:235], v1 offset:576
    v_add_f32 v8, v8, v26
    v_cvt_pk_bf16_f32 v14, v24, v25
    v_mfma_f32_16x16x32_bf16 v[20:23], a[120:123], a[0:3], 0
    s_waitcnt lgkmcnt(8)
    v_exp_f32 v28, v28
    v_mfma_f32_16x16x32_bf16 v[20:23], a[124:127], a[4:7], v[20:23]
    ds_read_b64_tr_b16 a[240:241], v1 offset:72
    ds_read_b64_tr_b16 a[242:243], v1 offset:584
    ds_read_b64_tr_b16 a[244:245], v1 offset:128
    v_add_f32 v8, v8, v27
    v_mfma_f32_16x16x32_bf16 v[20:23], a[192:195], a[8:11], v[20:23]
    s_waitcnt lgkmcnt(9)
    v_exp_f32 v29, v29
    v_mfma_f32_16x16x32_bf16 v[20:23], a[228:231], a[12:15], v[20:23]
    ds_read_b64_tr_b16 a[246:247], v1 offset:640
    ds_read_b64_tr_b16 a[204:205], v1 offset:136
    v_cvt_pk_bf16_f32 v15, v26, v27
    v_add_f32 v9, v9, v28
    v_mfma_f32_16x16x32_bf16 v[24:27], a[200:203], a[0:3], 0
    s_waitcnt lgkmcnt(9)
    v_exp_f32 v30, v30
    v_mfma_f32_16x16x32_bf16 v[24:27], a[216:219], a[4:7], v[24:27]
    ds_read_b64_tr_b16 a[206:207], v1 offset:648
    ds_read_b64_tr_b16 a[208:209], v1 offset:192
    ds_read_b64_tr_b16 a[210:211], v1 offset:704
    v_add_f32 v9, v9, v29
    v_mfma_f32_16x16x32_bf16 v[24:27], a[220:223], a[8:11], v[24:27]
    s_waitcnt lgkmcnt(10)
    s_add_u32 m0, s21, 33792
    s_mov_b32 s20, 32768
    v_exp_f32 v31, v31
    v_mfma_f32_16x16x32_bf16 v[24:27], a[224:227], a[12:15], v[24:27]
    ds_read_b64_tr_b16 a[248:249], v1 offset:200
    ds_read_b64_tr_b16 a[250:251], v1 offset:712
    buffer_load_dwordx4 v2, s[8:11], s20 offen nt lds
    v_add_f32 v9, v9, v30
    v_cvt_pk_bf16_f32 v16, v28, v29
    v_mfma_f32_16x16x32_bf16 v[128:131], a[112:115], v[12:15], v[128:131]
    s_waitcnt lgkmcnt(10)
    v_exp_f32 v32, v32
    v_mfma_f32_16x16x32_bf16 v[132:135], a[116:119], v[12:15], v[132:135]
    ds_read_b64_tr_b16 a[252:253], v1 offset:26160
    v_add_f32 v9, v9, v31
    v_mfma_f32_16x16x32_bf16 v[136:139], a[232:235], v[12:15], v[136:139]
    s_waitcnt lgkmcnt(8)
    v_exp_f32 v33, v33
    v_mfma_f32_16x16x32_bf16 v[140:143], a[240:243], v[12:15], v[140:143]
    s_waitcnt lgkmcnt(6)
    v_add_f32 v9, v9, v32
    v_cvt_pk_bf16_f32 v17, v30, v31
    v_mfma_f32_16x16x32_bf16 v[144:147], a[244:247], v[12:15], v[144:147]
    s_waitcnt lgkmcnt(3)
    v_exp_f32 v34, v34
    v_mfma_f32_16x16x32_bf16 v[148:151], a[204:207], v[12:15], v[148:151]
    ds_read_b64_tr_b16 a[254:255], v1 offset:26672
    v_add_f32 v9, v9, v33
    v_mfma_f32_16x16x32_bf16 v[152:155], a[208:211], v[12:15], v[152:155]
    s_waitcnt lgkmcnt(2)
    v_exp_f32 v35, v35
    v_mfma_f32_16x16x32_bf16 v[156:159], a[248:251], v[12:15], v[156:159]
    v_add_f32 v9, v9, v34
    v_cvt_pk_bf16_f32 v18, v32, v33
    v_mfma_f32_16x16x32_bf16 v[28:31], a[120:123], a[16:19], 0
    v_exp_f32 v20, v20
    v_mfma_f32_16x16x32_bf16 v[28:31], a[124:127], a[20:23], v[28:31]
    ds_read_b64_tr_b16 a[100:101], v1 offset:26168
    v_add_f32 v9, v9, v35
    v_mfma_f32_16x16x32_bf16 v[28:31], a[192:195], a[24:27], v[28:31]
    v_exp_f32 v21, v21
    v_mfma_f32_16x16x32_bf16 v[28:31], a[228:231], a[28:31], v[28:31]
    v_cvt_pk_bf16_f32 v19, v34, v35
    v_add_f32 v4, v4, v20
    v_mfma_f32_16x16x32_bf16 v[32:35], a[200:203], a[16:19], 0
    v_exp_f32 v22, v22
    v_mfma_f32_16x16x32_bf16 v[32:35], a[216:219], a[20:23], v[32:35]
    ds_read_b64_tr_b16 a[102:103], v1 offset:26680
    v_add_f32 v4, v4, v21
    v_mfma_f32_16x16x32_bf16 v[32:35], a[220:223], a[24:27], v[32:35]
    v_exp_f32 v23, v23
    v_mfma_f32_16x16x32_bf16 v[32:35], a[224:227], a[28:31], v[32:35]
    v_add_f32 v4, v4, v22
    v_cvt_pk_bf16_f32 v12, v20, v21
    v_mfma_f32_16x16x32_bf16 v[160:163], a[112:115], v[16:19], v[160:163]
    v_exp_f32 v24, v24
    v_mfma_f32_16x16x32_bf16 v[164:167], a[116:119], v[16:19], v[164:167]
    s_add_u32 m0, s21, 35968
    ds_read_b64_tr_b16 a[196:197], v1 offset:26224
    v_add_f32 v4, v4, v23
    v_mfma_f32_16x16x32_bf16 v[168:171], a[232:235], v[16:19], v[168:171]
    buffer_load_dwordx4 v2, s[8:11], s20 offen offset:2048 nt lds
    v_exp_f32 v25, v25
    v_mfma_f32_16x16x32_bf16 v[172:175], a[240:243], v[16:19], v[172:175]
    v_add_f32 v4, v4, v24
    v_cvt_pk_bf16_f32 v13, v22, v23
    v_mfma_f32_16x16x32_bf16 v[176:179], a[244:247], v[16:19], v[176:179]
    v_exp_f32 v26, v26
    v_mfma_f32_16x16x32_bf16 v[180:183], a[204:207], v[16:19], v[180:183]
    ds_read_b64_tr_b16 a[198:199], v1 offset:26736
    v_add_f32 v4, v4, v25
    v_mfma_f32_16x16x32_bf16 v[184:187], a[208:211], v[16:19], v[184:187]
    v_exp_f32 v27, v27
    v_mfma_f32_16x16x32_bf16 v[188:191], a[248:251], v[16:19], v[188:191]
    v_add_f32 v4, v4, v26
    v_cvt_pk_bf16_f32 v14, v24, v25
    v_mfma_f32_16x16x32_bf16 v[20:23], a[120:123], a[32:35], 0
    v_exp_f32 v28, v28
    v_mfma_f32_16x16x32_bf16 v[20:23], a[124:127], a[36:39], v[20:23]
    ds_read_b64_tr_b16 a[104:105], v1 offset:26232
    ds_read_b64_tr_b16 a[106:107], v1 offset:26744
    ds_read_b64_tr_b16 a[212:213], v1 offset:26288
    v_add_f32 v4, v4, v27
    v_mfma_f32_16x16x32_bf16 v[20:23], a[192:195], a[40:43], v[20:23]
    v_exp_f32 v29, v29
    v_mfma_f32_16x16x32_bf16 v[20:23], a[228:231], a[44:47], v[20:23]
    ds_read_b64_tr_b16 a[214:215], v1 offset:26800
    ds_read_b64_tr_b16 a[108:109], v1 offset:26296
    v_cvt_pk_bf16_f32 v15, v26, v27
    v_add_f32 v5, v5, v28
    v_mfma_f32_16x16x32_bf16 v[24:27], a[200:203], a[32:35], 0
    v_exp_f32 v30, v30
    v_mfma_f32_16x16x32_bf16 v[24:27], a[216:219], a[36:39], v[24:27]
    ds_read_b64_tr_b16 a[110:111], v1 offset:26808
    ds_read_b64_tr_b16 a[116:117], v1 offset:26352
    ds_read_b64_tr_b16 a[118:119], v1 offset:26864
    v_add_f32 v5, v5, v29
    v_mfma_f32_16x16x32_bf16 v[24:27], a[220:223], a[40:43], v[24:27]
    s_waitcnt lgkmcnt(8)
    v_exp_f32 v31, v31
    v_mfma_f32_16x16x32_bf16 v[24:27], a[224:227], a[44:47], v[24:27]
    ds_read_b64_tr_b16 a[244:245], v1 offset:26360
    ds_read_b64_tr_b16 a[246:247], v1 offset:26872
    v_add_f32 v5, v5, v30
    v_cvt_pk_bf16_f32 v16, v28, v29
    v_mfma_f32_16x16x32_bf16 v[64:67], a[252:255], v[12:15], v[64:67]
    v_exp_f32 v32, v32
    v_mfma_f32_16x16x32_bf16 v[68:71], a[100:103], v[12:15], v[68:71]
    v_add_f32 v5, v5, v31
    v_mfma_f32_16x16x32_bf16 v[72:75], a[196:199], v[12:15], v[72:75]
    s_waitcnt lgkmcnt(7)
    v_exp_f32 v33, v33
    v_mfma_f32_16x16x32_bf16 v[76:79], a[104:107], v[12:15], v[76:79]
    s_waitcnt lgkmcnt(5)
    v_add_f32 v5, v5, v32
    v_cvt_pk_bf16_f32 v17, v30, v31
    v_mfma_f32_16x16x32_bf16 v[80:83], a[212:215], v[12:15], v[80:83]
    s_waitcnt lgkmcnt(2)
    s_add_u32 m0, s39, 102464
    s_mov_b32 s25, 32768
    v_exp_f32 v34, v34
    v_mfma_f32_16x16x32_bf16 v[84:87], a[108:111], v[12:15], v[84:87]
    buffer_load_dwordx4 v3, s[12:15], s25 offen nt lds
    v_add_f32 v5, v5, v33
    v_mfma_f32_16x16x32_bf16 v[88:91], a[116:119], v[12:15], v[88:91]
    s_waitcnt lgkmcnt(0)
    v_exp_f32 v35, v35
    v_mfma_f32_16x16x32_bf16 v[92:95], a[244:247], v[12:15], v[92:95]
    v_add_f32 v5, v5, v34
    v_cvt_pk_bf16_f32 v18, v32, v33
    v_mfma_f32_16x16x32_bf16 v[28:31], a[120:123], a[48:51], 0
    v_exp_f32 v20, v20
    v_mfma_f32_16x16x32_bf16 v[28:31], a[124:127], a[52:55], v[28:31]
    ds_read_b128 a[248:251], v0 offset:16896
    v_add_f32 v5, v5, v35
    v_mfma_f32_16x16x32_bf16 v[28:31], a[192:195], a[56:59], v[28:31]
    v_exp_f32 v21, v21
    v_mfma_f32_16x16x32_bf16 v[28:31], a[228:231], a[60:63], v[28:31]
    v_cvt_pk_bf16_f32 v19, v34, v35
    v_add_f32 v6, v6, v20
    v_mfma_f32_16x16x32_bf16 v[32:35], a[200:203], a[48:51], 0
    v_exp_f32 v22, v22
    v_mfma_f32_16x16x32_bf16 v[32:35], a[216:219], a[52:55], v[32:35]
    v_add_f32 v6, v6, v21
    v_mfma_f32_16x16x32_bf16 v[32:35], a[220:223], a[56:59], v[32:35]
    v_exp_f32 v23, v23
    v_mfma_f32_16x16x32_bf16 v[32:35], a[224:227], a[60:63], v[32:35]
    v_add_f32 v6, v6, v22
    v_cvt_pk_bf16_f32 v12, v20, v21
    v_mfma_f32_16x16x32_bf16 v[96:99], a[252:255], v[16:19], v[96:99]
    v_exp_f32 v24, v24
    v_mfma_f32_16x16x32_bf16 v[100:103], a[100:103], v[16:19], v[100:103]
    ds_read_b128 a[204:207], v0 offset:17024
    v_add_f32 v6, v6, v23
    v_mfma_f32_16x16x32_bf16 v[104:107], a[196:199], v[16:19], v[104:107]
    v_exp_f32 v25, v25
    v_mfma_f32_16x16x32_bf16 v[108:111], a[104:107], v[16:19], v[108:111]
    v_add_f32 v6, v6, v24
    v_cvt_pk_bf16_f32 v13, v22, v23
    v_mfma_f32_16x16x32_bf16 v[112:115], a[212:215], v[16:19], v[112:115]
    v_exp_f32 v26, v26
    v_mfma_f32_16x16x32_bf16 v[116:119], a[108:111], v[16:19], v[116:119]
    ds_read_b64_tr_b16 a[112:113], v1 offset:17440
    v_add_f32 v6, v6, v25
    v_mfma_f32_16x16x32_bf16 v[120:123], a[116:119], v[16:19], v[120:123]
    v_exp_f32 v27, v27
    v_mfma_f32_16x16x32_bf16 v[124:127], a[244:247], v[16:19], v[124:127]
    s_add_u32 m0, s39, 105800
    v_add_f32 v6, v6, v26
    v_cvt_pk_bf16_f32 v14, v24, v25
    v_mfma_f32_16x16x32_bf16 v[20:23], a[120:123], a[64:67], 0
    buffer_load_dwordx4 v3, s[12:15], s25 offen offset:1024 nt lds
    v_exp_f32 v28, v28
    v_mfma_f32_16x16x32_bf16 v[20:23], a[124:127], a[68:71], v[20:23]
    ds_read_b64_tr_b16 a[114:115], v1 offset:17952
    v_add_f32 v6, v6, v27
    v_mfma_f32_16x16x32_bf16 v[20:23], a[192:195], a[72:75], v[20:23]
    v_exp_f32 v29, v29
    v_mfma_f32_16x16x32_bf16 v[20:23], a[228:231], a[76:79], v[20:23]
    v_cvt_pk_bf16_f32 v15, v26, v27
    v_add_f32 v7, v7, v28
    v_mfma_f32_16x16x32_bf16 v[24:27], a[200:203], a[64:67], 0
    v_exp_f32 v30, v30
    v_mfma_f32_16x16x32_bf16 v[24:27], a[216:219], a[68:71], v[24:27]
    v_add_f32 v7, v7, v29
    v_mfma_f32_16x16x32_bf16 v[24:27], a[220:223], a[72:75], v[24:27]
    v_exp_f32 v31, v31
    v_mfma_f32_16x16x32_bf16 v[24:27], a[224:227], a[76:79], v[24:27]
    v_add_f32 v7, v7, v30
    v_cvt_pk_bf16_f32 v16, v28, v29
    v_mfma_f32_16x16x32_bf16 a[128:131], a[252:255], v[12:15], a[128:131]
    v_exp_f32 v32, v32
    v_mfma_f32_16x16x32_bf16 a[132:135], a[100:103], v[12:15], a[132:135]
    ds_read_b128 a[208:211], v0 offset:17088
    v_add_f32 v7, v7, v31
    v_mfma_f32_16x16x32_bf16 a[136:139], a[196:199], v[12:15], a[136:139]
    v_exp_f32 v33, v33
    v_mfma_f32_16x16x32_bf16 a[140:143], a[104:107], v[12:15], a[140:143]
    v_add_f32 v7, v7, v32
    v_cvt_pk_bf16_f32 v17, v30, v31
    v_mfma_f32_16x16x32_bf16 a[144:147], a[212:215], v[12:15], a[144:147]
    v_exp_f32 v34, v34
    v_mfma_f32_16x16x32_bf16 a[148:151], a[108:111], v[12:15], a[148:151]
    ds_read_b64_tr_b16 a[232:233], v1 offset:17504
    v_add_f32 v7, v7, v33
    v_mfma_f32_16x16x32_bf16 a[152:155], a[116:119], v[12:15], a[152:155]
    v_exp_f32 v35, v35
    v_mfma_f32_16x16x32_bf16 a[156:159], a[244:247], v[12:15], a[156:159]
    v_add_f32 v7, v7, v34
    v_cvt_pk_bf16_f32 v18, v32, v33
    v_mfma_f32_16x16x32_bf16 v[28:31], a[120:123], a[80:83], 0
    v_exp_f32 v20, v20
    v_mfma_f32_16x16x32_bf16 v[28:31], a[124:127], a[84:87], v[28:31]
    ds_read_b64_tr_b16 a[234:235], v1 offset:18016
    v_add_f32 v7, v7, v35
    v_mfma_f32_16x16x32_bf16 v[28:31], a[192:195], a[88:91], v[28:31]
    s_add_u32 m0, s21, 42240
    s_mov_b32 s20, 40960
    v_exp_f32 v21, v21
    v_mfma_f32_16x16x32_bf16 v[28:31], a[228:231], a[92:95], v[28:31]
    buffer_load_dwordx4 v2, s[8:11], s20 offen nt lds
    v_cvt_pk_bf16_f32 v19, v34, v35
    v_add_f32 v8, v8, v20
    v_mfma_f32_16x16x32_bf16 v[32:35], a[200:203], a[80:83], 0
    v_exp_f32 v22, v22
    v_mfma_f32_16x16x32_bf16 v[32:35], a[216:219], a[84:87], v[32:35]
    v_add_f32 v8, v8, v21
    v_mfma_f32_16x16x32_bf16 v[32:35], a[220:223], a[88:91], v[32:35]
    v_exp_f32 v23, v23
    v_mfma_f32_16x16x32_bf16 v[32:35], a[224:227], a[92:95], v[32:35]
    v_add_f32 v8, v8, v22
    v_cvt_pk_bf16_f32 v12, v20, v21
    v_mfma_f32_16x16x32_bf16 a[160:163], a[252:255], v[16:19], a[160:163]
    v_exp_f32 v24, v24
    v_mfma_f32_16x16x32_bf16 a[164:167], a[100:103], v[16:19], a[164:167]
    ds_read_b128 a[236:239], v0 offset:17408
    v_add_f32 v8, v8, v23
    v_mfma_f32_16x16x32_bf16 a[168:171], a[196:199], v[16:19], a[168:171]
    v_exp_f32 v25, v25
    v_mfma_f32_16x16x32_bf16 a[172:175], a[104:107], v[16:19], a[172:175]
    v_add_f32 v8, v8, v24
    v_cvt_pk_bf16_f32 v13, v22, v23
    v_mfma_f32_16x16x32_bf16 a[176:179], a[212:215], v[16:19], a[176:179]
    v_exp_f32 v26, v26
    v_mfma_f32_16x16x32_bf16 a[180:183], a[108:111], v[16:19], a[180:183]
    ds_read_b64_tr_b16 a[240:241], v1 offset:17512
    v_add_f32 v8, v8, v25
    v_mfma_f32_16x16x32_bf16 a[184:187], a[116:119], v[16:19], a[184:187]
    v_exp_f32 v27, v27
    v_mfma_f32_16x16x32_bf16 a[188:191], a[244:247], v[16:19], a[188:191]
    v_add_f32 v8, v8, v26
    v_cvt_pk_bf16_f32 v14, v24, v25
    s_waitcnt vmcnt(12)
    v_lshlrev_b32 v20, 16, v192
    v_lshlrev_b32 v21, 16, v193
    v_and_b32 v192, s30, v192
    v_and_b32 v193, s30, v193
    v_pk_mul_f32 v[20:21], v[20:21], s[22:23]
    v_pk_mul_f32 v[192:193], v[192:193], s[22:23]
    v_cvt_pk_bf16_f32 v192, v20, v192
    v_cvt_pk_bf16_f32 v193, v21, v193
    v_accvgpr_write_b32 a96, v192
    v_accvgpr_write_b32 a97, v193
    v_lshlrev_b32 v22, 16, v194
    v_lshlrev_b32 v23, 16, v195
    v_and_b32 v194, s30, v194
    v_and_b32 v195, s30, v195
    v_pk_mul_f32 v[22:23], v[22:23], s[22:23]
    v_pk_mul_f32 v[194:195], v[194:195], s[22:23]
    v_cvt_pk_bf16_f32 v194, v22, v194
    v_cvt_pk_bf16_f32 v195, v23, v195
    v_accvgpr_write_b32 a98, v194
    v_accvgpr_write_b32 a99, v195
    s_waitcnt vmcnt(11)
    v_lshlrev_b32 v20, 16, v196
    v_lshlrev_b32 v21, 16, v197
    v_and_b32 v196, s30, v196
    v_and_b32 v197, s30, v197
    v_pk_mul_f32 v[20:21], v[20:21], s[22:23]
    v_pk_mul_f32 v[196:197], v[196:197], s[22:23]
    v_cvt_pk_bf16_f32 v36, v20, v196
    v_cvt_pk_bf16_f32 v37, v21, v197
    v_lshlrev_b32 v22, 16, v198
    v_lshlrev_b32 v23, 16, v199
    v_and_b32 v198, s30, v198
    v_and_b32 v199, s30, v199
    v_pk_mul_f32 v[22:23], v[22:23], s[22:23]
    v_pk_mul_f32 v[198:199], v[198:199], s[22:23]
    v_cvt_pk_bf16_f32 v38, v22, v198
    v_cvt_pk_bf16_f32 v39, v23, v199
    s_waitcnt vmcnt(10)
    v_lshlrev_b32 v20, 16, v200
    v_lshlrev_b32 v21, 16, v201
    v_and_b32 v200, s30, v200
    v_and_b32 v201, s30, v201
    v_pk_mul_f32 v[20:21], v[20:21], s[22:23]
    v_pk_mul_f32 v[200:201], v[200:201], s[22:23]
    v_cvt_pk_bf16_f32 v40, v20, v200
    v_cvt_pk_bf16_f32 v41, v21, v201
    v_lshlrev_b32 v22, 16, v202
    v_lshlrev_b32 v23, 16, v203
    v_and_b32 v202, s30, v202
    v_and_b32 v203, s30, v203
    v_pk_mul_f32 v[22:23], v[22:23], s[22:23]
    v_pk_mul_f32 v[202:203], v[202:203], s[22:23]
    v_cvt_pk_bf16_f32 v42, v22, v202
    v_cvt_pk_bf16_f32 v43, v23, v203
    s_waitcnt vmcnt(9)
    v_lshlrev_b32 v20, 16, v204
    v_lshlrev_b32 v21, 16, v205
    v_and_b32 v204, s30, v204
    v_and_b32 v205, s30, v205
    v_pk_mul_f32 v[20:21], v[20:21], s[22:23]
    v_pk_mul_f32 v[204:205], v[204:205], s[22:23]
    v_cvt_pk_bf16_f32 v44, v20, v204
    v_cvt_pk_bf16_f32 v45, v21, v205
    v_lshlrev_b32 v22, 16, v206
    v_lshlrev_b32 v23, 16, v207
    v_and_b32 v206, s30, v206
    v_and_b32 v207, s30, v207
    v_pk_mul_f32 v[22:23], v[22:23], s[22:23]
    v_pk_mul_f32 v[206:207], v[206:207], s[22:23]
    v_cvt_pk_bf16_f32 v46, v22, v206
    v_cvt_pk_bf16_f32 v47, v23, v207
    v_mfma_f32_16x16x32_bf16 v[20:23], a[120:123], a[96:99], 0
    v_exp_f32 v28, v28
    v_mfma_f32_16x16x32_bf16 v[20:23], a[124:127], v[36:39], v[20:23]
    ds_read_b64_tr_b16 a[242:243], v1 offset:18024
    v_add_f32 v8, v8, v27
    v_mfma_f32_16x16x32_bf16 v[20:23], a[192:195], v[40:43], v[20:23]
    v_exp_f32 v29, v29
    v_mfma_f32_16x16x32_bf16 v[20:23], a[228:231], v[44:47], v[20:23]
    v_cvt_pk_bf16_f32 v15, v26, v27
    v_add_f32 v9, v9, v28
    v_mfma_f32_16x16x32_bf16 v[24:27], a[200:203], a[96:99], 0
    s_add_u32 m0, s21, 44416
    v_exp_f32 v30, v30
    v_mfma_f32_16x16x32_bf16 v[24:27], a[216:219], v[36:39], v[24:27]
    buffer_load_dwordx4 v2, s[8:11], s20 offen offset:2048 nt lds
    v_add_f32 v9, v9, v29
    v_mfma_f32_16x16x32_bf16 v[24:27], a[220:223], v[40:43], v[24:27]
    v_exp_f32 v31, v31
    v_mfma_f32_16x16x32_bf16 v[24:27], a[224:227], v[44:47], v[24:27]
    v_add_f32 v9, v9, v30
    v_cvt_pk_bf16_f32 v16, v28, v29
    v_mfma_f32_16x16x32_bf16 v[128:131], a[252:255], v[12:15], v[128:131]
    v_exp_f32 v32, v32
    v_mfma_f32_16x16x32_bf16 v[132:135], a[100:103], v[12:15], v[132:135]
    v_add_f32 v9, v9, v31
    v_mfma_f32_16x16x32_bf16 v[136:139], a[196:199], v[12:15], v[136:139]
    v_exp_f32 v33, v33
    v_mfma_f32_16x16x32_bf16 v[140:143], a[104:107], v[12:15], v[140:143]
    v_add_f32 v9, v9, v32
    v_cvt_pk_bf16_f32 v17, v30, v31
    v_mfma_f32_16x16x32_bf16 v[144:147], a[212:215], v[12:15], v[144:147]
    v_exp_f32 v34, v34
    v_mfma_f32_16x16x32_bf16 v[148:151], a[108:111], v[12:15], v[148:151]
    v_add_f32 v9, v9, v33
    v_mfma_f32_16x16x32_bf16 v[152:155], a[116:119], v[12:15], v[152:155]
    v_exp_f32 v35, v35
    v_mfma_f32_16x16x32_bf16 v[156:159], a[244:247], v[12:15], v[156:159]
    v_add_f32 v9, v9, v34
    v_cvt_pk_bf16_f32 v18, v32, v33
    s_waitcnt vmcnt(9)
    v_lshlrev_b32 v28, 16, v224
    v_lshlrev_b32 v29, 16, v225
    v_and_b32 v224, s30, v224
    v_and_b32 v225, s30, v225
    v_pk_mul_f32 v[28:29], v[28:29], s[22:23]
    v_pk_mul_f32 v[224:225], v[224:225], s[22:23]
    v_cvt_pk_bf16_f32 v48, v28, v224
    v_cvt_pk_bf16_f32 v49, v29, v225
    v_lshlrev_b32 v30, 16, v226
    v_lshlrev_b32 v31, 16, v227
    v_and_b32 v226, s30, v226
    v_and_b32 v227, s30, v227
    v_pk_mul_f32 v[30:31], v[30:31], s[22:23]
    v_pk_mul_f32 v[226:227], v[226:227], s[22:23]
    v_cvt_pk_bf16_f32 v50, v30, v226
    v_cvt_pk_bf16_f32 v51, v31, v227
    s_waitcnt vmcnt(8)
    v_lshlrev_b32 v28, 16, v228
    v_lshlrev_b32 v29, 16, v229
    v_and_b32 v228, s30, v228
    v_and_b32 v229, s30, v229
    v_pk_mul_f32 v[28:29], v[28:29], s[22:23]
    v_pk_mul_f32 v[228:229], v[228:229], s[22:23]
    v_cvt_pk_bf16_f32 v52, v28, v228
    v_cvt_pk_bf16_f32 v53, v29, v229
    v_lshlrev_b32 v30, 16, v230
    v_lshlrev_b32 v31, 16, v231
    v_and_b32 v230, s30, v230
    v_and_b32 v231, s30, v231
    v_pk_mul_f32 v[30:31], v[30:31], s[22:23]
    v_pk_mul_f32 v[230:231], v[230:231], s[22:23]
    v_cvt_pk_bf16_f32 v54, v30, v230
    v_cvt_pk_bf16_f32 v55, v31, v231
    s_waitcnt vmcnt(7)
    v_lshlrev_b32 v28, 16, v232
    s_add_u32 m0, s39, 111184
    s_mov_b32 s25, 40960
    buffer_load_dwordx4 v3, s[12:15], s25 offen nt lds
    v_lshlrev_b32 v29, 16, v233
    v_and_b32 v232, s30, v232
    v_and_b32 v233, s30, v233
    v_pk_mul_f32 v[28:29], v[28:29], s[22:23]
    v_pk_mul_f32 v[232:233], v[232:233], s[22:23]
    v_cvt_pk_bf16_f32 v56, v28, v232
    v_cvt_pk_bf16_f32 v57, v29, v233
    v_lshlrev_b32 v30, 16, v234
    v_lshlrev_b32 v31, 16, v235
    v_and_b32 v234, s30, v234
    v_and_b32 v235, s30, v235
    v_pk_mul_f32 v[30:31], v[30:31], s[22:23]
    v_pk_mul_f32 v[234:235], v[234:235], s[22:23]
    v_cvt_pk_bf16_f32 v58, v30, v234
    v_cvt_pk_bf16_f32 v59, v31, v235
    s_waitcnt vmcnt(7)
    v_lshlrev_b32 v28, 16, v236
    s_add_u32 m0, s39, 114520
    s_nop 0
    buffer_load_dwordx4 v3, s[12:15], s25 offen offset:1024 nt lds
    v_lshlrev_b32 v29, 16, v237
    v_and_b32 v236, s30, v236
    v_and_b32 v237, s30, v237
    v_pk_mul_f32 v[28:29], v[28:29], s[22:23]
    v_pk_mul_f32 v[236:237], v[236:237], s[22:23]
    v_cvt_pk_bf16_f32 v60, v28, v236
    v_cvt_pk_bf16_f32 v61, v29, v237
    v_lshlrev_b32 v30, 16, v238
    v_lshlrev_b32 v31, 16, v239
    v_and_b32 v238, s30, v238
    v_and_b32 v239, s30, v239
    v_pk_mul_f32 v[30:31], v[30:31], s[22:23]
    v_pk_mul_f32 v[238:239], v[238:239], s[22:23]
    v_cvt_pk_bf16_f32 v62, v30, v238
    v_cvt_pk_bf16_f32 v63, v31, v239
    v_mfma_f32_16x16x32_bf16 v[28:31], a[120:123], v[48:51], 0
    v_exp_f32 v20, v20
    v_mfma_f32_16x16x32_bf16 v[28:31], a[124:127], v[52:55], v[28:31]
    ds_read_b128 a[124:127], v0 offset:16960
    v_add_f32 v9, v9, v35
    v_mfma_f32_16x16x32_bf16 v[28:31], a[192:195], v[56:59], v[28:31]
    v_exp_f32 v21, v21
    v_mfma_f32_16x16x32_bf16 v[28:31], a[228:231], v[60:63], v[28:31]
    v_cvt_pk_bf16_f32 v19, v34, v35
    v_mov_b32 v10, v20
    v_mfma_f32_16x16x32_bf16 v[32:35], a[200:203], v[48:51], 0
    v_exp_f32 v22, v22
    v_mfma_f32_16x16x32_bf16 v[32:35], a[216:219], v[52:55], v[32:35]
    ds_read_b128 a[216:219], v0 offset:17472
    v_add_f32 v10, v10, v21
    v_mfma_f32_16x16x32_bf16 v[32:35], a[220:223], v[56:59], v[32:35]
    v_exp_f32 v23, v23
    v_mfma_f32_16x16x32_bf16 v[32:35], a[224:227], v[60:63], v[32:35]
    v_add_f32 v10, v10, v22
    v_cvt_pk_bf16_f32 v12, v20, v21
    v_mfma_f32_16x16x32_bf16 v[160:163], a[252:255], v[16:19], v[160:163]
    v_exp_f32 v24, v24
    v_mfma_f32_16x16x32_bf16 v[164:167], a[100:103], v[16:19], v[164:167]
    ds_read_b128 a[192:195], v0 offset:17536
    v_add_f32 v10, v10, v23
    v_mfma_f32_16x16x32_bf16 v[168:171], a[196:199], v[16:19], v[168:171]
    v_exp_f32 v25, v25
    v_mfma_f32_16x16x32_bf16 v[172:175], a[104:107], v[16:19], v[172:175]
    v_add_f32 v10, v10, v24
    v_cvt_pk_bf16_f32 v13, v22, v23
    v_mfma_f32_16x16x32_bf16 v[176:179], a[212:215], v[16:19], v[176:179]
    v_exp_f32 v26, v26
    v_mfma_f32_16x16x32_bf16 v[180:183], a[108:111], v[16:19], v[180:183]
    ds_read_b128 a[228:231], v0 offset:17600
    v_add_f32 v10, v10, v25
    v_mfma_f32_16x16x32_bf16 v[184:187], a[116:119], v[16:19], v[184:187]
    v_exp_f32 v27, v27
    v_mfma_f32_16x16x32_bf16 v[188:191], a[244:247], v[16:19], v[188:191]
    s_waitcnt lgkmcnt(2)
    v_add_f32 v10, v10, v26
    v_cvt_pk_bf16_f32 v14, v24, v25
    v_mfma_f32_16x16x32_bf16 v[20:23], a[248:251], a[96:99], 0
    v_exp_f32 v28, v28
    v_mfma_f32_16x16x32_bf16 v[20:23], a[124:127], v[36:39], v[20:23]
    ds_read_b64_tr_b16 a[120:121], v1 offset:17568
    v_add_f32 v10, v10, v27
    v_mfma_f32_16x16x32_bf16 v[20:23], a[204:207], v[40:43], v[20:23]
    v_exp_f32 v29, v29
    v_mfma_f32_16x16x32_bf16 v[20:23], a[208:211], v[44:47], v[20:23]
    v_cvt_pk_bf16_f32 v15, v26, v27
    v_mov_b32 v11, v28
    v_mfma_f32_16x16x32_bf16 v[24:27], a[236:239], a[96:99], 0
    s_waitcnt lgkmcnt(2)
    v_exp_f32 v30, v30
    v_mfma_f32_16x16x32_bf16 v[24:27], a[216:219], v[36:39], v[24:27]
    ds_read_b64_tr_b16 a[122:123], v1 offset:18080
    v_add_f32 v11, v11, v29
    v_mfma_f32_16x16x32_bf16 v[24:27], a[192:195], v[40:43], v[24:27]
    s_waitcnt lgkmcnt(2)
    v_exp_f32 v31, v31
    v_mfma_f32_16x16x32_bf16 v[24:27], a[228:231], v[44:47], v[24:27]
    v_add_f32 v11, v11, v30
    v_cvt_pk_bf16_f32 v16, v28, v29
    v_mfma_f32_16x16x32_bf16 v[192:195], a[252:255], v[12:15], 0
    v_exp_f32 v32, v32
    v_mfma_f32_16x16x32_bf16 v[196:199], a[100:103], v[12:15], 0
    ds_read_b64_tr_b16 a[220:221], v1 offset:17576
    v_add_f32 v11, v11, v31
    v_mfma_f32_16x16x32_bf16 v[200:203], a[196:199], v[12:15], 0
    v_exp_f32 v33, v33
    v_mfma_f32_16x16x32_bf16 v[204:207], a[104:107], v[12:15], 0
    v_add_f32 v11, v11, v32
    v_cvt_pk_bf16_f32 v17, v30, v31
    v_mfma_f32_16x16x32_bf16 v[208:211], a[212:215], v[12:15], 0
    v_exp_f32 v34, v34
    v_mfma_f32_16x16x32_bf16 v[212:215], a[108:111], v[12:15], 0
    ds_read_b64_tr_b16 a[222:223], v1 offset:18088
    v_add_f32 v11, v11, v33
    v_mfma_f32_16x16x32_bf16 v[216:219], a[116:119], v[12:15], 0
    v_exp_f32 v35, v35
    v_mfma_f32_16x16x32_bf16 v[220:223], a[244:247], v[12:15], 0
    v_add_f32 v11, v11, v34
    v_cvt_pk_bf16_f32 v18, v32, v33
    v_mfma_f32_16x16x32_bf16 v[28:31], a[248:251], v[48:51], 0
    v_exp_f32 v20, v20
    v_mfma_f32_16x16x32_bf16 v[28:31], a[124:127], v[52:55], v[28:31]
    ds_read_b64_tr_b16 a[224:225], v1 offset:17632
    v_add_f32 v11, v11, v35
    v_mfma_f32_16x16x32_bf16 v[28:31], a[204:207], v[56:59], v[28:31]
    v_exp_f32 v21, v21
    v_mfma_f32_16x16x32_bf16 v[28:31], a[208:211], v[60:63], v[28:31]
    v_cvt_pk_bf16_f32 v19, v34, v35
    v_add_f32 v10, v10, v20
    v_mfma_f32_16x16x32_bf16 v[32:35], a[236:239], v[48:51], 0
    v_exp_f32 v22, v22
    v_mfma_f32_16x16x32_bf16 v[32:35], a[216:219], v[52:55], v[32:35]
    ds_read_b64_tr_b16 a[226:227], v1 offset:18144
    v_add_f32 v10, v10, v21
    v_mfma_f32_16x16x32_bf16 v[32:35], a[192:195], v[56:59], v[32:35]
    v_exp_f32 v23, v23
    v_mfma_f32_16x16x32_bf16 v[32:35], a[228:231], v[60:63], v[32:35]
    ds_read_b128 a[200:203], v0 offset:8448
    v_add_f32 v10, v10, v22
    v_cvt_pk_bf16_f32 v12, v20, v21
    v_mfma_f32_16x16x32_bf16 v[224:227], a[252:255], v[16:19], 0
    v_exp_f32 v24, v24
    v_mfma_f32_16x16x32_bf16 v[228:231], a[100:103], v[16:19], 0
    ds_read_b64_tr_b16 a[100:101], v1 offset:17448
    ds_read_b128 a[248:251], v0 offset:8512
    ds_read_b128 a[124:127], v0 offset:8576
    v_add_f32 v10, v10, v23
    v_mfma_f32_16x16x32_bf16 v[232:235], a[196:199], v[16:19], 0
    v_exp_f32 v25, v25
    v_mfma_f32_16x16x32_bf16 v[236:239], a[104:107], v[16:19], 0
    ds_read_b128 a[204:207], v0 offset:8640
    ds_read_b128 a[208:211], v0 offset:8960
    v_add_f32 v10, v10, v24
    v_cvt_pk_bf16_f32 v13, v22, v23
    v_mfma_f32_16x16x32_bf16 v[240:243], a[212:215], v[16:19], 0
    v_exp_f32 v26, v26
    v_mfma_f32_16x16x32_bf16 v[244:247], a[108:111], v[16:19], 0
    ds_read_b64_tr_b16 a[102:103], v1 offset:17960
    ds_read_b128 a[236:239], v0 offset:9024
    ds_read_b128 a[216:219], v0 offset:9088
    v_add_f32 v10, v10, v25
    v_mfma_f32_16x16x32_bf16 v[248:251], a[116:119], v[16:19], 0
    s_waitcnt lgkmcnt(8)
    v_exp_f32 v27, v27
    v_mfma_f32_16x16x32_bf16 v[252:255], a[244:247], v[16:19], 0
    ds_read_b128 a[192:195], v0 offset:9152
    v_add_f32 v10, v10, v26
    v_cvt_pk_bf16_f32 v14, v24, v25
    v_mfma_f32_16x16x32_bf16 v[20:23], a[200:203], a[96:99], 0
    s_waitcnt lgkmcnt(6)
    v_exp_f32 v28, v28
    v_mfma_f32_16x16x32_bf16 v[20:23], a[248:251], v[36:39], v[20:23]
    ds_read_b64_tr_b16 a[212:213], v1 offset:17640
    v_add_f32 v10, v10, v27
    v_mfma_f32_16x16x32_bf16 v[20:23], a[124:127], v[40:43], v[20:23]
    s_waitcnt lgkmcnt(6)
    v_exp_f32 v29, v29
    v_mfma_f32_16x16x32_bf16 v[20:23], a[204:207], v[44:47], v[20:23]
    s_waitcnt lgkmcnt(5)
    v_cvt_pk_bf16_f32 v15, v26, v27
    v_add_f32 v11, v11, v28
    v_mfma_f32_16x16x32_bf16 v[24:27], a[208:211], a[96:99], 0
    s_waitcnt lgkmcnt(2)
    v_exp_f32 v30, v30
    v_mfma_f32_16x16x32_bf16 v[24:27], a[236:239], v[36:39], v[24:27]
    ds_read_b64_tr_b16 a[214:215], v1 offset:18152
    v_add_f32 v11, v11, v29
    v_mfma_f32_16x16x32_bf16 v[24:27], a[216:219], v[40:43], v[24:27]
    s_waitcnt lgkmcnt(2)
    v_exp_f32 v31, v31
    v_mfma_f32_16x16x32_bf16 v[24:27], a[192:195], v[44:47], v[24:27]
    v_add_f32 v11, v11, v30
    v_cvt_pk_bf16_f32 v16, v28, v29
    v_mfma_f32_16x16x32_bf16 v[192:195], a[112:115], v[12:15], v[192:195]
    v_exp_f32 v32, v32
    v_mfma_f32_16x16x32_bf16 v[196:199], a[100:103], v[12:15], v[196:199]
    ds_read_b128 a[228:231], v0 offset:0
    v_add_f32 v11, v11, v31
    v_mfma_f32_16x16x32_bf16 v[200:203], a[232:235], v[12:15], v[200:203]
    v_exp_f32 v33, v33
    v_mfma_f32_16x16x32_bf16 v[204:207], a[240:243], v[12:15], v[204:207]
    v_add_f32 v11, v11, v32
    v_cvt_pk_bf16_f32 v17, v30, v31
    v_mfma_f32_16x16x32_bf16 v[208:211], a[120:123], v[12:15], v[208:211]
    v_exp_f32 v34, v34
    v_mfma_f32_16x16x32_bf16 v[212:215], a[220:223], v[12:15], v[212:215]
    ds_read_b128 a[252:255], v0 offset:64
    v_add_f32 v11, v11, v33
    v_mfma_f32_16x16x32_bf16 v[216:219], a[224:227], v[12:15], v[216:219]
    s_waitcnt lgkmcnt(2)
    v_exp_f32 v35, v35
    v_mfma_f32_16x16x32_bf16 v[220:223], a[212:215], v[12:15], v[220:223]
    v_add_f32 v11, v11, v34
    v_cvt_pk_bf16_f32 v18, v32, v33
    v_mfma_f32_16x16x32_bf16 v[28:31], a[200:203], v[48:51], 0
    v_exp_f32 v20, v20
    v_mfma_f32_16x16x32_bf16 v[28:31], a[248:251], v[52:55], v[28:31]
    ds_read_b128 a[196:199], v0 offset:128
    v_add_f32 v11, v11, v35
    v_mfma_f32_16x16x32_bf16 v[28:31], a[124:127], v[56:59], v[28:31]
    v_exp_f32 v21, v21
    v_mfma_f32_16x16x32_bf16 v[28:31], a[204:207], v[60:63], v[28:31]
    v_cvt_pk_bf16_f32 v19, v34, v35
    v_add_f32 v10, v10, v20
    v_mfma_f32_16x16x32_bf16 v[32:35], a[208:211], v[48:51], 0
    v_exp_f32 v22, v22
    v_mfma_f32_16x16x32_bf16 v[32:35], a[236:239], v[52:55], v[32:35]
    ds_read_b128 a[104:107], v0 offset:192
    v_add_f32 v10, v10, v21
    v_mfma_f32_16x16x32_bf16 v[32:35], a[216:219], v[56:59], v[32:35]
    v_exp_f32 v23, v23
    v_mfma_f32_16x16x32_bf16 v[32:35], a[192:195], v[60:63], v[32:35]
    v_add_f32 v10, v10, v22
    v_cvt_pk_bf16_f32 v12, v20, v21
    v_mfma_f32_16x16x32_bf16 v[224:227], a[112:115], v[16:19], v[224:227]
    v_exp_f32 v24, v24
    v_mfma_f32_16x16x32_bf16 v[228:231], a[100:103], v[16:19], v[228:231]
    ds_read_b128 a[108:111], v0 offset:512
    ds_read_b128 a[116:119], v0 offset:576
    ds_read_b128 a[244:247], v0 offset:640
    v_add_f32 v10, v10, v23
    v_mfma_f32_16x16x32_bf16 v[232:235], a[232:235], v[16:19], v[232:235]
    v_exp_f32 v25, v25
    v_mfma_f32_16x16x32_bf16 v[236:239], a[240:243], v[16:19], v[236:239]
    ds_read_b128 a[200:203], v0 offset:704
    ds_read_b64_tr_b16 a[248:249], v1 offset:8720
    v_add_f32 v10, v10, v24
    v_cvt_pk_bf16_f32 v13, v22, v23
    v_mfma_f32_16x16x32_bf16 v[240:243], a[120:123], v[16:19], v[240:243]
    v_exp_f32 v26, v26
    v_mfma_f32_16x16x32_bf16 v[244:247], a[220:223], v[16:19], v[244:247]
    ds_read_b64_tr_b16 a[250:251], v1 offset:9232
    ds_read_b64_tr_b16 a[124:125], v1 offset:8728
    ds_read_b64_tr_b16 a[126:127], v1 offset:9240
    v_add_f32 v10, v10, v25
    v_mfma_f32_16x16x32_bf16 v[248:251], a[224:227], v[16:19], v[248:251]
    s_waitcnt lgkmcnt(8)
    v_exp_f32 v27, v27
    v_mfma_f32_16x16x32_bf16 v[252:255], a[212:215], v[16:19], v[252:255]
    ds_read_b64_tr_b16 a[204:205], v1 offset:8784
    ds_read_b64_tr_b16 a[206:207], v1 offset:9296
    v_add_f32 v10, v10, v26
    v_cvt_pk_bf16_f32 v14, v24, v25
    v_mfma_f32_16x16x32_bf16 v[20:23], a[228:231], a[96:99], 0
    v_exp_f32 v28, v28
    v_mfma_f32_16x16x32_bf16 v[20:23], a[252:255], v[36:39], v[20:23]
    ds_read_b64_tr_b16 a[208:209], v1 offset:8792
    ds_read_b64_tr_b16 a[210:211], v1 offset:9304
    ds_read_b64_tr_b16 a[236:237], v1 offset:8848
    v_add_f32 v10, v10, v27
    v_mfma_f32_16x16x32_bf16 v[20:23], a[196:199], v[40:43], v[20:23]
    s_waitcnt lgkmcnt(10)
    v_exp_f32 v29, v29
    v_mfma_f32_16x16x32_bf16 v[20:23], a[104:107], v[44:47], v[20:23]
    ds_read_b64_tr_b16 a[238:239], v1 offset:9360
    ds_read_b64_tr_b16 a[216:217], v1 offset:8856
    v_cvt_pk_bf16_f32 v15, v26, v27
    v_add_f32 v11, v11, v28
    v_mfma_f32_16x16x32_bf16 v[24:27], a[108:111], a[96:99], 0
    v_exp_f32 v30, v30
    v_mfma_f32_16x16x32_bf16 v[24:27], a[116:119], v[36:39], v[24:27]
    ds_read_b64_tr_b16 a[218:219], v1 offset:9368
    ds_read_b64_tr_b16 a[192:193], v1 offset:8912
    ds_read_b64_tr_b16 a[194:195], v1 offset:9424
    v_add_f32 v11, v11, v29
    v_mfma_f32_16x16x32_bf16 v[24:27], a[244:247], v[40:43], v[24:27]
    s_waitcnt lgkmcnt(10)
    v_exp_f32 v31, v31
    v_mfma_f32_16x16x32_bf16 v[24:27], a[200:203], v[44:47], v[24:27]
    ds_read_b64_tr_b16 a[112:113], v1 offset:8920
    ds_read_b64_tr_b16 a[114:115], v1 offset:9432
    v_add_f32 v11, v11, v30
    v_cvt_pk_bf16_f32 v16, v28, v29
    v_mfma_f32_16x16x32_bf16 v[192:195], a[248:251], v[12:15], v[192:195]
    s_waitcnt lgkmcnt(10)
    v_exp_f32 v32, v32
    v_mfma_f32_16x16x32_bf16 v[196:199], a[124:127], v[12:15], v[196:199]
    ds_read_b64_tr_b16 a[100:101], v1 offset:0
    v_add_f32 v11, v11, v31
    v_mfma_f32_16x16x32_bf16 v[200:203], a[204:207], v[12:15], v[200:203]
    s_waitcnt lgkmcnt(8)
    v_exp_f32 v33, v33
    v_mfma_f32_16x16x32_bf16 v[204:207], a[208:211], v[12:15], v[204:207]
    s_waitcnt lgkmcnt(6)
    v_add_f32 v11, v11, v32
    v_cvt_pk_bf16_f32 v17, v30, v31
    v_mfma_f32_16x16x32_bf16 v[208:211], a[236:239], v[12:15], v[208:211]
    s_waitcnt lgkmcnt(3)
    v_exp_f32 v34, v34
    v_mfma_f32_16x16x32_bf16 v[212:215], a[216:219], v[12:15], v[212:215]
    ds_read_b64_tr_b16 a[102:103], v1 offset:512
    v_add_f32 v11, v11, v33
    v_mfma_f32_16x16x32_bf16 v[216:219], a[192:195], v[12:15], v[216:219]
    s_waitcnt lgkmcnt(2)
    v_exp_f32 v35, v35
    v_mfma_f32_16x16x32_bf16 v[220:223], a[112:115], v[12:15], v[220:223]
    v_add_f32 v11, v11, v34
    v_cvt_pk_bf16_f32 v18, v32, v33
    v_mfma_f32_16x16x32_bf16 v[28:31], a[228:231], v[48:51], 0
    v_exp_f32 v20, v20
    v_mfma_f32_16x16x32_bf16 v[28:31], a[252:255], v[52:55], v[28:31]
    ds_read_b64_tr_b16 a[232:233], v1 offset:8
    v_add_f32 v11, v11, v35
    v_mfma_f32_16x16x32_bf16 v[28:31], a[196:199], v[56:59], v[28:31]
    v_exp_f32 v21, v21
    v_mfma_f32_16x16x32_bf16 v[28:31], a[104:107], v[60:63], v[28:31]
    v_cvt_pk_bf16_f32 v19, v34, v35
    v_add_f32 v10, v10, v20
    v_mfma_f32_16x16x32_bf16 v[32:35], a[108:111], v[48:51], 0
    s_waitcnt vmcnt(4)
    s_barrier
    v_exp_f32 v22, v22
    v_mfma_f32_16x16x32_bf16 v[32:35], a[116:119], v[52:55], v[32:35]
    ds_read_b128 a[240:243], v0 offset:33792
    v_add_f32 v10, v10, v21
    v_mfma_f32_16x16x32_bf16 v[32:35], a[244:247], v[56:59], v[32:35]
    v_exp_f32 v23, v23
    v_mfma_f32_16x16x32_bf16 v[32:35], a[200:203], v[60:63], v[32:35]
    v_add_f32 v10, v10, v22
    v_cvt_pk_bf16_f32 v12, v20, v21
    v_mfma_f32_16x16x32_bf16 v[224:227], a[248:251], v[16:19], v[224:227]
    v_exp_f32 v24, v24
    v_mfma_f32_16x16x32_bf16 v[228:231], a[124:127], v[16:19], v[228:231]
    ds_read_b128 a[120:123], v0 offset:33856
    ds_read_b128 a[220:223], v0 offset:33920
    ds_read_b128 a[224:227], v0 offset:33984
    v_add_f32 v10, v10, v23
    v_mfma_f32_16x16x32_bf16 v[232:235], a[204:207], v[16:19], v[232:235]
    v_exp_f32 v25, v25
    v_mfma_f32_16x16x32_bf16 v[236:239], a[208:211], v[16:19], v[236:239]
    ds_read_b128 a[212:215], v0 offset:34304
    ds_read_b128 a[228:231], v0 offset:34368
    v_add_f32 v10, v10, v24
    v_cvt_pk_bf16_f32 v13, v22, v23
    v_mfma_f32_16x16x32_bf16 v[240:243], a[236:239], v[16:19], v[240:243]
    v_exp_f32 v26, v26
    v_mfma_f32_16x16x32_bf16 v[244:247], a[216:219], v[16:19], v[244:247]
    ds_read_b128 a[252:255], v0 offset:34432
    ds_read_b128 a[196:199], v0 offset:34496
    ds_read_b64_tr_b16 a[234:235], v1 offset:520
    v_add_f32 v10, v10, v25
    v_mfma_f32_16x16x32_bf16 v[248:251], a[192:195], v[16:19], v[248:251]
    s_waitcnt lgkmcnt(8)
    v_exp_f32 v27, v27
    v_mfma_f32_16x16x32_bf16 v[252:255], a[112:115], v[16:19], v[252:255]
    ds_read_b64_tr_b16 a[104:105], v1 offset:64
    ds_read_b64_tr_b16 a[106:107], v1 offset:576
    v_add_f32 v10, v10, v26
    v_cvt_pk_bf16_f32 v14, v24, v25
    v_mfma_f32_16x16x32_bf16 v[20:23], a[240:243], a[0:3], 0
    s_waitcnt lgkmcnt(8)
    v_exp_f32 v28, v28
    v_mfma_f32_16x16x32_bf16 v[20:23], a[120:123], a[4:7], v[20:23]
    ds_read_b64_tr_b16 a[108:109], v1 offset:72
    ds_read_b64_tr_b16 a[110:111], v1 offset:584
    ds_read_b64_tr_b16 a[116:117], v1 offset:128
    v_add_f32 v10, v10, v27
    v_mfma_f32_16x16x32_bf16 v[20:23], a[220:223], a[8:11], v[20:23]
    s_waitcnt lgkmcnt(9)
    v_exp_f32 v29, v29
    v_mfma_f32_16x16x32_bf16 v[20:23], a[224:227], a[12:15], v[20:23]
    ds_read_b64_tr_b16 a[118:119], v1 offset:640
    ds_read_b64_tr_b16 a[244:245], v1 offset:136
    v_cvt_pk_bf16_f32 v15, v26, v27
    v_add_f32 v11, v11, v28
    v_mfma_f32_16x16x32_bf16 v[24:27], a[212:215], a[0:3], 0
    s_waitcnt lgkmcnt(9)
    v_exp_f32 v30, v30
    v_mfma_f32_16x16x32_bf16 v[24:27], a[228:231], a[4:7], v[24:27]
    ds_read_b64_tr_b16 a[246:247], v1 offset:648
    ds_read_b64_tr_b16 a[200:201], v1 offset:192
    ds_read_b64_tr_b16 a[202:203], v1 offset:704
    v_add_f32 v11, v11, v29
    v_mfma_f32_16x16x32_bf16 v[24:27], a[252:255], a[8:11], v[24:27]
    s_waitcnt lgkmcnt(10)
    v_exp_f32 v31, v31
    v_mfma_f32_16x16x32_bf16 v[24:27], a[196:199], a[12:15], v[24:27]
    ds_read_b64_tr_b16 a[248:249], v1 offset:200
    ds_read_b64_tr_b16 a[250:251], v1 offset:712
    v_add_f32 v11, v11, v30
    v_cvt_pk_bf16_f32 v16, v28, v29
    v_mfma_f32_16x16x32_bf16 v[192:195], a[100:103], v[12:15], v[192:195]
    s_waitcnt lgkmcnt(10)
    v_exp_f32 v32, v32
    v_mfma_f32_16x16x32_bf16 v[196:199], a[232:235], v[12:15], v[196:199]
    ds_read_b64_tr_b16 a[124:125], v1 offset:34880
    v_add_f32 v11, v11, v31
    v_mfma_f32_16x16x32_bf16 v[200:203], a[104:107], v[12:15], v[200:203]
    s_waitcnt lgkmcnt(8)
    v_exp_f32 v33, v33
    v_mfma_f32_16x16x32_bf16 v[204:207], a[108:111], v[12:15], v[204:207]
    s_waitcnt lgkmcnt(6)
    v_add_f32 v11, v11, v32
    v_cvt_pk_bf16_f32 v17, v30, v31
    v_mfma_f32_16x16x32_bf16 v[208:211], a[116:119], v[12:15], v[208:211]
    s_waitcnt lgkmcnt(3)
    v_exp_f32 v34, v34
    v_mfma_f32_16x16x32_bf16 v[212:215], a[244:247], v[12:15], v[212:215]
    ds_read_b64_tr_b16 a[126:127], v1 offset:35392
    v_add_f32 v11, v11, v33
    v_mfma_f32_16x16x32_bf16 v[216:219], a[200:203], v[12:15], v[216:219]
    s_waitcnt lgkmcnt(2)
    v_exp_f32 v35, v35
    v_mfma_f32_16x16x32_bf16 v[220:223], a[248:251], v[12:15], v[220:223]
    v_add_f32 v11, v11, v34
    v_cvt_pk_bf16_f32 v18, v32, v33
    v_mfma_f32_16x16x32_bf16 v[28:31], a[240:243], a[16:19], 0
    v_exp_f32 v20, v20
    v_mfma_f32_16x16x32_bf16 v[28:31], a[120:123], a[20:23], v[28:31]
    ds_read_b64_tr_b16 a[204:205], v1 offset:34888
    v_add_f32 v11, v11, v35
    v_mfma_f32_16x16x32_bf16 v[28:31], a[220:223], a[24:27], v[28:31]
    v_exp_f32 v21, v21
    v_mfma_f32_16x16x32_bf16 v[28:31], a[224:227], a[28:31], v[28:31]
    v_cvt_pk_bf16_f32 v19, v34, v35
    v_add_f32 v4, v4, v20
    v_mfma_f32_16x16x32_bf16 v[32:35], a[212:215], a[16:19], 0
    v_exp_f32 v22, v22
    v_mfma_f32_16x16x32_bf16 v[32:35], a[228:231], a[20:23], v[32:35]
    ds_read_b64_tr_b16 a[206:207], v1 offset:35400
    v_add_f32 v4, v4, v21
    v_mfma_f32_16x16x32_bf16 v[32:35], a[252:255], a[24:27], v[32:35]
    v_exp_f32 v23, v23
    v_mfma_f32_16x16x32_bf16 v[32:35], a[196:199], a[28:31], v[32:35]
    v_add_f32 v4, v4, v22
    v_cvt_pk_bf16_f32 v12, v20, v21
    v_mfma_f32_16x16x32_bf16 v[224:227], a[100:103], v[16:19], v[224:227]
    v_exp_f32 v24, v24
    v_mfma_f32_16x16x32_bf16 v[228:231], a[232:235], v[16:19], v[228:231]
    ds_read_b64_tr_b16 a[208:209], v1 offset:34944
    v_add_f32 v4, v4, v23
    v_mfma_f32_16x16x32_bf16 v[232:235], a[104:107], v[16:19], v[232:235]
    v_exp_f32 v25, v25
    v_mfma_f32_16x16x32_bf16 v[236:239], a[108:111], v[16:19], v[236:239]
    v_add_f32 v4, v4, v24
    v_cvt_pk_bf16_f32 v13, v22, v23
    v_mfma_f32_16x16x32_bf16 v[240:243], a[116:119], v[16:19], v[240:243]
    v_exp_f32 v26, v26
    v_mfma_f32_16x16x32_bf16 v[244:247], a[244:247], v[16:19], v[244:247]
    ds_read_b64_tr_b16 a[210:211], v1 offset:35456
    v_add_f32 v4, v4, v25
    v_mfma_f32_16x16x32_bf16 v[248:251], a[200:203], v[16:19], v[248:251]
    v_exp_f32 v27, v27
    v_mfma_f32_16x16x32_bf16 v[252:255], a[248:251], v[16:19], v[252:255]
    v_add_f32 v4, v4, v26
    v_cvt_pk_bf16_f32 v14, v24, v25
    v_mfma_f32_16x16x32_bf16 v[20:23], a[240:243], a[32:35], 0
    v_exp_f32 v28, v28
    v_mfma_f32_16x16x32_bf16 v[20:23], a[120:123], a[36:39], v[20:23]
    ds_read_b64_tr_b16 a[236:237], v1 offset:34952
    ds_read_b64_tr_b16 a[238:239], v1 offset:35464
    ds_read_b64_tr_b16 a[216:217], v1 offset:35008
    v_add_f32 v4, v4, v27
    v_mfma_f32_16x16x32_bf16 v[20:23], a[220:223], a[40:43], v[20:23]
    v_exp_f32 v29, v29
    v_mfma_f32_16x16x32_bf16 v[20:23], a[224:227], a[44:47], v[20:23]
    ds_read_b64_tr_b16 a[218:219], v1 offset:35520
    ds_read_b64_tr_b16 a[192:193], v1 offset:35016
    v_cvt_pk_bf16_f32 v15, v26, v27
    v_add_f32 v5, v5, v28
    v_mfma_f32_16x16x32_bf16 v[24:27], a[212:215], a[32:35], 0
    v_exp_f32 v30, v30
    v_mfma_f32_16x16x32_bf16 v[24:27], a[228:231], a[36:39], v[24:27]
    ds_read_b64_tr_b16 a[194:195], v1 offset:35528
    ds_read_b64_tr_b16 a[112:113], v1 offset:35072
    ds_read_b64_tr_b16 a[114:115], v1 offset:35584
    v_add_f32 v5, v5, v29
    v_mfma_f32_16x16x32_bf16 v[24:27], a[252:255], a[40:43], v[24:27]
    s_waitcnt lgkmcnt(8)
    v_exp_f32 v31, v31
    v_mfma_f32_16x16x32_bf16 v[24:27], a[196:199], a[44:47], v[24:27]
    ds_read_b64_tr_b16 a[100:101], v1 offset:35080
    ds_read_b64_tr_b16 a[102:103], v1 offset:35592
    v_add_f32 v5, v5, v30
    v_cvt_pk_bf16_f32 v16, v28, v29
    v_mfma_f32_16x16x32_bf16 v[64:67], a[124:127], v[12:15], v[64:67]
    s_add_u32 m0, s21, 50688
    s_mov_b32 s20, 49152
    v_exp_f32 v32, v32
    v_mfma_f32_16x16x32_bf16 v[68:71], a[204:207], v[12:15], v[68:71]
    buffer_load_dwordx4 v2, s[8:11], s20 offen nt lds
    v_add_f32 v5, v5, v31
    v_mfma_f32_16x16x32_bf16 v[72:75], a[208:211], v[12:15], v[72:75]
    s_waitcnt lgkmcnt(7)
    v_exp_f32 v33, v33
    v_mfma_f32_16x16x32_bf16 v[76:79], a[236:239], v[12:15], v[76:79]
    s_waitcnt lgkmcnt(5)
    v_add_f32 v5, v5, v32
    v_cvt_pk_bf16_f32 v17, v30, v31
    v_mfma_f32_16x16x32_bf16 v[80:83], a[216:219], v[12:15], v[80:83]
    s_waitcnt lgkmcnt(2)
    s_add_u32 m0, s21, 52864
    v_exp_f32 v34, v34
    v_mfma_f32_16x16x32_bf16 v[84:87], a[192:195], v[12:15], v[84:87]
    buffer_load_dwordx4 v2, s[8:11], s20 offen offset:2048 nt lds
    v_add_f32 v5, v5, v33
    v_mfma_f32_16x16x32_bf16 v[88:91], a[112:115], v[12:15], v[88:91]
    s_waitcnt lgkmcnt(0)
    v_exp_f32 v35, v35
    v_mfma_f32_16x16x32_bf16 v[92:95], a[100:103], v[12:15], v[92:95]
    v_add_f32 v5, v5, v34
    v_cvt_pk_bf16_f32 v18, v32, v33
    v_mfma_f32_16x16x32_bf16 v[28:31], a[240:243], a[48:51], 0
    s_add_u32 m0, s39, 119904
    s_mov_b32 s25, 49152
    v_exp_f32 v20, v20
    v_mfma_f32_16x16x32_bf16 v[28:31], a[120:123], a[52:55], v[28:31]
    buffer_load_dwordx4 v3, s[12:15], s25 offen nt lds
    v_add_f32 v5, v5, v35
    v_mfma_f32_16x16x32_bf16 v[28:31], a[220:223], a[56:59], v[28:31]
    v_exp_f32 v21, v21
    v_mfma_f32_16x16x32_bf16 v[28:31], a[224:227], a[60:63], v[28:31]
    v_cvt_pk_bf16_f32 v19, v34, v35
    v_add_f32 v6, v6, v20
    v_mfma_f32_16x16x32_bf16 v[32:35], a[212:215], a[48:51], 0
    s_add_u32 m0, s39, 123240
    v_exp_f32 v22, v22
    v_mfma_f32_16x16x32_bf16 v[32:35], a[228:231], a[52:55], v[32:35]
    buffer_load_dwordx4 v3, s[12:15], s25 offen offset:1024 nt lds
    v_add_f32 v6, v6, v21
    v_mfma_f32_16x16x32_bf16 v[32:35], a[252:255], a[56:59], v[32:35]
    v_exp_f32 v23, v23
    v_mfma_f32_16x16x32_bf16 v[32:35], a[196:199], a[60:63], v[32:35]
    v_add_f32 v6, v6, v22
    v_cvt_pk_bf16_f32 v12, v20, v21
    v_mfma_f32_16x16x32_bf16 v[96:99], a[124:127], v[16:19], v[96:99]
    s_add_u32 m0, s21, 59136
    s_mov_b32 s20, 57344
    v_exp_f32 v24, v24
    v_mfma_f32_16x16x32_bf16 v[100:103], a[204:207], v[16:19], v[100:103]
    buffer_load_dwordx4 v2, s[8:11], s20 offen nt lds
    v_add_f32 v6, v6, v23
    v_mfma_f32_16x16x32_bf16 v[104:107], a[208:211], v[16:19], v[104:107]
    v_exp_f32 v25, v25
    v_mfma_f32_16x16x32_bf16 v[108:111], a[236:239], v[16:19], v[108:111]
    v_add_f32 v6, v6, v24
    v_cvt_pk_bf16_f32 v13, v22, v23
    v_mfma_f32_16x16x32_bf16 v[112:115], a[216:219], v[16:19], v[112:115]
    s_add_u32 m0, s21, 61312
    v_exp_f32 v26, v26
    v_mfma_f32_16x16x32_bf16 v[116:119], a[192:195], v[16:19], v[116:119]
    buffer_load_dwordx4 v2, s[8:11], s20 offen offset:2048 nt lds
    v_add_f32 v6, v6, v25
    v_mfma_f32_16x16x32_bf16 v[120:123], a[112:115], v[16:19], v[120:123]
    v_exp_f32 v27, v27
    v_mfma_f32_16x16x32_bf16 v[124:127], a[100:103], v[16:19], v[124:127]
    v_add_f32 v6, v6, v26
    v_cvt_pk_bf16_f32 v14, v24, v25
    v_mfma_f32_16x16x32_bf16 v[20:23], a[240:243], a[64:67], 0
    s_add_u32 m0, s39, 128624
    s_mov_b32 s25, 57344
    v_exp_f32 v28, v28
    v_mfma_f32_16x16x32_bf16 v[20:23], a[120:123], a[68:71], v[20:23]
    buffer_load_dwordx4 v3, s[12:15], s25 offen nt lds
    v_add_f32 v6, v6, v27
    v_mfma_f32_16x16x32_bf16 v[20:23], a[220:223], a[72:75], v[20:23]
    v_exp_f32 v29, v29
    v_mfma_f32_16x16x32_bf16 v[20:23], a[224:227], a[76:79], v[20:23]
    v_cvt_pk_bf16_f32 v15, v26, v27
    v_add_f32 v7, v7, v28
    v_mfma_f32_16x16x32_bf16 v[24:27], a[212:215], a[64:67], 0
    s_add_u32 m0, s39, 131960
    v_exp_f32 v30, v30
    v_mfma_f32_16x16x32_bf16 v[24:27], a[228:231], a[68:71], v[24:27]
    buffer_load_dwordx4 v3, s[12:15], s25 offen offset:1024 nt lds
    v_add_f32 v7, v7, v29
    v_mfma_f32_16x16x32_bf16 v[24:27], a[252:255], a[72:75], v[24:27]
    v_exp_f32 v31, v31
    v_mfma_f32_16x16x32_bf16 v[24:27], a[196:199], a[76:79], v[24:27]
    v_add_f32 v7, v7, v30
    v_cvt_pk_bf16_f32 v16, v28, v29
    v_mfma_f32_16x16x32_bf16 a[128:131], a[124:127], v[12:15], a[128:131]
    s_add_u32 m0, s21, 0
    s_mov_b32 s20, 65536
    v_exp_f32 v32, v32
    v_mfma_f32_16x16x32_bf16 a[132:135], a[204:207], v[12:15], a[132:135]
    buffer_load_dwordx4 v2, s[8:11], s20 offen nt lds
    v_add_f32 v7, v7, v31
    v_mfma_f32_16x16x32_bf16 a[136:139], a[208:211], v[12:15], a[136:139]
    v_exp_f32 v33, v33
    v_mfma_f32_16x16x32_bf16 a[140:143], a[236:239], v[12:15], a[140:143]
    v_add_f32 v7, v7, v32
    v_cvt_pk_bf16_f32 v17, v30, v31
    v_mfma_f32_16x16x32_bf16 a[144:147], a[216:219], v[12:15], a[144:147]
    s_add_u32 m0, s21, 2176
    v_exp_f32 v34, v34
    v_mfma_f32_16x16x32_bf16 a[148:151], a[192:195], v[12:15], a[148:151]
    buffer_load_dwordx4 v2, s[8:11], s20 offen offset:2048 nt lds
    v_add_f32 v7, v7, v33
    v_mfma_f32_16x16x32_bf16 a[152:155], a[112:115], v[12:15], a[152:155]
    v_exp_f32 v35, v35
    v_mfma_f32_16x16x32_bf16 a[156:159], a[100:103], v[12:15], a[156:159]
    v_add_f32 v7, v7, v34
    v_cvt_pk_bf16_f32 v18, v32, v33
    v_mfma_f32_16x16x32_bf16 v[28:31], a[240:243], a[80:83], 0
    v_exp_f32 v20, v20
    v_mfma_f32_16x16x32_bf16 v[28:31], a[120:123], a[84:87], v[28:31]
    v_add_f32 v7, v7, v35
    v_mfma_f32_16x16x32_bf16 v[28:31], a[220:223], a[88:91], v[28:31]
    v_exp_f32 v21, v21
    v_mfma_f32_16x16x32_bf16 v[28:31], a[224:227], a[92:95], v[28:31]
    v_cvt_pk_bf16_f32 v19, v34, v35
    v_add_f32 v8, v8, v20
    v_mfma_f32_16x16x32_bf16 v[32:35], a[212:215], a[80:83], 0
    v_exp_f32 v22, v22
    v_mfma_f32_16x16x32_bf16 v[32:35], a[228:231], a[84:87], v[32:35]
    v_add_f32 v8, v8, v21
    v_mfma_f32_16x16x32_bf16 v[32:35], a[252:255], a[88:91], v[32:35]
    v_exp_f32 v23, v23
    v_mfma_f32_16x16x32_bf16 v[32:35], a[196:199], a[92:95], v[32:35]
    v_add_f32 v8, v8, v22
    v_cvt_pk_bf16_f32 v12, v20, v21
    v_mfma_f32_16x16x32_bf16 a[160:163], a[124:127], v[16:19], a[160:163]
    v_exp_f32 v24, v24
    v_mfma_f32_16x16x32_bf16 a[164:167], a[204:207], v[16:19], a[164:167]
    v_add_f32 v8, v8, v23
    v_mfma_f32_16x16x32_bf16 a[168:171], a[208:211], v[16:19], a[168:171]
    v_exp_f32 v25, v25
    v_mfma_f32_16x16x32_bf16 a[172:175], a[236:239], v[16:19], a[172:175]
    v_add_f32 v8, v8, v24
    v_cvt_pk_bf16_f32 v13, v22, v23
    v_mfma_f32_16x16x32_bf16 a[176:179], a[216:219], v[16:19], a[176:179]
    v_exp_f32 v26, v26
    v_mfma_f32_16x16x32_bf16 a[180:183], a[192:195], v[16:19], a[180:183]
    v_add_f32 v8, v8, v25
    v_mfma_f32_16x16x32_bf16 a[184:187], a[112:115], v[16:19], a[184:187]
    v_exp_f32 v27, v27
    v_mfma_f32_16x16x32_bf16 a[188:191], a[100:103], v[16:19], a[188:191]
    v_add_f32 v8, v8, v26
    v_cvt_pk_bf16_f32 v14, v24, v25
    v_mfma_f32_16x16x32_bf16 v[20:23], a[240:243], a[96:99], 0
    v_exp_f32 v28, v28
    v_mfma_f32_16x16x32_bf16 v[20:23], a[120:123], v[36:39], v[20:23]
    v_add_f32 v8, v8, v27
    v_mfma_f32_16x16x32_bf16 v[20:23], a[220:223], v[40:43], v[20:23]
    v_exp_f32 v29, v29
    v_mfma_f32_16x16x32_bf16 v[20:23], a[224:227], v[44:47], v[20:23]
    v_cvt_pk_bf16_f32 v15, v26, v27
    v_add_f32 v9, v9, v28
    v_mfma_f32_16x16x32_bf16 v[24:27], a[212:215], a[96:99], 0
    v_exp_f32 v30, v30
    v_mfma_f32_16x16x32_bf16 v[24:27], a[228:231], v[36:39], v[24:27]
    v_add_f32 v9, v9, v29
    v_mfma_f32_16x16x32_bf16 v[24:27], a[252:255], v[40:43], v[24:27]
    v_exp_f32 v31, v31
    v_mfma_f32_16x16x32_bf16 v[24:27], a[196:199], v[44:47], v[24:27]
    v_add_f32 v9, v9, v30
    v_cvt_pk_bf16_f32 v16, v28, v29
    v_mfma_f32_16x16x32_bf16 v[128:131], a[124:127], v[12:15], v[128:131]
    v_exp_f32 v32, v32
    v_mfma_f32_16x16x32_bf16 v[132:135], a[204:207], v[12:15], v[132:135]
    v_add_f32 v9, v9, v31
    v_mfma_f32_16x16x32_bf16 v[136:139], a[208:211], v[12:15], v[136:139]
    v_exp_f32 v33, v33
    v_mfma_f32_16x16x32_bf16 v[140:143], a[236:239], v[12:15], v[140:143]
    v_add_f32 v9, v9, v32
    v_cvt_pk_bf16_f32 v17, v30, v31
    v_mfma_f32_16x16x32_bf16 v[144:147], a[216:219], v[12:15], v[144:147]
    v_exp_f32 v34, v34
    v_mfma_f32_16x16x32_bf16 v[148:151], a[192:195], v[12:15], v[148:151]
    v_add_f32 v9, v9, v33
    v_mfma_f32_16x16x32_bf16 v[152:155], a[112:115], v[12:15], v[152:155]
    v_exp_f32 v35, v35
    v_mfma_f32_16x16x32_bf16 v[156:159], a[100:103], v[12:15], v[156:159]
    v_add_f32 v9, v9, v34
    v_cvt_pk_bf16_f32 v18, v32, v33
    v_mfma_f32_16x16x32_bf16 v[28:31], a[240:243], v[48:51], 0
    v_exp_f32 v20, v20
    v_mfma_f32_16x16x32_bf16 v[28:31], a[120:123], v[52:55], v[28:31]
    v_add_f32 v9, v9, v35
    v_mfma_f32_16x16x32_bf16 v[28:31], a[220:223], v[56:59], v[28:31]
    v_exp_f32 v21, v21
    v_mfma_f32_16x16x32_bf16 v[28:31], a[224:227], v[60:63], v[28:31]
    v_cvt_pk_bf16_f32 v19, v34, v35
    v_add_f32 v10, v10, v20
    v_mfma_f32_16x16x32_bf16 v[32:35], a[212:215], v[48:51], 0
    s_waitcnt vmcnt(10)
    s_barrier
    v_exp_f32 v22, v22
    v_mfma_f32_16x16x32_bf16 v[32:35], a[228:231], v[52:55], v[32:35]
    ds_read_b128 a[232:235], v0 offset:42240
    v_add_f32 v10, v10, v21
    v_mfma_f32_16x16x32_bf16 v[32:35], a[252:255], v[56:59], v[32:35]
    v_exp_f32 v23, v23
    v_mfma_f32_16x16x32_bf16 v[32:35], a[196:199], v[60:63], v[32:35]
    v_add_f32 v10, v10, v22
    v_cvt_pk_bf16_f32 v12, v20, v21
    v_mfma_f32_16x16x32_bf16 v[160:163], a[124:127], v[16:19], v[160:163]
    v_exp_f32 v24, v24
    v_mfma_f32_16x16x32_bf16 v[164:167], a[204:207], v[16:19], v[164:167]
    ds_read_b128 a[104:107], v0 offset:42304
    ds_read_b128 a[108:111], v0 offset:42368
    v_add_f32 v10, v10, v23
    v_mfma_f32_16x16x32_bf16 v[168:171], a[208:211], v[16:19], v[168:171]
    v_exp_f32 v25, v25
    v_mfma_f32_16x16x32_bf16 v[172:175], a[236:239], v[16:19], v[172:175]
    ds_read_b128 a[116:119], v0 offset:42432
    ds_read_b128 a[244:247], v0 offset:42752
    v_add_f32 v10, v10, v24
    v_cvt_pk_bf16_f32 v13, v22, v23
    v_mfma_f32_16x16x32_bf16 v[176:179], a[216:219], v[16:19], v[176:179]
    v_exp_f32 v26, v26
    v_mfma_f32_16x16x32_bf16 v[180:183], a[192:195], v[16:19], v[180:183]
    ds_read_b128 a[200:203], v0 offset:42816
    ds_read_b128 a[248:251], v0 offset:42880
    v_add_f32 v10, v10, v25
    v_mfma_f32_16x16x32_bf16 v[184:187], a[112:115], v[16:19], v[184:187]
    s_waitcnt lgkmcnt(6)
    v_exp_f32 v27, v27
    v_mfma_f32_16x16x32_bf16 v[188:191], a[100:103], v[16:19], v[188:191]
    ds_read_b128 a[240:243], v0 offset:42944
    v_add_f32 v10, v10, v26
    v_cvt_pk_bf16_f32 v14, v24, v25
    v_mfma_f32_16x16x32_bf16 v[20:23], a[232:235], a[0:3], 0
    s_waitcnt lgkmcnt(5)
    v_exp_f32 v28, v28
    v_mfma_f32_16x16x32_bf16 v[20:23], a[104:107], a[4:7], v[20:23]
    ds_read_b64_tr_b16 a[120:121], v1 offset:43600
    v_add_f32 v10, v10, v27
    v_mfma_f32_16x16x32_bf16 v[20:23], a[108:111], a[8:11], v[20:23]
    s_waitcnt lgkmcnt(5)
    v_exp_f32 v29, v29
    v_mfma_f32_16x16x32_bf16 v[20:23], a[116:119], a[12:15], v[20:23]
    s_waitcnt lgkmcnt(4)
    v_cvt_pk_bf16_f32 v15, v26, v27
    v_add_f32 v11, v11, v28
    v_mfma_f32_16x16x32_bf16 v[24:27], a[244:247], a[0:3], 0
    s_waitcnt lgkmcnt(2)
    v_exp_f32 v30, v30
    v_mfma_f32_16x16x32_bf16 v[24:27], a[200:203], a[4:7], v[24:27]
    ds_read_b64_tr_b16 a[122:123], v1 offset:44112
    v_add_f32 v11, v11, v29
    v_mfma_f32_16x16x32_bf16 v[24:27], a[248:251], a[8:11], v[24:27]
    s_waitcnt lgkmcnt(2)
    v_exp_f32 v31, v31
    v_mfma_f32_16x16x32_bf16 v[24:27], a[240:243], a[12:15], v[24:27]
    v_add_f32 v11, v11, v30
    v_cvt_pk_bf16_f32 v16, v28, v29
    v_mfma_f32_16x16x32_bf16 v[192:195], a[124:127], v[12:15], v[192:195]
    v_exp_f32 v32, v32
    v_mfma_f32_16x16x32_bf16 v[196:199], a[204:207], v[12:15], v[196:199]
    ds_read_b64_tr_b16 a[220:221], v1 offset:43608
    v_add_f32 v11, v11, v31
    v_mfma_f32_16x16x32_bf16 v[200:203], a[208:211], v[12:15], v[200:203]
    v_exp_f32 v33, v33
    v_mfma_f32_16x16x32_bf16 v[204:207], a[236:239], v[12:15], v[204:207]
    v_add_f32 v11, v11, v32
    v_cvt_pk_bf16_f32 v17, v30, v31
    v_mfma_f32_16x16x32_bf16 v[208:211], a[216:219], v[12:15], v[208:211]
    v_exp_f32 v34, v34
    v_mfma_f32_16x16x32_bf16 v[212:215], a[192:195], v[12:15], v[212:215]
    ds_read_b64_tr_b16 a[222:223], v1 offset:44120
    v_add_f32 v11, v11, v33
    v_mfma_f32_16x16x32_bf16 v[216:219], a[112:115], v[12:15], v[216:219]
    v_exp_f32 v35, v35
    v_mfma_f32_16x16x32_bf16 v[220:223], a[100:103], v[12:15], v[220:223]
    v_add_f32 v11, v11, v34
    v_cvt_pk_bf16_f32 v18, v32, v33
    v_mfma_f32_16x16x32_bf16 v[28:31], a[232:235], a[16:19], 0
    v_exp_f32 v20, v20
    v_mfma_f32_16x16x32_bf16 v[28:31], a[104:107], a[20:23], v[28:31]
    ds_read_b64_tr_b16 a[224:225], v1 offset:43664
    v_add_f32 v11, v11, v35
    v_mfma_f32_16x16x32_bf16 v[28:31], a[108:111], a[24:27], v[28:31]
    v_exp_f32 v21, v21
    v_mfma_f32_16x16x32_bf16 v[28:31], a[116:119], a[28:31], v[28:31]
    v_cvt_pk_bf16_f32 v19, v34, v35
    v_add_f32 v4, v4, v20
    v_mfma_f32_16x16x32_bf16 v[32:35], a[244:247], a[16:19], 0
    v_exp_f32 v22, v22
    v_mfma_f32_16x16x32_bf16 v[32:35], a[200:203], a[20:23], v[32:35]
    ds_read_b64_tr_b16 a[226:227], v1 offset:44176
    v_add_f32 v4, v4, v21
    v_mfma_f32_16x16x32_bf16 v[32:35], a[248:251], a[24:27], v[32:35]
    v_exp_f32 v23, v23
    v_mfma_f32_16x16x32_bf16 v[32:35], a[240:243], a[28:31], v[32:35]
    v_add_f32 v4, v4, v22
    v_cvt_pk_bf16_f32 v12, v20, v21
    v_mfma_f32_16x16x32_bf16 v[224:227], a[124:127], v[16:19], v[224:227]
    v_exp_f32 v24, v24
    v_mfma_f32_16x16x32_bf16 v[228:231], a[204:207], v[16:19], v[228:231]
    ds_read_b64_tr_b16 a[228:229], v1 offset:43672
    v_add_f32 v4, v4, v23
    v_mfma_f32_16x16x32_bf16 v[232:235], a[208:211], v[16:19], v[232:235]
    v_exp_f32 v25, v25
    v_mfma_f32_16x16x32_bf16 v[236:239], a[236:239], v[16:19], v[236:239]
    v_add_f32 v4, v4, v24
    v_cvt_pk_bf16_f32 v13, v22, v23
    v_mfma_f32_16x16x32_bf16 v[240:243], a[216:219], v[16:19], v[240:243]
    v_exp_f32 v26, v26
    v_mfma_f32_16x16x32_bf16 v[244:247], a[192:195], v[16:19], v[244:247]
    ds_read_b64_tr_b16 a[230:231], v1 offset:44184
    v_add_f32 v4, v4, v25
    v_mfma_f32_16x16x32_bf16 v[248:251], a[112:115], v[16:19], v[248:251]
    v_exp_f32 v27, v27
    v_mfma_f32_16x16x32_bf16 v[252:255], a[100:103], v[16:19], v[252:255]
    v_add_f32 v4, v4, v26
    v_cvt_pk_bf16_f32 v14, v24, v25
    v_mfma_f32_16x16x32_bf16 v[20:23], a[232:235], a[32:35], 0
    v_exp_f32 v28, v28
    v_mfma_f32_16x16x32_bf16 v[20:23], a[104:107], a[36:39], v[20:23]
    ds_read_b64_tr_b16 a[252:253], v1 offset:43728
    v_add_f32 v4, v4, v27
    v_mfma_f32_16x16x32_bf16 v[20:23], a[108:111], a[40:43], v[20:23]
    v_exp_f32 v29, v29
    v_mfma_f32_16x16x32_bf16 v[20:23], a[116:119], a[44:47], v[20:23]
    ds_read_b64_tr_b16 a[254:255], v1 offset:44240
    ds_read_b64_tr_b16 a[196:197], v1 offset:43736
    v_cvt_pk_bf16_f32 v15, v26, v27
    v_add_f32 v5, v5, v28
    v_mfma_f32_16x16x32_bf16 v[24:27], a[244:247], a[32:35], 0
    v_exp_f32 v30, v30
    v_mfma_f32_16x16x32_bf16 v[24:27], a[200:203], a[36:39], v[24:27]
    ds_read_b64_tr_b16 a[198:199], v1 offset:44248
    ds_read_b64_tr_b16 a[204:205], v1 offset:43792
    ds_read_b64_tr_b16 a[206:207], v1 offset:44304
    v_add_f32 v5, v5, v29
    v_mfma_f32_16x16x32_bf16 v[24:27], a[248:251], a[40:43], v[24:27]
    s_waitcnt lgkmcnt(6)
    v_exp_f32 v31, v31
    v_mfma_f32_16x16x32_bf16 v[24:27], a[240:243], a[44:47], v[24:27]
    ds_read_b64_tr_b16 a[216:217], v1 offset:43800
    ds_read_b64_tr_b16 a[218:219], v1 offset:44312
    v_add_f32 v5, v5, v30
    v_cvt_pk_bf16_f32 v16, v28, v29
    v_mfma_f32_16x16x32_bf16 v[64:67], a[120:123], v[12:15], v[64:67]
    s_add_u32 m0, s39, 67584
    s_mov_b32 s25, 65536
    v_exp_f32 v32, v32
    v_mfma_f32_16x16x32_bf16 v[68:71], a[220:223], v[12:15], v[68:71]
    buffer_load_dwordx4 v3, s[12:15], s25 offen nt lds
    v_add_f32 v5, v5, v31
    v_mfma_f32_16x16x32_bf16 v[72:75], a[224:227], v[12:15], v[72:75]
    v_exp_f32 v33, v33
    v_mfma_f32_16x16x32_bf16 v[76:79], a[228:231], v[12:15], v[76:79]
    s_waitcnt lgkmcnt(5)
    v_add_f32 v5, v5, v32
    v_cvt_pk_bf16_f32 v17, v30, v31
    v_mfma_f32_16x16x32_bf16 v[80:83], a[252:255], v[12:15], v[80:83]
    s_waitcnt lgkmcnt(2)
    s_add_u32 m0, s39, 70920
    v_exp_f32 v34, v34
    v_mfma_f32_16x16x32_bf16 v[84:87], a[196:199], v[12:15], v[84:87]
    buffer_load_dwordx4 v3, s[12:15], s25 offen offset:1024 nt lds
    v_add_f32 v5, v5, v33
    v_mfma_f32_16x16x32_bf16 v[88:91], a[204:207], v[12:15], v[88:91]
    s_waitcnt lgkmcnt(0)
    v_exp_f32 v35, v35
    v_mfma_f32_16x16x32_bf16 v[92:95], a[216:219], v[12:15], v[92:95]
    v_add_f32 v5, v5, v34
    v_cvt_pk_bf16_f32 v18, v32, v33
    v_mfma_f32_16x16x32_bf16 v[28:31], a[232:235], a[48:51], 0
    s_waitcnt vmcnt(8)
    s_barrier
    v_exp_f32 v20, v20
    v_mfma_f32_16x16x32_bf16 v[28:31], a[104:107], a[52:55], v[28:31]
    ds_read_b128 a[100:103], v0 offset:50688
    v_add_f32 v5, v5, v35
    v_mfma_f32_16x16x32_bf16 v[28:31], a[108:111], a[56:59], v[28:31]
    v_exp_f32 v21, v21
    v_mfma_f32_16x16x32_bf16 v[28:31], a[116:119], a[60:63], v[28:31]
    v_cvt_pk_bf16_f32 v19, v34, v35
    v_add_f32 v6, v6, v20
    v_mfma_f32_16x16x32_bf16 v[32:35], a[244:247], a[48:51], 0
    s_add_u32 m0, s21, 8448
    s_mov_b32 s20, 73728
    v_exp_f32 v22, v22
    v_mfma_f32_16x16x32_bf16 v[32:35], a[200:203], a[52:55], v[32:35]
    buffer_load_dwordx4 v2, s[8:11], s20 offen nt lds
    v_add_f32 v6, v6, v21
    v_mfma_f32_16x16x32_bf16 v[32:35], a[248:251], a[56:59], v[32:35]
    v_exp_f32 v23, v23
    v_mfma_f32_16x16x32_bf16 v[32:35], a[240:243], a[60:63], v[32:35]
    v_add_f32 v6, v6, v22
    v_cvt_pk_bf16_f32 v12, v20, v21
    v_mfma_f32_16x16x32_bf16 v[96:99], a[120:123], v[16:19], v[96:99]
    v_exp_f32 v24, v24
    v_mfma_f32_16x16x32_bf16 v[100:103], a[220:223], v[16:19], v[100:103]
    ds_read_b128 a[192:195], v0 offset:50816
    v_add_f32 v6, v6, v23
    v_mfma_f32_16x16x32_bf16 v[104:107], a[224:227], v[16:19], v[104:107]
    v_exp_f32 v25, v25
    v_mfma_f32_16x16x32_bf16 v[108:111], a[228:231], v[16:19], v[108:111]
    v_add_f32 v6, v6, v24
    v_cvt_pk_bf16_f32 v13, v22, v23
    v_mfma_f32_16x16x32_bf16 v[112:115], a[252:255], v[16:19], v[112:115]
    v_exp_f32 v26, v26
    v_mfma_f32_16x16x32_bf16 v[116:119], a[196:199], v[16:19], v[116:119]
    ds_read_b64_tr_b16 a[124:125], v1 offset:52320
    v_add_f32 v6, v6, v25
    v_mfma_f32_16x16x32_bf16 v[120:123], a[204:207], v[16:19], v[120:123]
    v_exp_f32 v27, v27
    v_mfma_f32_16x16x32_bf16 v[124:127], a[216:219], v[16:19], v[124:127]
    v_add_f32 v6, v6, v26
    v_cvt_pk_bf16_f32 v14, v24, v25
    v_mfma_f32_16x16x32_bf16 v[20:23], a[232:235], a[64:67], 0
    v_exp_f32 v28, v28
    v_mfma_f32_16x16x32_bf16 v[20:23], a[104:107], a[68:71], v[20:23]
    ds_read_b64_tr_b16 a[126:127], v1 offset:52832
    v_add_f32 v6, v6, v27
    v_mfma_f32_16x16x32_bf16 v[20:23], a[108:111], a[72:75], v[20:23]
    v_exp_f32 v29, v29
    v_mfma_f32_16x16x32_bf16 v[20:23], a[116:119], a[76:79], v[20:23]
    v_cvt_pk_bf16_f32 v15, v26, v27
    v_add_f32 v7, v7, v28
    v_mfma_f32_16x16x32_bf16 v[24:27], a[244:247], a[64:67], 0
    s_add_u32 m0, s21, 10624
    v_exp_f32 v30, v30
    v_mfma_f32_16x16x32_bf16 v[24:27], a[200:203], a[68:71], v[24:27]
    buffer_load_dwordx4 v2, s[8:11], s20 offen offset:2048 nt lds
    v_add_f32 v7, v7, v29
    v_mfma_f32_16x16x32_bf16 v[24:27], a[248:251], a[72:75], v[24:27]
    v_exp_f32 v31, v31
    v_mfma_f32_16x16x32_bf16 v[24:27], a[240:243], a[76:79], v[24:27]
    v_add_f32 v7, v7, v30
    v_cvt_pk_bf16_f32 v16, v28, v29
    v_mfma_f32_16x16x32_bf16 a[128:131], a[120:123], v[12:15], a[128:131]
    v_exp_f32 v32, v32
    v_mfma_f32_16x16x32_bf16 a[132:135], a[220:223], v[12:15], a[132:135]
    ds_read_b128 a[112:115], v0 offset:50880
    v_add_f32 v7, v7, v31
    v_mfma_f32_16x16x32_bf16 a[136:139], a[224:227], v[12:15], a[136:139]
    v_exp_f32 v33, v33
    v_mfma_f32_16x16x32_bf16 a[140:143], a[228:231], v[12:15], a[140:143]
    v_add_f32 v7, v7, v32
    v_cvt_pk_bf16_f32 v17, v30, v31
    v_mfma_f32_16x16x32_bf16 a[144:147], a[252:255], v[12:15], a[144:147]
    v_exp_f32 v34, v34
    v_mfma_f32_16x16x32_bf16 a[148:151], a[196:199], v[12:15], a[148:151]
    ds_read_b64_tr_b16 a[208:209], v1 offset:52384
    v_add_f32 v7, v7, v33
    v_mfma_f32_16x16x32_bf16 a[152:155], a[204:207], v[12:15], a[152:155]
    v_exp_f32 v35, v35
    v_mfma_f32_16x16x32_bf16 a[156:159], a[216:219], v[12:15], a[156:159]
    v_add_f32 v7, v7, v34
    v_cvt_pk_bf16_f32 v18, v32, v33
    v_mfma_f32_16x16x32_bf16 v[28:31], a[232:235], a[80:83], 0
    v_exp_f32 v20, v20
    v_mfma_f32_16x16x32_bf16 v[28:31], a[104:107], a[84:87], v[28:31]
    ds_read_b64_tr_b16 a[210:211], v1 offset:52896
    v_add_f32 v7, v7, v35
    v_mfma_f32_16x16x32_bf16 v[28:31], a[108:111], a[88:91], v[28:31]
    v_exp_f32 v21, v21
    v_mfma_f32_16x16x32_bf16 v[28:31], a[116:119], a[92:95], v[28:31]
    v_cvt_pk_bf16_f32 v19, v34, v35
    v_add_f32 v8, v8, v20
    v_mfma_f32_16x16x32_bf16 v[32:35], a[244:247], a[80:83], 0
    s_add_u32 m0, s39, 76304
    s_mov_b32 s25, 73728
    v_exp_f32 v22, v22
    v_mfma_f32_16x16x32_bf16 v[32:35], a[200:203], a[84:87], v[32:35]
    buffer_load_dwordx4 v3, s[12:15], s25 offen nt lds
    v_add_f32 v8, v8, v21
    v_mfma_f32_16x16x32_bf16 v[32:35], a[248:251], a[88:91], v[32:35]
    v_exp_f32 v23, v23
    v_mfma_f32_16x16x32_bf16 v[32:35], a[240:243], a[92:95], v[32:35]
    v_add_f32 v8, v8, v22
    v_cvt_pk_bf16_f32 v12, v20, v21
    v_mfma_f32_16x16x32_bf16 a[160:163], a[120:123], v[16:19], a[160:163]
    v_exp_f32 v24, v24
    v_mfma_f32_16x16x32_bf16 a[164:167], a[220:223], v[16:19], a[164:167]
    ds_read_b128 a[212:215], v0 offset:51200
    v_add_f32 v8, v8, v23
    v_mfma_f32_16x16x32_bf16 a[168:171], a[224:227], v[16:19], a[168:171]
    v_exp_f32 v25, v25
    v_mfma_f32_16x16x32_bf16 a[172:175], a[228:231], v[16:19], a[172:175]
    v_add_f32 v8, v8, v24
    v_cvt_pk_bf16_f32 v13, v22, v23
    v_mfma_f32_16x16x32_bf16 a[176:179], a[252:255], v[16:19], a[176:179]
    v_exp_f32 v26, v26
    v_mfma_f32_16x16x32_bf16 a[180:183], a[196:199], v[16:19], a[180:183]
    ds_read_b64_tr_b16 a[236:237], v1 offset:52392
    v_add_f32 v8, v8, v25
    v_mfma_f32_16x16x32_bf16 a[184:187], a[204:207], v[16:19], a[184:187]
    v_exp_f32 v27, v27
    v_mfma_f32_16x16x32_bf16 a[188:191], a[216:219], v[16:19], a[188:191]
    v_add_f32 v8, v8, v26
    v_cvt_pk_bf16_f32 v14, v24, v25
    v_mfma_f32_16x16x32_bf16 v[20:23], a[232:235], a[96:99], 0
    v_exp_f32 v28, v28
    v_mfma_f32_16x16x32_bf16 v[20:23], a[104:107], v[36:39], v[20:23]
    ds_read_b64_tr_b16 a[238:239], v1 offset:52904
    v_add_f32 v8, v8, v27
    v_mfma_f32_16x16x32_bf16 v[20:23], a[108:111], v[40:43], v[20:23]
    v_exp_f32 v29, v29
    v_mfma_f32_16x16x32_bf16 v[20:23], a[116:119], v[44:47], v[20:23]
    v_cvt_pk_bf16_f32 v15, v26, v27
    v_add_f32 v9, v9, v28
    v_mfma_f32_16x16x32_bf16 v[24:27], a[244:247], a[96:99], 0
    s_add_u32 m0, s39, 79640
    v_exp_f32 v30, v30
    v_mfma_f32_16x16x32_bf16 v[24:27], a[200:203], v[36:39], v[24:27]
    buffer_load_dwordx4 v3, s[12:15], s25 offen offset:1024 nt lds
    v_add_f32 v9, v9, v29
    v_mfma_f32_16x16x32_bf16 v[24:27], a[248:251], v[40:43], v[24:27]
    v_exp_f32 v31, v31
    v_mfma_f32_16x16x32_bf16 v[24:27], a[240:243], v[44:47], v[24:27]
    v_add_f32 v9, v9, v30
    v_cvt_pk_bf16_f32 v16, v28, v29
    v_mfma_f32_16x16x32_bf16 v[128:131], a[120:123], v[12:15], v[128:131]
    s_add_u32 m0, s21, 16896
    s_mov_b32 s20, 81920
    v_exp_f32 v32, v32
    v_mfma_f32_16x16x32_bf16 v[132:135], a[220:223], v[12:15], v[132:135]
    buffer_load_dwordx4 v2, s[8:11], s20 offen nt lds
    v_add_f32 v9, v9, v31
    v_mfma_f32_16x16x32_bf16 v[136:139], a[224:227], v[12:15], v[136:139]
    v_exp_f32 v33, v33
    v_mfma_f32_16x16x32_bf16 v[140:143], a[228:231], v[12:15], v[140:143]
    v_add_f32 v9, v9, v32
    v_cvt_pk_bf16_f32 v17, v30, v31
    v_mfma_f32_16x16x32_bf16 v[144:147], a[252:255], v[12:15], v[144:147]
    s_add_u32 m0, s21, 19072
    v_exp_f32 v34, v34
    v_mfma_f32_16x16x32_bf16 v[148:151], a[196:199], v[12:15], v[148:151]
    buffer_load_dwordx4 v2, s[8:11], s20 offen offset:2048 nt lds
    v_add_f32 v9, v9, v33
    v_mfma_f32_16x16x32_bf16 v[152:155], a[204:207], v[12:15], v[152:155]
    v_exp_f32 v35, v35
    v_mfma_f32_16x16x32_bf16 v[156:159], a[216:219], v[12:15], v[156:159]
    v_add_f32 v9, v9, v34
    v_cvt_pk_bf16_f32 v18, v32, v33
    v_mfma_f32_16x16x32_bf16 v[28:31], a[232:235], v[48:51], 0
    v_exp_f32 v20, v20
    v_mfma_f32_16x16x32_bf16 v[28:31], a[104:107], v[52:55], v[28:31]
    ds_read_b128 a[104:107], v0 offset:50752
    v_add_f32 v9, v9, v35
    v_mfma_f32_16x16x32_bf16 v[28:31], a[108:111], v[56:59], v[28:31]
    v_exp_f32 v21, v21
    v_mfma_f32_16x16x32_bf16 v[28:31], a[116:119], v[60:63], v[28:31]
    v_cvt_pk_bf16_f32 v19, v34, v35
    v_add_f32 v10, v10, v20
    v_mfma_f32_16x16x32_bf16 v[32:35], a[244:247], v[48:51], 0
    v_exp_f32 v22, v22
    v_mfma_f32_16x16x32_bf16 v[32:35], a[200:203], v[52:55], v[32:35]
    ds_read_b128 a[200:203], v0 offset:51264
    v_add_f32 v10, v10, v21
    v_mfma_f32_16x16x32_bf16 v[32:35], a[248:251], v[56:59], v[32:35]
    v_exp_f32 v23, v23
    v_mfma_f32_16x16x32_bf16 v[32:35], a[240:243], v[60:63], v[32:35]
    v_add_f32 v10, v10, v22
    v_cvt_pk_bf16_f32 v12, v20, v21
    v_mfma_f32_16x16x32_bf16 v[160:163], a[120:123], v[16:19], v[160:163]
    v_exp_f32 v24, v24
    v_mfma_f32_16x16x32_bf16 v[164:167], a[220:223], v[16:19], v[164:167]
    ds_read_b128 a[108:111], v0 offset:51328
    v_add_f32 v10, v10, v23
    v_mfma_f32_16x16x32_bf16 v[168:171], a[224:227], v[16:19], v[168:171]
    v_exp_f32 v25, v25
    v_mfma_f32_16x16x32_bf16 v[172:175], a[228:231], v[16:19], v[172:175]
    v_add_f32 v10, v10, v24
    v_cvt_pk_bf16_f32 v13, v22, v23
    v_mfma_f32_16x16x32_bf16 v[176:179], a[252:255], v[16:19], v[176:179]
    v_exp_f32 v26, v26
    v_mfma_f32_16x16x32_bf16 v[180:183], a[196:199], v[16:19], v[180:183]
    ds_read_b128 a[116:119], v0 offset:51392
    v_add_f32 v10, v10, v25
    v_mfma_f32_16x16x32_bf16 v[184:187], a[204:207], v[16:19], v[184:187]
    v_exp_f32 v27, v27
    v_mfma_f32_16x16x32_bf16 v[188:191], a[216:219], v[16:19], v[188:191]
    s_waitcnt lgkmcnt(2)
    v_add_f32 v10, v10, v26
    v_cvt_pk_bf16_f32 v14, v24, v25
    v_mfma_f32_16x16x32_bf16 v[20:23], a[100:103], a[0:3], 0
    v_exp_f32 v28, v28
    v_mfma_f32_16x16x32_bf16 v[20:23], a[104:107], a[4:7], v[20:23]
    ds_read_b64_tr_b16 a[232:233], v1 offset:52448
    v_add_f32 v10, v10, v27
    v_mfma_f32_16x16x32_bf16 v[20:23], a[192:195], a[8:11], v[20:23]
    v_exp_f32 v29, v29
    v_mfma_f32_16x16x32_bf16 v[20:23], a[112:115], a[12:15], v[20:23]
    v_cvt_pk_bf16_f32 v15, v26, v27
    v_add_f32 v11, v11, v28
    v_mfma_f32_16x16x32_bf16 v[24:27], a[212:215], a[0:3], 0
    s_waitcnt lgkmcnt(2)
    v_exp_f32 v30, v30
    v_mfma_f32_16x16x32_bf16 v[24:27], a[200:203], a[4:7], v[24:27]
    ds_read_b64_tr_b16 a[234:235], v1 offset:52960
    v_add_f32 v11, v11, v29
    v_mfma_f32_16x16x32_bf16 v[24:27], a[108:111], a[8:11], v[24:27]
    s_waitcnt lgkmcnt(2)
    v_exp_f32 v31, v31
    v_mfma_f32_16x16x32_bf16 v[24:27], a[116:119], a[12:15], v[24:27]
    v_add_f32 v11, v11, v30
    v_cvt_pk_bf16_f32 v16, v28, v29
    v_mfma_f32_16x16x32_bf16 v[192:195], a[120:123], v[12:15], v[192:195]
    v_exp_f32 v32, v32
    v_mfma_f32_16x16x32_bf16 v[196:199], a[220:223], v[12:15], v[196:199]
    ds_read_b64_tr_b16 a[248:249], v1 offset:52456
    v_add_f32 v11, v11, v31
    v_mfma_f32_16x16x32_bf16 v[200:203], a[224:227], v[12:15], v[200:203]
    v_exp_f32 v33, v33
    v_mfma_f32_16x16x32_bf16 v[204:207], a[228:231], v[12:15], v[204:207]
    v_add_f32 v11, v11, v32
    v_cvt_pk_bf16_f32 v17, v30, v31
    v_mfma_f32_16x16x32_bf16 v[208:211], a[252:255], v[12:15], v[208:211]
    v_exp_f32 v34, v34
    v_mfma_f32_16x16x32_bf16 v[212:215], a[196:199], v[12:15], v[212:215]
    ds_read_b64_tr_b16 a[250:251], v1 offset:52968
    v_add_f32 v11, v11, v33
    v_mfma_f32_16x16x32_bf16 v[216:219], a[204:207], v[12:15], v[216:219]
    v_exp_f32 v35, v35
    v_mfma_f32_16x16x32_bf16 v[220:223], a[216:219], v[12:15], v[220:223]
    v_add_f32 v11, v11, v34
    v_cvt_pk_bf16_f32 v18, v32, v33
    v_mfma_f32_16x16x32_bf16 v[28:31], a[100:103], a[16:19], 0
    v_exp_f32 v20, v20
    v_mfma_f32_16x16x32_bf16 v[28:31], a[104:107], a[20:23], v[28:31]
    ds_read_b64_tr_b16 a[240:241], v1 offset:52512
    v_add_f32 v11, v11, v35
    v_mfma_f32_16x16x32_bf16 v[28:31], a[192:195], a[24:27], v[28:31]
    v_exp_f32 v21, v21
    v_mfma_f32_16x16x32_bf16 v[28:31], a[112:115], a[28:31], v[28:31]
    v_cvt_pk_bf16_f32 v19, v34, v35
    v_add_f32 v4, v4, v20
    v_mfma_f32_16x16x32_bf16 v[32:35], a[212:215], a[16:19], 0
    v_exp_f32 v22, v22
    v_mfma_f32_16x16x32_bf16 v[32:35], a[200:203], a[20:23], v[32:35]
    ds_read_b64_tr_b16 a[242:243], v1 offset:53024
    v_add_f32 v4, v4, v21
    v_mfma_f32_16x16x32_bf16 v[32:35], a[108:111], a[24:27], v[32:35]
    v_exp_f32 v23, v23
    v_mfma_f32_16x16x32_bf16 v[32:35], a[116:119], a[28:31], v[32:35]
    v_add_f32 v4, v4, v22
    v_cvt_pk_bf16_f32 v12, v20, v21
    v_mfma_f32_16x16x32_bf16 v[224:227], a[120:123], v[16:19], v[224:227]
    v_exp_f32 v24, v24
    v_mfma_f32_16x16x32_bf16 v[228:231], a[220:223], v[16:19], v[228:231]
    ds_read_b64_tr_b16 a[220:221], v1 offset:52328
    v_add_f32 v4, v4, v23
    v_mfma_f32_16x16x32_bf16 v[232:235], a[224:227], v[16:19], v[232:235]
    v_exp_f32 v25, v25
    v_mfma_f32_16x16x32_bf16 v[236:239], a[228:231], v[16:19], v[236:239]
    v_add_f32 v4, v4, v24
    v_cvt_pk_bf16_f32 v13, v22, v23
    v_mfma_f32_16x16x32_bf16 v[240:243], a[252:255], v[16:19], v[240:243]
    v_exp_f32 v26, v26
    v_mfma_f32_16x16x32_bf16 v[244:247], a[196:199], v[16:19], v[244:247]
    ds_read_b64_tr_b16 a[222:223], v1 offset:52840
    v_add_f32 v4, v4, v25
    v_mfma_f32_16x16x32_bf16 v[248:251], a[204:207], v[16:19], v[248:251]
    v_exp_f32 v27, v27
    v_mfma_f32_16x16x32_bf16 v[252:255], a[216:219], v[16:19], v[252:255]
    v_add_f32 v4, v4, v26
    v_cvt_pk_bf16_f32 v14, v24, v25
    v_mfma_f32_16x16x32_bf16 v[20:23], a[100:103], a[32:35], 0
    v_exp_f32 v28, v28
    v_mfma_f32_16x16x32_bf16 v[20:23], a[104:107], a[36:39], v[20:23]
    ds_read_b64_tr_b16 a[252:253], v1 offset:52520
    v_add_f32 v4, v4, v27
    v_mfma_f32_16x16x32_bf16 v[20:23], a[192:195], a[40:43], v[20:23]
    v_exp_f32 v29, v29
    v_mfma_f32_16x16x32_bf16 v[20:23], a[112:115], a[44:47], v[20:23]
    v_cvt_pk_bf16_f32 v15, v26, v27
    v_add_f32 v5, v5, v28
    v_mfma_f32_16x16x32_bf16 v[24:27], a[212:215], a[32:35], 0
    v_exp_f32 v30, v30
    v_mfma_f32_16x16x32_bf16 v[24:27], a[200:203], a[36:39], v[24:27]
    ds_read_b64_tr_b16 a[254:255], v1 offset:53032
    v_add_f32 v5, v5, v29
    v_mfma_f32_16x16x32_bf16 v[24:27], a[108:111], a[40:43], v[24:27]
    v_exp_f32 v31, v31
    v_mfma_f32_16x16x32_bf16 v[24:27], a[116:119], a[44:47], v[24:27]
    v_add_f32 v5, v5, v30
    v_cvt_pk_bf16_f32 v16, v28, v29
    v_mfma_f32_16x16x32_bf16 v[64:67], a[124:127], v[12:15], v[64:67]
    s_waitcnt lgkmcnt(2)
    s_add_u32 m0, s39, 85024
    s_mov_b32 s25, 81920
    v_exp_f32 v32, v32
    v_mfma_f32_16x16x32_bf16 v[68:71], a[220:223], v[12:15], v[68:71]
    buffer_load_dwordx4 v3, s[12:15], s25 offen nt lds
    v_add_f32 v5, v5, v31
    v_mfma_f32_16x16x32_bf16 v[72:75], a[208:211], v[12:15], v[72:75]
    v_exp_f32 v33, v33
    v_mfma_f32_16x16x32_bf16 v[76:79], a[236:239], v[12:15], v[76:79]
    v_add_f32 v5, v5, v32
    v_cvt_pk_bf16_f32 v17, v30, v31
    v_mfma_f32_16x16x32_bf16 v[80:83], a[232:235], v[12:15], v[80:83]
    s_add_u32 m0, s39, 88360
    v_exp_f32 v34, v34
    v_mfma_f32_16x16x32_bf16 v[84:87], a[248:251], v[12:15], v[84:87]
    buffer_load_dwordx4 v3, s[12:15], s25 offen offset:1024 nt lds
    v_add_f32 v5, v5, v33
    v_mfma_f32_16x16x32_bf16 v[88:91], a[240:243], v[12:15], v[88:91]
    s_waitcnt lgkmcnt(0)
    v_exp_f32 v35, v35
    v_mfma_f32_16x16x32_bf16 v[92:95], a[252:255], v[12:15], v[92:95]
    v_add_f32 v5, v5, v34
    v_cvt_pk_bf16_f32 v18, v32, v33
    v_mfma_f32_16x16x32_bf16 v[28:31], a[100:103], a[48:51], 0
    s_waitcnt vmcnt(10)
    s_barrier
    v_exp_f32 v20, v20
    v_mfma_f32_16x16x32_bf16 v[28:31], a[104:107], a[52:55], v[28:31]
    ds_read_b128 a[216:219], v0 offset:59136
    v_add_f32 v5, v5, v35
    v_mfma_f32_16x16x32_bf16 v[28:31], a[192:195], a[56:59], v[28:31]
    v_exp_f32 v21, v21
    v_mfma_f32_16x16x32_bf16 v[28:31], a[112:115], a[60:63], v[28:31]
    v_cvt_pk_bf16_f32 v19, v34, v35
    v_add_f32 v6, v6, v20
    v_mfma_f32_16x16x32_bf16 v[32:35], a[212:215], a[48:51], 0
    s_add_u32 m0, s21, 25344
    s_mov_b32 s20, 90112
    v_exp_f32 v22, v22
    v_mfma_f32_16x16x32_bf16 v[32:35], a[200:203], a[52:55], v[32:35]
    buffer_load_dwordx4 v2, s[8:11], s20 offen nt lds
    v_add_f32 v6, v6, v21
    v_mfma_f32_16x16x32_bf16 v[32:35], a[108:111], a[56:59], v[32:35]
    v_exp_f32 v23, v23
    v_mfma_f32_16x16x32_bf16 v[32:35], a[116:119], a[60:63], v[32:35]
    v_add_f32 v6, v6, v22
    v_cvt_pk_bf16_f32 v12, v20, v21
    v_mfma_f32_16x16x32_bf16 v[96:99], a[124:127], v[16:19], v[96:99]
    v_exp_f32 v24, v24
    v_mfma_f32_16x16x32_bf16 v[100:103], a[220:223], v[16:19], v[100:103]
    ds_read_b128 a[196:199], v0 offset:59264
    v_add_f32 v6, v6, v23
    v_mfma_f32_16x16x32_bf16 v[104:107], a[208:211], v[16:19], v[104:107]
    v_exp_f32 v25, v25
    v_mfma_f32_16x16x32_bf16 v[108:111], a[236:239], v[16:19], v[108:111]
    v_add_f32 v6, v6, v24
    v_cvt_pk_bf16_f32 v13, v22, v23
    v_mfma_f32_16x16x32_bf16 v[112:115], a[232:235], v[16:19], v[112:115]
    v_exp_f32 v26, v26
    v_mfma_f32_16x16x32_bf16 v[116:119], a[248:251], v[16:19], v[116:119]
    ds_read_b64_tr_b16 a[120:121], v1 offset:61040
    v_add_f32 v6, v6, v25
    v_mfma_f32_16x16x32_bf16 v[120:123], a[240:243], v[16:19], v[120:123]
    v_exp_f32 v27, v27
    v_mfma_f32_16x16x32_bf16 v[124:127], a[252:255], v[16:19], v[124:127]
    v_add_f32 v6, v6, v26
    v_cvt_pk_bf16_f32 v14, v24, v25
    v_mfma_f32_16x16x32_bf16 v[20:23], a[100:103], a[64:67], 0
    v_exp_f32 v28, v28
    v_mfma_f32_16x16x32_bf16 v[20:23], a[104:107], a[68:71], v[20:23]
    ds_read_b64_tr_b16 a[122:123], v1 offset:61552
    v_add_f32 v6, v6, v27
    v_mfma_f32_16x16x32_bf16 v[20:23], a[192:195], a[72:75], v[20:23]
    v_exp_f32 v29, v29
    v_mfma_f32_16x16x32_bf16 v[20:23], a[112:115], a[76:79], v[20:23]
    v_cvt_pk_bf16_f32 v15, v26, v27
    v_add_f32 v7, v7, v28
    v_mfma_f32_16x16x32_bf16 v[24:27], a[212:215], a[64:67], 0
    s_add_u32 m0, s21, 27520
    v_exp_f32 v30, v30
    v_mfma_f32_16x16x32_bf16 v[24:27], a[200:203], a[68:71], v[24:27]
    buffer_load_dwordx4 v2, s[8:11], s20 offen offset:2048 nt lds
    v_add_f32 v7, v7, v29
    v_mfma_f32_16x16x32_bf16 v[24:27], a[108:111], a[72:75], v[24:27]
    v_exp_f32 v31, v31
    v_mfma_f32_16x16x32_bf16 v[24:27], a[116:119], a[76:79], v[24:27]
    v_add_f32 v7, v7, v30
    v_cvt_pk_bf16_f32 v16, v28, v29
    v_mfma_f32_16x16x32_bf16 a[128:131], a[124:127], v[12:15], a[128:131]
    v_exp_f32 v32, v32
    v_mfma_f32_16x16x32_bf16 a[132:135], a[220:223], v[12:15], a[132:135]
    ds_read_b128 a[204:207], v0 offset:59328
    v_add_f32 v7, v7, v31
    v_mfma_f32_16x16x32_bf16 a[136:139], a[208:211], v[12:15], a[136:139]
    v_exp_f32 v33, v33
    v_mfma_f32_16x16x32_bf16 a[140:143], a[236:239], v[12:15], a[140:143]
    v_add_f32 v7, v7, v32
    v_cvt_pk_bf16_f32 v17, v30, v31
    v_mfma_f32_16x16x32_bf16 a[144:147], a[232:235], v[12:15], a[144:147]
    v_exp_f32 v34, v34
    v_mfma_f32_16x16x32_bf16 a[148:151], a[248:251], v[12:15], a[148:151]
    ds_read_b64_tr_b16 a[224:225], v1 offset:61104
    v_add_f32 v7, v7, v33
    v_mfma_f32_16x16x32_bf16 a[152:155], a[240:243], v[12:15], a[152:155]
    v_exp_f32 v35, v35
    v_mfma_f32_16x16x32_bf16 a[156:159], a[252:255], v[12:15], a[156:159]
    v_add_f32 v7, v7, v34
    v_cvt_pk_bf16_f32 v18, v32, v33
    v_mfma_f32_16x16x32_bf16 v[28:31], a[100:103], a[80:83], 0
    v_exp_f32 v20, v20
    v_mfma_f32_16x16x32_bf16 v[28:31], a[104:107], a[84:87], v[28:31]
    ds_read_b64_tr_b16 a[226:227], v1 offset:61616
    v_add_f32 v7, v7, v35
    v_mfma_f32_16x16x32_bf16 v[28:31], a[192:195], a[88:91], v[28:31]
    v_exp_f32 v21, v21
    v_mfma_f32_16x16x32_bf16 v[28:31], a[112:115], a[92:95], v[28:31]
    v_cvt_pk_bf16_f32 v19, v34, v35
    v_add_f32 v8, v8, v20
    v_mfma_f32_16x16x32_bf16 v[32:35], a[212:215], a[80:83], 0
    s_add_u32 m0, s39, 93744
    s_mov_b32 s25, 90112
    v_exp_f32 v22, v22
    v_mfma_f32_16x16x32_bf16 v[32:35], a[200:203], a[84:87], v[32:35]
    buffer_load_dwordx4 v3, s[12:15], s25 offen nt lds
    v_add_f32 v8, v8, v21
    v_mfma_f32_16x16x32_bf16 v[32:35], a[108:111], a[88:91], v[32:35]
    v_exp_f32 v23, v23
    v_mfma_f32_16x16x32_bf16 v[32:35], a[116:119], a[92:95], v[32:35]
    v_add_f32 v8, v8, v22
    v_cvt_pk_bf16_f32 v12, v20, v21
    v_mfma_f32_16x16x32_bf16 a[160:163], a[124:127], v[16:19], a[160:163]
    v_exp_f32 v24, v24
    v_mfma_f32_16x16x32_bf16 a[164:167], a[220:223], v[16:19], a[164:167]
    ds_read_b128 a[244:247], v0 offset:59648
    v_add_f32 v8, v8, v23
    v_mfma_f32_16x16x32_bf16 a[168:171], a[208:211], v[16:19], a[168:171]
    v_exp_f32 v25, v25
    v_mfma_f32_16x16x32_bf16 a[172:175], a[236:239], v[16:19], a[172:175]
    v_add_f32 v8, v8, v24
    v_cvt_pk_bf16_f32 v13, v22, v23
    v_mfma_f32_16x16x32_bf16 a[176:179], a[232:235], v[16:19], a[176:179]
    v_exp_f32 v26, v26
    v_mfma_f32_16x16x32_bf16 a[180:183], a[248:251], v[16:19], a[180:183]
    ds_read_b64_tr_b16 a[228:229], v1 offset:61112
    v_add_f32 v8, v8, v25
    v_mfma_f32_16x16x32_bf16 a[184:187], a[240:243], v[16:19], a[184:187]
    v_exp_f32 v27, v27
    v_mfma_f32_16x16x32_bf16 a[188:191], a[252:255], v[16:19], a[188:191]
    v_add_f32 v8, v8, v26
    v_cvt_pk_bf16_f32 v14, v24, v25
    v_mfma_f32_16x16x32_bf16 v[20:23], a[100:103], a[96:99], 0
    v_exp_f32 v28, v28
    v_mfma_f32_16x16x32_bf16 v[20:23], a[104:107], v[36:39], v[20:23]
    ds_read_b64_tr_b16 a[230:231], v1 offset:61624
    v_add_f32 v8, v8, v27
    v_mfma_f32_16x16x32_bf16 v[20:23], a[192:195], v[40:43], v[20:23]
    v_exp_f32 v29, v29
    v_mfma_f32_16x16x32_bf16 v[20:23], a[112:115], v[44:47], v[20:23]
    v_cvt_pk_bf16_f32 v15, v26, v27
    v_add_f32 v9, v9, v28
    v_mfma_f32_16x16x32_bf16 v[24:27], a[212:215], a[96:99], 0
    s_add_u32 m0, s39, 97080
    v_exp_f32 v30, v30
    v_mfma_f32_16x16x32_bf16 v[24:27], a[200:203], v[36:39], v[24:27]
    buffer_load_dwordx4 v3, s[12:15], s25 offen offset:1024 nt lds
    v_add_f32 v9, v9, v29
    v_mfma_f32_16x16x32_bf16 v[24:27], a[108:111], v[40:43], v[24:27]
    v_exp_f32 v31, v31
    v_mfma_f32_16x16x32_bf16 v[24:27], a[116:119], v[44:47], v[24:27]
    v_add_f32 v9, v9, v30
    v_cvt_pk_bf16_f32 v16, v28, v29
    v_mfma_f32_16x16x32_bf16 v[128:131], a[124:127], v[12:15], v[128:131]
    v_exp_f32 v32, v32
    v_mfma_f32_16x16x32_bf16 v[132:135], a[220:223], v[12:15], v[132:135]
    v_add_f32 v9, v9, v31
    v_mfma_f32_16x16x32_bf16 v[136:139], a[208:211], v[12:15], v[136:139]
    v_exp_f32 v33, v33
    v_mfma_f32_16x16x32_bf16 v[140:143], a[236:239], v[12:15], v[140:143]
    v_add_f32 v9, v9, v32
    v_cvt_pk_bf16_f32 v17, v30, v31
    v_mfma_f32_16x16x32_bf16 v[144:147], a[232:235], v[12:15], v[144:147]
    v_exp_f32 v34, v34
    v_mfma_f32_16x16x32_bf16 v[148:151], a[248:251], v[12:15], v[148:151]
    v_add_f32 v9, v9, v33
    v_mfma_f32_16x16x32_bf16 v[152:155], a[240:243], v[12:15], v[152:155]
    v_exp_f32 v35, v35
    v_mfma_f32_16x16x32_bf16 v[156:159], a[252:255], v[12:15], v[156:159]
    v_add_f32 v9, v9, v34
    v_cvt_pk_bf16_f32 v18, v32, v33
    v_mfma_f32_16x16x32_bf16 v[28:31], a[100:103], v[48:51], 0
    v_exp_f32 v20, v20
    v_mfma_f32_16x16x32_bf16 v[28:31], a[104:107], v[52:55], v[28:31]
    ds_read_b128 a[104:107], v0 offset:59200
    v_add_f32 v9, v9, v35
    v_mfma_f32_16x16x32_bf16 v[28:31], a[192:195], v[56:59], v[28:31]
    v_exp_f32 v21, v21
    v_mfma_f32_16x16x32_bf16 v[28:31], a[112:115], v[60:63], v[28:31]
    v_cvt_pk_bf16_f32 v19, v34, v35
    v_add_f32 v10, v10, v20
    v_mfma_f32_16x16x32_bf16 v[32:35], a[212:215], v[48:51], 0
    v_exp_f32 v22, v22
    v_mfma_f32_16x16x32_bf16 v[32:35], a[200:203], v[52:55], v[32:35]
    ds_read_b128 a[200:203], v0 offset:59712
    v_add_f32 v10, v10, v21
    v_mfma_f32_16x16x32_bf16 v[32:35], a[108:111], v[56:59], v[32:35]
    v_exp_f32 v23, v23
    v_mfma_f32_16x16x32_bf16 v[32:35], a[116:119], v[60:63], v[32:35]
    v_add_f32 v10, v10, v22
    v_cvt_pk_bf16_f32 v12, v20, v21
    v_mfma_f32_16x16x32_bf16 v[160:163], a[124:127], v[16:19], v[160:163]
    v_exp_f32 v24, v24
    v_mfma_f32_16x16x32_bf16 v[164:167], a[220:223], v[16:19], v[164:167]
    ds_read_b128 a[192:195], v0 offset:59776
    v_add_f32 v10, v10, v23
    v_mfma_f32_16x16x32_bf16 v[168:171], a[208:211], v[16:19], v[168:171]
    v_exp_f32 v25, v25
    v_mfma_f32_16x16x32_bf16 v[172:175], a[236:239], v[16:19], v[172:175]
    v_add_f32 v10, v10, v24
    v_cvt_pk_bf16_f32 v13, v22, v23
    v_mfma_f32_16x16x32_bf16 v[176:179], a[232:235], v[16:19], v[176:179]
    v_exp_f32 v26, v26
    v_mfma_f32_16x16x32_bf16 v[180:183], a[248:251], v[16:19], v[180:183]
    ds_read_b128 a[112:115], v0 offset:59840
    v_add_f32 v10, v10, v25
    v_mfma_f32_16x16x32_bf16 v[184:187], a[240:243], v[16:19], v[184:187]
    v_exp_f32 v27, v27
    v_mfma_f32_16x16x32_bf16 v[188:191], a[252:255], v[16:19], v[188:191]
    s_waitcnt lgkmcnt(2)
    v_add_f32 v10, v10, v26
    v_cvt_pk_bf16_f32 v14, v24, v25
    v_mfma_f32_16x16x32_bf16 v[20:23], a[216:219], a[0:3], 0
    v_exp_f32 v28, v28
    v_mfma_f32_16x16x32_bf16 v[20:23], a[104:107], a[4:7], v[20:23]
    ds_read_b64_tr_b16 a[100:101], v1 offset:61168
    v_add_f32 v10, v10, v27
    v_mfma_f32_16x16x32_bf16 v[20:23], a[196:199], a[8:11], v[20:23]
    v_exp_f32 v29, v29
    v_mfma_f32_16x16x32_bf16 v[20:23], a[204:207], a[12:15], v[20:23]
    v_cvt_pk_bf16_f32 v15, v26, v27
    v_add_f32 v11, v11, v28
    v_mfma_f32_16x16x32_bf16 v[24:27], a[244:247], a[0:3], 0
    s_waitcnt lgkmcnt(2)
    v_exp_f32 v30, v30
    v_mfma_f32_16x16x32_bf16 v[24:27], a[200:203], a[4:7], v[24:27]
    ds_read_b64_tr_b16 a[102:103], v1 offset:61680
    v_add_f32 v11, v11, v29
    v_mfma_f32_16x16x32_bf16 v[24:27], a[192:195], a[8:11], v[24:27]
    s_waitcnt lgkmcnt(2)
    v_exp_f32 v31, v31
    v_mfma_f32_16x16x32_bf16 v[24:27], a[112:115], a[12:15], v[24:27]
    v_add_f32 v11, v11, v30
    v_cvt_pk_bf16_f32 v16, v28, v29
    v_mfma_f32_16x16x32_bf16 v[192:195], a[124:127], v[12:15], v[192:195]
    v_exp_f32 v32, v32
    v_mfma_f32_16x16x32_bf16 v[196:199], a[220:223], v[12:15], v[196:199]
    ds_read_b64_tr_b16 a[108:109], v1 offset:61176
    v_add_f32 v11, v11, v31
    v_mfma_f32_16x16x32_bf16 v[200:203], a[208:211], v[12:15], v[200:203]
    v_exp_f32 v33, v33
    v_mfma_f32_16x16x32_bf16 v[204:207], a[236:239], v[12:15], v[204:207]
    v_add_f32 v11, v11, v32
    v_cvt_pk_bf16_f32 v17, v30, v31
    v_mfma_f32_16x16x32_bf16 v[208:211], a[232:235], v[12:15], v[208:211]
    v_exp_f32 v34, v34
    v_mfma_f32_16x16x32_bf16 v[212:215], a[248:251], v[12:15], v[212:215]
    ds_read_b64_tr_b16 a[110:111], v1 offset:61688
    v_add_f32 v11, v11, v33
    v_mfma_f32_16x16x32_bf16 v[216:219], a[240:243], v[12:15], v[216:219]
    v_exp_f32 v35, v35
    v_mfma_f32_16x16x32_bf16 v[220:223], a[252:255], v[12:15], v[220:223]
    v_add_f32 v11, v11, v34
    v_cvt_pk_bf16_f32 v18, v32, v33
    v_mfma_f32_16x16x32_bf16 v[28:31], a[216:219], a[16:19], 0
    v_exp_f32 v20, v20
    v_mfma_f32_16x16x32_bf16 v[28:31], a[104:107], a[20:23], v[28:31]
    ds_read_b64_tr_b16 a[116:117], v1 offset:61232
    v_add_f32 v11, v11, v35
    v_mfma_f32_16x16x32_bf16 v[28:31], a[196:199], a[24:27], v[28:31]
    v_exp_f32 v21, v21
    v_mfma_f32_16x16x32_bf16 v[28:31], a[204:207], a[28:31], v[28:31]
    v_cvt_pk_bf16_f32 v19, v34, v35
    v_add_f32 v4, v4, v20
    v_mfma_f32_16x16x32_bf16 v[32:35], a[244:247], a[16:19], 0
    v_exp_f32 v22, v22
    v_mfma_f32_16x16x32_bf16 v[32:35], a[200:203], a[20:23], v[32:35]
    ds_read_b64_tr_b16 a[118:119], v1 offset:61744
    v_add_f32 v4, v4, v21
    v_mfma_f32_16x16x32_bf16 v[32:35], a[192:195], a[24:27], v[32:35]
    v_exp_f32 v23, v23
    v_mfma_f32_16x16x32_bf16 v[32:35], a[112:115], a[28:31], v[32:35]
    v_add_f32 v4, v4, v22
    v_cvt_pk_bf16_f32 v12, v20, v21
    v_mfma_f32_16x16x32_bf16 v[224:227], a[124:127], v[16:19], v[224:227]
    v_exp_f32 v24, v24
    v_mfma_f32_16x16x32_bf16 v[228:231], a[220:223], v[16:19], v[228:231]
    ds_read_b64_tr_b16 a[220:221], v1 offset:61048
    v_add_f32 v4, v4, v23
    v_mfma_f32_16x16x32_bf16 v[232:235], a[208:211], v[16:19], v[232:235]
    v_exp_f32 v25, v25
    v_mfma_f32_16x16x32_bf16 v[236:239], a[236:239], v[16:19], v[236:239]
    v_add_f32 v4, v4, v24
    v_cvt_pk_bf16_f32 v13, v22, v23
    v_mfma_f32_16x16x32_bf16 v[240:243], a[232:235], v[16:19], v[240:243]
    v_exp_f32 v26, v26
    v_mfma_f32_16x16x32_bf16 v[244:247], a[248:251], v[16:19], v[244:247]
    ds_read_b64_tr_b16 a[222:223], v1 offset:61560
    v_add_f32 v4, v4, v25
    v_mfma_f32_16x16x32_bf16 v[248:251], a[240:243], v[16:19], v[248:251]
    v_exp_f32 v27, v27
    v_mfma_f32_16x16x32_bf16 v[252:255], a[252:255], v[16:19], v[252:255]
    v_add_f32 v4, v4, v26
    v_cvt_pk_bf16_f32 v14, v24, v25
    v_mfma_f32_16x16x32_bf16 v[20:23], a[216:219], a[32:35], 0
    v_exp_f32 v28, v28
    v_mfma_f32_16x16x32_bf16 v[20:23], a[104:107], a[36:39], v[20:23]
    ds_read_b64_tr_b16 a[232:233], v1 offset:61240
    v_add_f32 v4, v4, v27
    v_mfma_f32_16x16x32_bf16 v[20:23], a[196:199], a[40:43], v[20:23]
    v_exp_f32 v29, v29
    v_mfma_f32_16x16x32_bf16 v[20:23], a[204:207], a[44:47], v[20:23]
    v_cvt_pk_bf16_f32 v15, v26, v27
    v_add_f32 v5, v5, v28
    v_mfma_f32_16x16x32_bf16 v[24:27], a[244:247], a[32:35], 0
    v_exp_f32 v30, v30
    v_mfma_f32_16x16x32_bf16 v[24:27], a[200:203], a[36:39], v[24:27]
    ds_read_b64_tr_b16 a[234:235], v1 offset:61752
    v_add_f32 v5, v5, v29
    v_mfma_f32_16x16x32_bf16 v[24:27], a[192:195], a[40:43], v[24:27]
    v_exp_f32 v31, v31
    v_mfma_f32_16x16x32_bf16 v[24:27], a[112:115], a[44:47], v[24:27]
    v_add_f32 v5, v5, v30
    v_cvt_pk_bf16_f32 v16, v28, v29
    v_mfma_f32_16x16x32_bf16 v[64:67], a[120:123], v[12:15], v[64:67]
    s_waitcnt lgkmcnt(2)
    v_exp_f32 v32, v32
    v_mfma_f32_16x16x32_bf16 v[68:71], a[220:223], v[12:15], v[68:71]
    v_add_f32 v5, v5, v31
    v_mfma_f32_16x16x32_bf16 v[72:75], a[224:227], v[12:15], v[72:75]
    v_exp_f32 v33, v33
    v_mfma_f32_16x16x32_bf16 v[76:79], a[228:231], v[12:15], v[76:79]
    v_add_f32 v5, v5, v32
    v_cvt_pk_bf16_f32 v17, v30, v31
    v_mfma_f32_16x16x32_bf16 v[80:83], a[100:103], v[12:15], v[80:83]
    v_exp_f32 v34, v34
    v_mfma_f32_16x16x32_bf16 v[84:87], a[108:111], v[12:15], v[84:87]
    v_add_f32 v5, v5, v33
    v_mfma_f32_16x16x32_bf16 v[88:91], a[116:119], v[12:15], v[88:91]
    s_waitcnt lgkmcnt(0)
    v_exp_f32 v35, v35
    v_mfma_f32_16x16x32_bf16 v[92:95], a[232:235], v[12:15], v[92:95]
    v_add_f32 v5, v5, v34
    v_cvt_pk_bf16_f32 v18, v32, v33
    v_mfma_f32_16x16x32_bf16 v[28:31], a[216:219], a[48:51], 0
L_loop:
    s_waitcnt vmcnt(8)
    s_barrier
    v_exp_f32 v20, v20
    v_mfma_f32_16x16x32_bf16 v[28:31], a[104:107], a[52:55], v[28:31]
    ds_read_b128 a[252:255], v0 offset:0
    v_add_f32 v5, v5, v35
    v_mfma_f32_16x16x32_bf16 v[28:31], a[196:199], a[56:59], v[28:31]
    v_exp_f32 v21, v21
    v_mfma_f32_16x16x32_bf16 v[28:31], a[204:207], a[60:63], v[28:31]
    v_cvt_pk_bf16_f32 v19, v34, v35
    v_add_f32 v6, v6, v20
    v_mfma_f32_16x16x32_bf16 v[32:35], a[244:247], a[48:51], 0
    s_add_u32 s21, s21, s40
    s_add_u32 m0, s21, 0
    s_add_u32 s20, s20, 8192
    v_exp_f32 v22, v22
    v_mfma_f32_16x16x32_bf16 v[32:35], a[200:203], a[52:55], v[32:35]
    buffer_load_dwordx4 v2, s[8:11], s20 offen nt lds
    v_add_f32 v6, v6, v21
    v_mfma_f32_16x16x32_bf16 v[32:35], a[192:195], a[56:59], v[32:35]
    v_exp_f32 v23, v23
    v_mfma_f32_16x16x32_bf16 v[32:35], a[112:115], a[60:63], v[32:35]
    v_add_f32 v6, v6, v22
    v_cvt_pk_bf16_f32 v12, v20, v21
    v_mfma_f32_16x16x32_bf16 v[96:99], a[120:123], v[16:19], v[96:99]
    v_exp_f32 v24, v24
    v_mfma_f32_16x16x32_bf16 v[100:103], a[220:223], v[16:19], v[100:103]
    ds_read_b128 a[248:251], v0 offset:128
    v_add_f32 v6, v6, v23
    v_mfma_f32_16x16x32_bf16 v[104:107], a[224:227], v[16:19], v[104:107]
    v_exp_f32 v25, v25
    v_mfma_f32_16x16x32_bf16 v[108:111], a[228:231], v[16:19], v[108:111]
    v_add_f32 v6, v6, v24
    v_cvt_pk_bf16_f32 v13, v22, v23
    v_mfma_f32_16x16x32_bf16 v[112:115], a[100:103], v[16:19], v[112:115]
    v_exp_f32 v26, v26
    v_mfma_f32_16x16x32_bf16 v[116:119], a[108:111], v[16:19], v[116:119]
    ds_read_b64_tr_b16 a[124:125], v1 offset:0
    v_add_f32 v6, v6, v25
    v_mfma_f32_16x16x32_bf16 v[120:123], a[116:119], v[16:19], v[120:123]
    v_exp_f32 v27, v27
    v_mfma_f32_16x16x32_bf16 v[124:127], a[232:235], v[16:19], v[124:127]
    v_add_f32 v6, v6, v26
    v_cvt_pk_bf16_f32 v14, v24, v25
    v_mfma_f32_16x16x32_bf16 v[20:23], a[216:219], a[64:67], 0
    v_exp_f32 v28, v28
    v_mfma_f32_16x16x32_bf16 v[20:23], a[104:107], a[68:71], v[20:23]
    ds_read_b64_tr_b16 a[126:127], v1 offset:512
    v_add_f32 v6, v6, v27
    v_mfma_f32_16x16x32_bf16 v[20:23], a[196:199], a[72:75], v[20:23]
    v_exp_f32 v29, v29
    v_mfma_f32_16x16x32_bf16 v[20:23], a[204:207], a[76:79], v[20:23]
    v_cvt_pk_bf16_f32 v15, v26, v27
    v_add_f32 v7, v7, v28
    v_mfma_f32_16x16x32_bf16 v[24:27], a[244:247], a[64:67], 0
    s_add_u32 m0, s21, 2176
    v_exp_f32 v30, v30
    v_mfma_f32_16x16x32_bf16 v[24:27], a[200:203], a[68:71], v[24:27]
    buffer_load_dwordx4 v2, s[8:11], s20 offen offset:2048 nt lds
    v_add_f32 v7, v7, v29
    v_mfma_f32_16x16x32_bf16 v[24:27], a[192:195], a[72:75], v[24:27]
    v_exp_f32 v31, v31
    v_mfma_f32_16x16x32_bf16 v[24:27], a[112:115], a[76:79], v[24:27]
    v_add_f32 v7, v7, v30
    v_cvt_pk_bf16_f32 v16, v28, v29
    v_mfma_f32_16x16x32_bf16 a[128:131], a[120:123], v[12:15], a[128:131]
    v_exp_f32 v32, v32
    v_mfma_f32_16x16x32_bf16 a[132:135], a[220:223], v[12:15], a[132:135]
    ds_read_b128 a[240:243], v0 offset:192
    v_add_f32 v7, v7, v31
    v_mfma_f32_16x16x32_bf16 a[136:139], a[224:227], v[12:15], a[136:139]
    v_exp_f32 v33, v33
    v_mfma_f32_16x16x32_bf16 a[140:143], a[228:231], v[12:15], a[140:143]
    v_add_f32 v7, v7, v32
    v_cvt_pk_bf16_f32 v17, v30, v31
    v_mfma_f32_16x16x32_bf16 a[144:147], a[100:103], v[12:15], a[144:147]
    v_exp_f32 v34, v34
    v_mfma_f32_16x16x32_bf16 a[148:151], a[108:111], v[12:15], a[148:151]
    ds_read_b64_tr_b16 a[208:209], v1 offset:64
    v_add_f32 v7, v7, v33
    v_mfma_f32_16x16x32_bf16 a[152:155], a[116:119], v[12:15], a[152:155]
    v_exp_f32 v35, v35
    v_mfma_f32_16x16x32_bf16 a[156:159], a[232:235], v[12:15], a[156:159]
    v_add_f32 v7, v7, v34
    v_cvt_pk_bf16_f32 v18, v32, v33
    v_mfma_f32_16x16x32_bf16 v[28:31], a[216:219], a[80:83], 0
    v_exp_f32 v20, v20
    v_mfma_f32_16x16x32_bf16 v[28:31], a[104:107], a[84:87], v[28:31]
    ds_read_b64_tr_b16 a[210:211], v1 offset:576
    v_add_f32 v7, v7, v35
    v_mfma_f32_16x16x32_bf16 v[28:31], a[196:199], a[88:91], v[28:31]
    v_exp_f32 v21, v21
    v_mfma_f32_16x16x32_bf16 v[28:31], a[204:207], a[92:95], v[28:31]
    v_cvt_pk_bf16_f32 v19, v34, v35
    v_add_f32 v8, v8, v20
    v_mfma_f32_16x16x32_bf16 v[32:35], a[244:247], a[80:83], 0
    s_add_u32 s39, s39, s41
    s_add_u32 m0, s39, 67584
    s_add_u32 s25, s25, 8192
    v_exp_f32 v22, v22
    v_mfma_f32_16x16x32_bf16 v[32:35], a[200:203], a[84:87], v[32:35]
    buffer_load_dwordx4 v3, s[12:15], s25 offen nt lds
    v_add_f32 v8, v8, v21
    v_mfma_f32_16x16x32_bf16 v[32:35], a[192:195], a[88:91], v[32:35]
    v_exp_f32 v23, v23
    v_mfma_f32_16x16x32_bf16 v[32:35], a[112:115], a[92:95], v[32:35]
    v_add_f32 v8, v8, v22
    v_cvt_pk_bf16_f32 v12, v20, v21
    v_mfma_f32_16x16x32_bf16 a[160:163], a[120:123], v[16:19], a[160:163]
    v_exp_f32 v24, v24
    v_mfma_f32_16x16x32_bf16 a[164:167], a[220:223], v[16:19], a[164:167]
    ds_read_b128 a[212:215], v0 offset:512
    v_add_f32 v8, v8, v23
    v_mfma_f32_16x16x32_bf16 a[168:171], a[224:227], v[16:19], a[168:171]
    v_exp_f32 v25, v25
    v_mfma_f32_16x16x32_bf16 a[172:175], a[228:231], v[16:19], a[172:175]
    v_add_f32 v8, v8, v24
    v_cvt_pk_bf16_f32 v13, v22, v23
    v_mfma_f32_16x16x32_bf16 a[176:179], a[100:103], v[16:19], a[176:179]
    v_exp_f32 v26, v26
    v_mfma_f32_16x16x32_bf16 a[180:183], a[108:111], v[16:19], a[180:183]
    ds_read_b64_tr_b16 a[236:237], v1 offset:72
    v_add_f32 v8, v8, v25
    v_mfma_f32_16x16x32_bf16 a[184:187], a[116:119], v[16:19], a[184:187]
    v_exp_f32 v27, v27
    v_mfma_f32_16x16x32_bf16 a[188:191], a[232:235], v[16:19], a[188:191]
    v_add_f32 v8, v8, v26
    v_cvt_pk_bf16_f32 v14, v24, v25
    v_mfma_f32_16x16x32_bf16 v[20:23], a[216:219], a[96:99], 0
    v_exp_f32 v28, v28
    v_mfma_f32_16x16x32_bf16 v[20:23], a[104:107], v[36:39], v[20:23]
    ds_read_b64_tr_b16 a[238:239], v1 offset:584
    v_add_f32 v8, v8, v27
    v_mfma_f32_16x16x32_bf16 v[20:23], a[196:199], v[40:43], v[20:23]
    v_exp_f32 v29, v29
    v_mfma_f32_16x16x32_bf16 v[20:23], a[204:207], v[44:47], v[20:23]
    v_cvt_pk_bf16_f32 v15, v26, v27
    v_add_f32 v9, v9, v28
    v_mfma_f32_16x16x32_bf16 v[24:27], a[244:247], a[96:99], 0
    s_add_u32 m0, s39, 70920
    v_exp_f32 v30, v30
    v_mfma_f32_16x16x32_bf16 v[24:27], a[200:203], v[36:39], v[24:27]
    buffer_load_dwordx4 v3, s[12:15], s25 offen offset:1024 nt lds
    v_add_f32 v9, v9, v29
    v_mfma_f32_16x16x32_bf16 v[24:27], a[192:195], v[40:43], v[24:27]
    v_exp_f32 v31, v31
    v_mfma_f32_16x16x32_bf16 v[24:27], a[112:115], v[44:47], v[24:27]
    v_add_f32 v9, v9, v30
    v_cvt_pk_bf16_f32 v16, v28, v29
    v_mfma_f32_16x16x32_bf16 v[128:131], a[120:123], v[12:15], v[128:131]
    s_add_u32 m0, s21, 8448
    s_add_u32 s20, s20, 8192
    v_exp_f32 v32, v32
    v_mfma_f32_16x16x32_bf16 v[132:135], a[220:223], v[12:15], v[132:135]
    buffer_load_dwordx4 v2, s[8:11], s20 offen nt lds
    v_add_f32 v9, v9, v31
    v_mfma_f32_16x16x32_bf16 v[136:139], a[224:227], v[12:15], v[136:139]
    v_exp_f32 v33, v33
    v_mfma_f32_16x16x32_bf16 v[140:143], a[228:231], v[12:15], v[140:143]
    v_add_f32 v9, v9, v32
    v_cvt_pk_bf16_f32 v17, v30, v31
    v_mfma_f32_16x16x32_bf16 v[144:147], a[100:103], v[12:15], v[144:147]
    s_add_u32 m0, s21, 10624
    v_exp_f32 v34, v34
    v_mfma_f32_16x16x32_bf16 v[148:151], a[108:111], v[12:15], v[148:151]
    buffer_load_dwordx4 v2, s[8:11], s20 offen offset:2048 nt lds
    v_add_f32 v9, v9, v33
    v_mfma_f32_16x16x32_bf16 v[152:155], a[116:119], v[12:15], v[152:155]
    v_exp_f32 v35, v35
    v_mfma_f32_16x16x32_bf16 v[156:159], a[232:235], v[12:15], v[156:159]
    v_add_f32 v9, v9, v34
    v_cvt_pk_bf16_f32 v18, v32, v33
    v_mfma_f32_16x16x32_bf16 v[28:31], a[216:219], v[48:51], 0
    v_exp_f32 v20, v20
    v_mfma_f32_16x16x32_bf16 v[28:31], a[104:107], v[52:55], v[28:31]
    ds_read_b128 a[104:107], v0 offset:64
    v_add_f32 v9, v9, v35
    v_mfma_f32_16x16x32_bf16 v[28:31], a[196:199], v[56:59], v[28:31]
    v_exp_f32 v21, v21
    v_mfma_f32_16x16x32_bf16 v[28:31], a[204:207], v[60:63], v[28:31]
    v_cvt_pk_bf16_f32 v19, v34, v35
    v_add_f32 v10, v10, v20
    v_mfma_f32_16x16x32_bf16 v[32:35], a[244:247], v[48:51], 0
    v_exp_f32 v22, v22
    v_mfma_f32_16x16x32_bf16 v[32:35], a[200:203], v[52:55], v[32:35]
    ds_read_b128 a[200:203], v0 offset:576
    v_add_f32 v10, v10, v21
    v_mfma_f32_16x16x32_bf16 v[32:35], a[192:195], v[56:59], v[32:35]
    v_exp_f32 v23, v23
    v_mfma_f32_16x16x32_bf16 v[32:35], a[112:115], v[60:63], v[32:35]
    v_add_f32 v10, v10, v22
    v_cvt_pk_bf16_f32 v12, v20, v21
    v_mfma_f32_16x16x32_bf16 v[160:163], a[120:123], v[16:19], v[160:163]
    v_exp_f32 v24, v24
    v_mfma_f32_16x16x32_bf16 v[164:167], a[220:223], v[16:19], v[164:167]
    ds_read_b128 a[196:199], v0 offset:640
    v_add_f32 v10, v10, v23
    v_mfma_f32_16x16x32_bf16 v[168:171], a[224:227], v[16:19], v[168:171]
    v_exp_f32 v25, v25
    v_mfma_f32_16x16x32_bf16 v[172:175], a[228:231], v[16:19], v[172:175]
    v_add_f32 v10, v10, v24
    v_cvt_pk_bf16_f32 v13, v22, v23
    v_mfma_f32_16x16x32_bf16 v[176:179], a[100:103], v[16:19], v[176:179]
    v_exp_f32 v26, v26
    v_mfma_f32_16x16x32_bf16 v[180:183], a[108:111], v[16:19], v[180:183]
    ds_read_b128 a[204:207], v0 offset:704
    v_add_f32 v10, v10, v25
    v_mfma_f32_16x16x32_bf16 v[184:187], a[116:119], v[16:19], v[184:187]
    v_exp_f32 v27, v27
    v_mfma_f32_16x16x32_bf16 v[188:191], a[232:235], v[16:19], v[188:191]
    s_waitcnt lgkmcnt(2)
    v_add_f32 v10, v10, v26
    v_cvt_pk_bf16_f32 v14, v24, v25
    v_mfma_f32_16x16x32_bf16 v[20:23], a[252:255], a[0:3], 0
    v_exp_f32 v28, v28
    v_mfma_f32_16x16x32_bf16 v[20:23], a[104:107], a[4:7], v[20:23]
    ds_read_b64_tr_b16 a[216:217], v1 offset:128
    v_add_f32 v10, v10, v27
    v_mfma_f32_16x16x32_bf16 v[20:23], a[248:251], a[8:11], v[20:23]
    v_exp_f32 v29, v29
    v_mfma_f32_16x16x32_bf16 v[20:23], a[240:243], a[12:15], v[20:23]
    v_cvt_pk_bf16_f32 v15, v26, v27
    v_add_f32 v11, v11, v28
    v_mfma_f32_16x16x32_bf16 v[24:27], a[212:215], a[0:3], 0
    s_waitcnt lgkmcnt(2)
    v_exp_f32 v30, v30
    v_mfma_f32_16x16x32_bf16 v[24:27], a[200:203], a[4:7], v[24:27]
    ds_read_b64_tr_b16 a[218:219], v1 offset:640
    v_add_f32 v11, v11, v29
    v_mfma_f32_16x16x32_bf16 v[24:27], a[196:199], a[8:11], v[24:27]
    s_waitcnt lgkmcnt(2)
    v_exp_f32 v31, v31
    v_mfma_f32_16x16x32_bf16 v[24:27], a[204:207], a[12:15], v[24:27]
    v_add_f32 v11, v11, v30
    v_cvt_pk_bf16_f32 v16, v28, v29
    v_mfma_f32_16x16x32_bf16 v[192:195], a[120:123], v[12:15], v[192:195]
    v_exp_f32 v32, v32
    v_mfma_f32_16x16x32_bf16 v[196:199], a[220:223], v[12:15], v[196:199]
    ds_read_b64_tr_b16 a[192:193], v1 offset:136
    v_add_f32 v11, v11, v31
    v_mfma_f32_16x16x32_bf16 v[200:203], a[224:227], v[12:15], v[200:203]
    v_exp_f32 v33, v33
    v_mfma_f32_16x16x32_bf16 v[204:207], a[228:231], v[12:15], v[204:207]
    v_add_f32 v11, v11, v32
    v_cvt_pk_bf16_f32 v17, v30, v31
    v_mfma_f32_16x16x32_bf16 v[208:211], a[100:103], v[12:15], v[208:211]
    v_exp_f32 v34, v34
    v_mfma_f32_16x16x32_bf16 v[212:215], a[108:111], v[12:15], v[212:215]
    ds_read_b64_tr_b16 a[194:195], v1 offset:648
    v_add_f32 v11, v11, v33
    v_mfma_f32_16x16x32_bf16 v[216:219], a[116:119], v[12:15], v[216:219]
    v_exp_f32 v35, v35
    v_mfma_f32_16x16x32_bf16 v[220:223], a[232:235], v[12:15], v[220:223]
    v_add_f32 v11, v11, v34
    v_cvt_pk_bf16_f32 v18, v32, v33
    v_mfma_f32_16x16x32_bf16 v[28:31], a[252:255], a[16:19], 0
    v_exp_f32 v20, v20
    v_mfma_f32_16x16x32_bf16 v[28:31], a[104:107], a[20:23], v[28:31]
    ds_read_b64_tr_b16 a[112:113], v1 offset:192
    v_add_f32 v11, v11, v35
    v_mfma_f32_16x16x32_bf16 v[28:31], a[248:251], a[24:27], v[28:31]
    v_exp_f32 v21, v21
    v_mfma_f32_16x16x32_bf16 v[28:31], a[240:243], a[28:31], v[28:31]
    v_cvt_pk_bf16_f32 v19, v34, v35
    v_add_f32 v4, v4, v20
    v_mfma_f32_16x16x32_bf16 v[32:35], a[212:215], a[16:19], 0
    v_exp_f32 v22, v22
    v_mfma_f32_16x16x32_bf16 v[32:35], a[200:203], a[20:23], v[32:35]
    ds_read_b64_tr_b16 a[114:115], v1 offset:704
    v_add_f32 v4, v4, v21
    v_mfma_f32_16x16x32_bf16 v[32:35], a[196:199], a[24:27], v[32:35]
    v_exp_f32 v23, v23
    v_mfma_f32_16x16x32_bf16 v[32:35], a[204:207], a[28:31], v[32:35]
    v_add_f32 v4, v4, v22
    v_cvt_pk_bf16_f32 v12, v20, v21
    v_mfma_f32_16x16x32_bf16 v[224:227], a[120:123], v[16:19], v[224:227]
    v_exp_f32 v24, v24
    v_mfma_f32_16x16x32_bf16 v[228:231], a[220:223], v[16:19], v[228:231]
    ds_read_b64_tr_b16 a[220:221], v1 offset:8
    v_add_f32 v4, v4, v23
    v_mfma_f32_16x16x32_bf16 v[232:235], a[224:227], v[16:19], v[232:235]
    v_exp_f32 v25, v25
    v_mfma_f32_16x16x32_bf16 v[236:239], a[228:231], v[16:19], v[236:239]
    v_add_f32 v4, v4, v24
    v_cvt_pk_bf16_f32 v13, v22, v23
    v_mfma_f32_16x16x32_bf16 v[240:243], a[100:103], v[16:19], v[240:243]
    v_exp_f32 v26, v26
    v_mfma_f32_16x16x32_bf16 v[244:247], a[108:111], v[16:19], v[244:247]
    ds_read_b64_tr_b16 a[222:223], v1 offset:520
    v_add_f32 v4, v4, v25
    v_mfma_f32_16x16x32_bf16 v[248:251], a[116:119], v[16:19], v[248:251]
    v_exp_f32 v27, v27
    v_mfma_f32_16x16x32_bf16 v[252:255], a[232:235], v[16:19], v[252:255]
    v_add_f32 v4, v4, v26
    v_cvt_pk_bf16_f32 v14, v24, v25
    v_mfma_f32_16x16x32_bf16 v[20:23], a[252:255], a[32:35], 0
    v_exp_f32 v28, v28
    v_mfma_f32_16x16x32_bf16 v[20:23], a[104:107], a[36:39], v[20:23]
    ds_read_b64_tr_b16 a[100:101], v1 offset:200
    v_add_f32 v4, v4, v27
    v_mfma_f32_16x16x32_bf16 v[20:23], a[248:251], a[40:43], v[20:23]
    v_exp_f32 v29, v29
    v_mfma_f32_16x16x32_bf16 v[20:23], a[240:243], a[44:47], v[20:23]
    v_cvt_pk_bf16_f32 v15, v26, v27
    v_add_f32 v5, v5, v28
    v_mfma_f32_16x16x32_bf16 v[24:27], a[212:215], a[32:35], 0
    v_exp_f32 v30, v30
    v_mfma_f32_16x16x32_bf16 v[24:27], a[200:203], a[36:39], v[24:27]
    ds_read_b64_tr_b16 a[102:103], v1 offset:712
    v_add_f32 v5, v5, v29
    v_mfma_f32_16x16x32_bf16 v[24:27], a[196:199], a[40:43], v[24:27]
    v_exp_f32 v31, v31
    v_mfma_f32_16x16x32_bf16 v[24:27], a[204:207], a[44:47], v[24:27]
    v_add_f32 v5, v5, v30
    v_cvt_pk_bf16_f32 v16, v28, v29
    v_mfma_f32_16x16x32_bf16 v[64:67], a[124:127], v[12:15], v[64:67]
    s_waitcnt lgkmcnt(2)
    s_add_u32 m0, s39, 76304
    s_add_u32 s25, s25, 8192
    v_exp_f32 v32, v32
    v_mfma_f32_16x16x32_bf16 v[68:71], a[220:223], v[12:15], v[68:71]
    buffer_load_dwordx4 v3, s[12:15], s25 offen nt lds
    v_add_f32 v5, v5, v31
    v_mfma_f32_16x16x32_bf16 v[72:75], a[208:211], v[12:15], v[72:75]
    v_exp_f32 v33, v33
    v_mfma_f32_16x16x32_bf16 v[76:79], a[236:239], v[12:15], v[76:79]
    v_add_f32 v5, v5, v32
    v_cvt_pk_bf16_f32 v17, v30, v31
    v_mfma_f32_16x16x32_bf16 v[80:83], a[216:219], v[12:15], v[80:83]
    s_add_u32 m0, s39, 79640
    v_exp_f32 v34, v34
    v_mfma_f32_16x16x32_bf16 v[84:87], a[192:195], v[12:15], v[84:87]
    buffer_load_dwordx4 v3, s[12:15], s25 offen offset:1024 nt lds
    v_add_f32 v5, v5, v33
    v_mfma_f32_16x16x32_bf16 v[88:91], a[112:115], v[12:15], v[88:91]
    s_waitcnt lgkmcnt(0)
    v_exp_f32 v35, v35
    v_mfma_f32_16x16x32_bf16 v[92:95], a[100:103], v[12:15], v[92:95]
    v_add_f32 v5, v5, v34
    v_cvt_pk_bf16_f32 v18, v32, v33
    v_mfma_f32_16x16x32_bf16 v[28:31], a[252:255], a[48:51], 0
    v_exp_f32 v20, v20
    v_mfma_f32_16x16x32_bf16 v[28:31], a[104:107], a[52:55], v[28:31]
    ds_read_b128 a[232:235], v0 offset:8448
    v_add_f32 v5, v5, v35
    v_mfma_f32_16x16x32_bf16 v[28:31], a[248:251], a[56:59], v[28:31]
    v_exp_f32 v21, v21
    v_mfma_f32_16x16x32_bf16 v[28:31], a[240:243], a[60:63], v[28:31]
    v_cvt_pk_bf16_f32 v19, v34, v35
    v_add_f32 v6, v6, v20
    v_mfma_f32_16x16x32_bf16 v[32:35], a[212:215], a[48:51], 0
    v_exp_f32 v22, v22
    v_mfma_f32_16x16x32_bf16 v[32:35], a[200:203], a[52:55], v[32:35]
    v_add_f32 v6, v6, v21
    v_mfma_f32_16x16x32_bf16 v[32:35], a[196:199], a[56:59], v[32:35]
    v_exp_f32 v23, v23
    v_mfma_f32_16x16x32_bf16 v[32:35], a[204:207], a[60:63], v[32:35]
    v_add_f32 v6, v6, v22
    v_cvt_pk_bf16_f32 v12, v20, v21
    v_mfma_f32_16x16x32_bf16 v[96:99], a[124:127], v[16:19], v[96:99]
    v_exp_f32 v24, v24
    v_mfma_f32_16x16x32_bf16 v[100:103], a[220:223], v[16:19], v[100:103]
    ds_read_b128 a[108:111], v0 offset:8576
    v_add_f32 v6, v6, v23
    v_mfma_f32_16x16x32_bf16 v[104:107], a[208:211], v[16:19], v[104:107]
    v_exp_f32 v25, v25
    v_mfma_f32_16x16x32_bf16 v[108:111], a[236:239], v[16:19], v[108:111]
    v_add_f32 v6, v6, v24
    v_cvt_pk_bf16_f32 v13, v22, v23
    v_mfma_f32_16x16x32_bf16 v[112:115], a[216:219], v[16:19], v[112:115]
    v_exp_f32 v26, v26
    v_mfma_f32_16x16x32_bf16 v[116:119], a[192:195], v[16:19], v[116:119]
    ds_read_b64_tr_b16 a[120:121], v1 offset:8720
    v_add_f32 v6, v6, v25
    v_mfma_f32_16x16x32_bf16 v[120:123], a[112:115], v[16:19], v[120:123]
    v_exp_f32 v27, v27
    v_mfma_f32_16x16x32_bf16 v[124:127], a[100:103], v[16:19], v[124:127]
    v_add_f32 v6, v6, v26
    v_cvt_pk_bf16_f32 v14, v24, v25
    v_mfma_f32_16x16x32_bf16 v[20:23], a[252:255], a[64:67], 0
    v_exp_f32 v28, v28
    v_mfma_f32_16x16x32_bf16 v[20:23], a[104:107], a[68:71], v[20:23]
    ds_read_b64_tr_b16 a[122:123], v1 offset:9232
    v_add_f32 v6, v6, v27
    v_mfma_f32_16x16x32_bf16 v[20:23], a[248:251], a[72:75], v[20:23]
    v_exp_f32 v29, v29
    v_mfma_f32_16x16x32_bf16 v[20:23], a[240:243], a[76:79], v[20:23]
    v_cvt_pk_bf16_f32 v15, v26, v27
    v_add_f32 v7, v7, v28
    v_mfma_f32_16x16x32_bf16 v[24:27], a[212:215], a[64:67], 0
    v_exp_f32 v30, v30
    v_mfma_f32_16x16x32_bf16 v[24:27], a[200:203], a[68:71], v[24:27]
    v_add_f32 v7, v7, v29
    v_mfma_f32_16x16x32_bf16 v[24:27], a[196:199], a[72:75], v[24:27]
    v_exp_f32 v31, v31
    v_mfma_f32_16x16x32_bf16 v[24:27], a[204:207], a[76:79], v[24:27]
    v_add_f32 v7, v7, v30
    v_cvt_pk_bf16_f32 v16, v28, v29
    v_mfma_f32_16x16x32_bf16 a[128:131], a[124:127], v[12:15], a[128:131]
    v_exp_f32 v32, v32
    v_mfma_f32_16x16x32_bf16 a[132:135], a[220:223], v[12:15], a[132:135]
    ds_read_b128 a[116:119], v0 offset:8640
    v_add_f32 v7, v7, v31
    v_mfma_f32_16x16x32_bf16 a[136:139], a[208:211], v[12:15], a[136:139]
    v_exp_f32 v33, v33
    v_mfma_f32_16x16x32_bf16 a[140:143], a[236:239], v[12:15], a[140:143]
    v_add_f32 v7, v7, v32
    v_cvt_pk_bf16_f32 v17, v30, v31
    v_mfma_f32_16x16x32_bf16 a[144:147], a[216:219], v[12:15], a[144:147]
    v_exp_f32 v34, v34
    v_mfma_f32_16x16x32_bf16 a[148:151], a[192:195], v[12:15], a[148:151]
    ds_read_b64_tr_b16 a[224:225], v1 offset:8784
    v_add_f32 v7, v7, v33
    v_mfma_f32_16x16x32_bf16 a[152:155], a[112:115], v[12:15], a[152:155]
    v_exp_f32 v35, v35
    v_mfma_f32_16x16x32_bf16 a[156:159], a[100:103], v[12:15], a[156:159]
    v_add_f32 v7, v7, v34
    v_cvt_pk_bf16_f32 v18, v32, v33
    v_mfma_f32_16x16x32_bf16 v[28:31], a[252:255], a[80:83], 0
    v_exp_f32 v20, v20
    v_mfma_f32_16x16x32_bf16 v[28:31], a[104:107], a[84:87], v[28:31]
    ds_read_b64_tr_b16 a[226:227], v1 offset:9296
    v_add_f32 v7, v7, v35
    v_mfma_f32_16x16x32_bf16 v[28:31], a[248:251], a[88:91], v[28:31]
    v_exp_f32 v21, v21
    v_mfma_f32_16x16x32_bf16 v[28:31], a[240:243], a[92:95], v[28:31]
    v_cvt_pk_bf16_f32 v19, v34, v35
    v_add_f32 v8, v8, v20
    v_mfma_f32_16x16x32_bf16 v[32:35], a[212:215], a[80:83], 0
    v_exp_f32 v22, v22
    v_mfma_f32_16x16x32_bf16 v[32:35], a[200:203], a[84:87], v[32:35]
    v_add_f32 v8, v8, v21
    v_mfma_f32_16x16x32_bf16 v[32:35], a[196:199], a[88:91], v[32:35]
    v_exp_f32 v23, v23
    v_mfma_f32_16x16x32_bf16 v[32:35], a[204:207], a[92:95], v[32:35]
    v_add_f32 v8, v8, v22
    v_cvt_pk_bf16_f32 v12, v20, v21
    v_mfma_f32_16x16x32_bf16 a[160:163], a[124:127], v[16:19], a[160:163]
    v_exp_f32 v24, v24
    v_mfma_f32_16x16x32_bf16 a[164:167], a[220:223], v[16:19], a[164:167]
    ds_read_b128 a[244:247], v0 offset:8960
    v_add_f32 v8, v8, v23
    v_mfma_f32_16x16x32_bf16 a[168:171], a[208:211], v[16:19], a[168:171]
    v_exp_f32 v25, v25
    v_mfma_f32_16x16x32_bf16 a[172:175], a[236:239], v[16:19], a[172:175]
    v_add_f32 v8, v8, v24
    v_cvt_pk_bf16_f32 v13, v22, v23
    v_mfma_f32_16x16x32_bf16 a[176:179], a[216:219], v[16:19], a[176:179]
    v_exp_f32 v26, v26
    v_mfma_f32_16x16x32_bf16 a[180:183], a[192:195], v[16:19], a[180:183]
    ds_read_b64_tr_b16 a[228:229], v1 offset:8792
    v_add_f32 v8, v8, v25
    v_mfma_f32_16x16x32_bf16 a[184:187], a[112:115], v[16:19], a[184:187]
    v_exp_f32 v27, v27
    v_mfma_f32_16x16x32_bf16 a[188:191], a[100:103], v[16:19], a[188:191]
    v_add_f32 v8, v8, v26
    v_cvt_pk_bf16_f32 v14, v24, v25
    v_mfma_f32_16x16x32_bf16 v[20:23], a[252:255], a[96:99], 0
    v_exp_f32 v28, v28
    v_mfma_f32_16x16x32_bf16 v[20:23], a[104:107], v[36:39], v[20:23]
    ds_read_b64_tr_b16 a[230:231], v1 offset:9304
    v_add_f32 v8, v8, v27
    v_mfma_f32_16x16x32_bf16 v[20:23], a[248:251], v[40:43], v[20:23]
    v_exp_f32 v29, v29
    v_mfma_f32_16x16x32_bf16 v[20:23], a[240:243], v[44:47], v[20:23]
    v_cvt_pk_bf16_f32 v15, v26, v27
    v_add_f32 v9, v9, v28
    v_mfma_f32_16x16x32_bf16 v[24:27], a[212:215], a[96:99], 0
    v_exp_f32 v30, v30
    v_mfma_f32_16x16x32_bf16 v[24:27], a[200:203], v[36:39], v[24:27]
    v_add_f32 v9, v9, v29
    v_mfma_f32_16x16x32_bf16 v[24:27], a[196:199], v[40:43], v[24:27]
    v_exp_f32 v31, v31
    v_mfma_f32_16x16x32_bf16 v[24:27], a[204:207], v[44:47], v[24:27]
    v_add_f32 v9, v9, v30
    v_cvt_pk_bf16_f32 v16, v28, v29
    v_mfma_f32_16x16x32_bf16 v[128:131], a[124:127], v[12:15], v[128:131]
    v_exp_f32 v32, v32
    v_mfma_f32_16x16x32_bf16 v[132:135], a[220:223], v[12:15], v[132:135]
    v_add_f32 v9, v9, v31
    v_mfma_f32_16x16x32_bf16 v[136:139], a[208:211], v[12:15], v[136:139]
    v_exp_f32 v33, v33
    v_mfma_f32_16x16x32_bf16 v[140:143], a[236:239], v[12:15], v[140:143]
    v_add_f32 v9, v9, v32
    v_cvt_pk_bf16_f32 v17, v30, v31
    v_mfma_f32_16x16x32_bf16 v[144:147], a[216:219], v[12:15], v[144:147]
    v_exp_f32 v34, v34
    v_mfma_f32_16x16x32_bf16 v[148:151], a[192:195], v[12:15], v[148:151]
    v_add_f32 v9, v9, v33
    v_mfma_f32_16x16x32_bf16 v[152:155], a[112:115], v[12:15], v[152:155]
    v_exp_f32 v35, v35
    v_mfma_f32_16x16x32_bf16 v[156:159], a[100:103], v[12:15], v[156:159]
    v_add_f32 v9, v9, v34
    v_cvt_pk_bf16_f32 v18, v32, v33
    v_mfma_f32_16x16x32_bf16 v[28:31], a[252:255], v[48:51], 0
    v_exp_f32 v20, v20
    v_mfma_f32_16x16x32_bf16 v[28:31], a[104:107], v[52:55], v[28:31]
    ds_read_b128 a[104:107], v0 offset:8512
    v_add_f32 v9, v9, v35
    v_mfma_f32_16x16x32_bf16 v[28:31], a[248:251], v[56:59], v[28:31]
    v_exp_f32 v21, v21
    v_mfma_f32_16x16x32_bf16 v[28:31], a[240:243], v[60:63], v[28:31]
    v_cvt_pk_bf16_f32 v19, v34, v35
    v_add_f32 v10, v10, v20
    v_mfma_f32_16x16x32_bf16 v[32:35], a[212:215], v[48:51], 0
    v_exp_f32 v22, v22
    v_mfma_f32_16x16x32_bf16 v[32:35], a[200:203], v[52:55], v[32:35]
    ds_read_b128 a[200:203], v0 offset:9024
    v_add_f32 v10, v10, v21
    v_mfma_f32_16x16x32_bf16 v[32:35], a[196:199], v[56:59], v[32:35]
    v_exp_f32 v23, v23
    v_mfma_f32_16x16x32_bf16 v[32:35], a[204:207], v[60:63], v[32:35]
    v_add_f32 v10, v10, v22
    v_cvt_pk_bf16_f32 v12, v20, v21
    v_mfma_f32_16x16x32_bf16 v[160:163], a[124:127], v[16:19], v[160:163]
    v_exp_f32 v24, v24
    v_mfma_f32_16x16x32_bf16 v[164:167], a[220:223], v[16:19], v[164:167]
    ds_read_b128 a[248:251], v0 offset:9088
    v_add_f32 v10, v10, v23
    v_mfma_f32_16x16x32_bf16 v[168:171], a[208:211], v[16:19], v[168:171]
    v_exp_f32 v25, v25
    v_mfma_f32_16x16x32_bf16 v[172:175], a[236:239], v[16:19], v[172:175]
    v_add_f32 v10, v10, v24
    v_cvt_pk_bf16_f32 v13, v22, v23
    v_mfma_f32_16x16x32_bf16 v[176:179], a[216:219], v[16:19], v[176:179]
    v_exp_f32 v26, v26
    v_mfma_f32_16x16x32_bf16 v[180:183], a[192:195], v[16:19], v[180:183]
    ds_read_b128 a[240:243], v0 offset:9152
    v_add_f32 v10, v10, v25
    v_mfma_f32_16x16x32_bf16 v[184:187], a[112:115], v[16:19], v[184:187]
    v_exp_f32 v27, v27
    v_mfma_f32_16x16x32_bf16 v[188:191], a[100:103], v[16:19], v[188:191]
    s_waitcnt lgkmcnt(2)
    v_add_f32 v10, v10, v26
    v_cvt_pk_bf16_f32 v14, v24, v25
    v_mfma_f32_16x16x32_bf16 v[20:23], a[232:235], a[0:3], 0
    v_exp_f32 v28, v28
    v_mfma_f32_16x16x32_bf16 v[20:23], a[104:107], a[4:7], v[20:23]
    ds_read_b64_tr_b16 a[252:253], v1 offset:8848
    v_add_f32 v10, v10, v27
    v_mfma_f32_16x16x32_bf16 v[20:23], a[108:111], a[8:11], v[20:23]
    v_exp_f32 v29, v29
    v_mfma_f32_16x16x32_bf16 v[20:23], a[116:119], a[12:15], v[20:23]
    v_cvt_pk_bf16_f32 v15, v26, v27
    v_add_f32 v11, v11, v28
    v_mfma_f32_16x16x32_bf16 v[24:27], a[244:247], a[0:3], 0
    s_waitcnt lgkmcnt(2)
    v_exp_f32 v30, v30
    v_mfma_f32_16x16x32_bf16 v[24:27], a[200:203], a[4:7], v[24:27]
    ds_read_b64_tr_b16 a[254:255], v1 offset:9360
    v_add_f32 v11, v11, v29
    v_mfma_f32_16x16x32_bf16 v[24:27], a[248:251], a[8:11], v[24:27]
    s_waitcnt lgkmcnt(2)
    v_exp_f32 v31, v31
    v_mfma_f32_16x16x32_bf16 v[24:27], a[240:243], a[12:15], v[24:27]
    v_add_f32 v11, v11, v30
    v_cvt_pk_bf16_f32 v16, v28, v29
    v_mfma_f32_16x16x32_bf16 v[192:195], a[124:127], v[12:15], v[192:195]
    v_exp_f32 v32, v32
    v_mfma_f32_16x16x32_bf16 v[196:199], a[220:223], v[12:15], v[196:199]
    ds_read_b64_tr_b16 a[196:197], v1 offset:8856
    v_add_f32 v11, v11, v31
    v_mfma_f32_16x16x32_bf16 v[200:203], a[208:211], v[12:15], v[200:203]
    v_exp_f32 v33, v33
    v_mfma_f32_16x16x32_bf16 v[204:207], a[236:239], v[12:15], v[204:207]
    v_add_f32 v11, v11, v32
    v_cvt_pk_bf16_f32 v17, v30, v31
    v_mfma_f32_16x16x32_bf16 v[208:211], a[216:219], v[12:15], v[208:211]
    v_exp_f32 v34, v34
    v_mfma_f32_16x16x32_bf16 v[212:215], a[192:195], v[12:15], v[212:215]
    ds_read_b64_tr_b16 a[198:199], v1 offset:9368
    v_add_f32 v11, v11, v33
    v_mfma_f32_16x16x32_bf16 v[216:219], a[112:115], v[12:15], v[216:219]
    v_exp_f32 v35, v35
    v_mfma_f32_16x16x32_bf16 v[220:223], a[100:103], v[12:15], v[220:223]
    v_add_f32 v11, v11, v34
    v_cvt_pk_bf16_f32 v18, v32, v33
    v_mfma_f32_16x16x32_bf16 v[28:31], a[232:235], a[16:19], 0
    v_exp_f32 v20, v20
    v_mfma_f32_16x16x32_bf16 v[28:31], a[104:107], a[20:23], v[28:31]
    ds_read_b64_tr_b16 a[204:205], v1 offset:8912
    v_add_f32 v11, v11, v35
    v_mfma_f32_16x16x32_bf16 v[28:31], a[108:111], a[24:27], v[28:31]
    v_exp_f32 v21, v21
    v_mfma_f32_16x16x32_bf16 v[28:31], a[116:119], a[28:31], v[28:31]
    v_cvt_pk_bf16_f32 v19, v34, v35
    v_add_f32 v4, v4, v20
    v_mfma_f32_16x16x32_bf16 v[32:35], a[244:247], a[16:19], 0
    v_exp_f32 v22, v22
    v_mfma_f32_16x16x32_bf16 v[32:35], a[200:203], a[20:23], v[32:35]
    ds_read_b64_tr_b16 a[206:207], v1 offset:9424
    v_add_f32 v4, v4, v21
    v_mfma_f32_16x16x32_bf16 v[32:35], a[248:251], a[24:27], v[32:35]
    v_exp_f32 v23, v23
    v_mfma_f32_16x16x32_bf16 v[32:35], a[240:243], a[28:31], v[32:35]
    v_add_f32 v4, v4, v22
    v_cvt_pk_bf16_f32 v12, v20, v21
    v_mfma_f32_16x16x32_bf16 v[224:227], a[124:127], v[16:19], v[224:227]
    v_exp_f32 v24, v24
    v_mfma_f32_16x16x32_bf16 v[228:231], a[220:223], v[16:19], v[228:231]
    ds_read_b64_tr_b16 a[220:221], v1 offset:8728
    v_add_f32 v4, v4, v23
    v_mfma_f32_16x16x32_bf16 v[232:235], a[208:211], v[16:19], v[232:235]
    v_exp_f32 v25, v25
    v_mfma_f32_16x16x32_bf16 v[236:239], a[236:239], v[16:19], v[236:239]
    v_add_f32 v4, v4, v24
    v_cvt_pk_bf16_f32 v13, v22, v23
    v_mfma_f32_16x16x32_bf16 v[240:243], a[216:219], v[16:19], v[240:243]
    v_exp_f32 v26, v26
    v_mfma_f32_16x16x32_bf16 v[244:247], a[192:195], v[16:19], v[244:247]
    ds_read_b64_tr_b16 a[222:223], v1 offset:9240
    v_add_f32 v4, v4, v25
    v_mfma_f32_16x16x32_bf16 v[248:251], a[112:115], v[16:19], v[248:251]
    v_exp_f32 v27, v27
    v_mfma_f32_16x16x32_bf16 v[252:255], a[100:103], v[16:19], v[252:255]
    v_add_f32 v4, v4, v26
    v_cvt_pk_bf16_f32 v14, v24, v25
    v_mfma_f32_16x16x32_bf16 v[20:23], a[232:235], a[32:35], 0
    v_exp_f32 v28, v28
    v_mfma_f32_16x16x32_bf16 v[20:23], a[104:107], a[36:39], v[20:23]
    ds_read_b64_tr_b16 a[216:217], v1 offset:8920
    v_add_f32 v4, v4, v27
    v_mfma_f32_16x16x32_bf16 v[20:23], a[108:111], a[40:43], v[20:23]
    v_exp_f32 v29, v29
    v_mfma_f32_16x16x32_bf16 v[20:23], a[116:119], a[44:47], v[20:23]
    v_cvt_pk_bf16_f32 v15, v26, v27
    v_add_f32 v5, v5, v28
    v_mfma_f32_16x16x32_bf16 v[24:27], a[244:247], a[32:35], 0
    v_exp_f32 v30, v30
    v_mfma_f32_16x16x32_bf16 v[24:27], a[200:203], a[36:39], v[24:27]
    ds_read_b64_tr_b16 a[218:219], v1 offset:9432
    v_add_f32 v5, v5, v29
    v_mfma_f32_16x16x32_bf16 v[24:27], a[248:251], a[40:43], v[24:27]
    v_exp_f32 v31, v31
    v_mfma_f32_16x16x32_bf16 v[24:27], a[240:243], a[44:47], v[24:27]
    v_add_f32 v5, v5, v30
    v_cvt_pk_bf16_f32 v16, v28, v29
    v_mfma_f32_16x16x32_bf16 v[64:67], a[120:123], v[12:15], v[64:67]
    s_waitcnt lgkmcnt(2)
    v_exp_f32 v32, v32
    v_mfma_f32_16x16x32_bf16 v[68:71], a[220:223], v[12:15], v[68:71]
    v_add_f32 v5, v5, v31
    v_mfma_f32_16x16x32_bf16 v[72:75], a[224:227], v[12:15], v[72:75]
    v_exp_f32 v33, v33
    v_mfma_f32_16x16x32_bf16 v[76:79], a[228:231], v[12:15], v[76:79]
    v_add_f32 v5, v5, v32
    v_cvt_pk_bf16_f32 v17, v30, v31
    v_mfma_f32_16x16x32_bf16 v[80:83], a[252:255], v[12:15], v[80:83]
    v_exp_f32 v34, v34
    v_mfma_f32_16x16x32_bf16 v[84:87], a[196:199], v[12:15], v[84:87]
    v_add_f32 v5, v5, v33
    v_mfma_f32_16x16x32_bf16 v[88:91], a[204:207], v[12:15], v[88:91]
    s_waitcnt lgkmcnt(0)
    v_exp_f32 v35, v35
    v_mfma_f32_16x16x32_bf16 v[92:95], a[216:219], v[12:15], v[92:95]
    v_add_f32 v5, v5, v34
    v_cvt_pk_bf16_f32 v18, v32, v33
    v_mfma_f32_16x16x32_bf16 v[28:31], a[232:235], a[48:51], 0
    s_waitcnt vmcnt(8)
    s_barrier
    v_exp_f32 v20, v20
    v_mfma_f32_16x16x32_bf16 v[28:31], a[104:107], a[52:55], v[28:31]
    ds_read_b128 a[100:103], v0 offset:16896
    v_add_f32 v5, v5, v35
    v_mfma_f32_16x16x32_bf16 v[28:31], a[108:111], a[56:59], v[28:31]
    v_exp_f32 v21, v21
    v_mfma_f32_16x16x32_bf16 v[28:31], a[116:119], a[60:63], v[28:31]
    v_cvt_pk_bf16_f32 v19, v34, v35
    v_add_f32 v6, v6, v20
    v_mfma_f32_16x16x32_bf16 v[32:35], a[244:247], a[48:51], 0
    s_add_u32 m0, s21, 16896
    s_add_u32 s20, s20, 8192
    v_exp_f32 v22, v22
    v_mfma_f32_16x16x32_bf16 v[32:35], a[200:203], a[52:55], v[32:35]
    buffer_load_dwordx4 v2, s[8:11], s20 offen nt lds
    v_add_f32 v6, v6, v21
    v_mfma_f32_16x16x32_bf16 v[32:35], a[248:251], a[56:59], v[32:35]
    v_exp_f32 v23, v23
    v_mfma_f32_16x16x32_bf16 v[32:35], a[240:243], a[60:63], v[32:35]
    v_add_f32 v6, v6, v22
    v_cvt_pk_bf16_f32 v12, v20, v21
    v_mfma_f32_16x16x32_bf16 v[96:99], a[120:123], v[16:19], v[96:99]
    v_exp_f32 v24, v24
    v_mfma_f32_16x16x32_bf16 v[100:103], a[220:223], v[16:19], v[100:103]
    ds_read_b128 a[192:195], v0 offset:17024
    v_add_f32 v6, v6, v23
    v_mfma_f32_16x16x32_bf16 v[104:107], a[224:227], v[16:19], v[104:107]
    v_exp_f32 v25, v25
    v_mfma_f32_16x16x32_bf16 v[108:111], a[228:231], v[16:19], v[108:111]
    v_add_f32 v6, v6, v24
    v_cvt_pk_bf16_f32 v13, v22, v23
    v_mfma_f32_16x16x32_bf16 v[112:115], a[252:255], v[16:19], v[112:115]
    v_exp_f32 v26, v26
    v_mfma_f32_16x16x32_bf16 v[116:119], a[196:199], v[16:19], v[116:119]
    ds_read_b64_tr_b16 a[124:125], v1 offset:17440
    v_add_f32 v6, v6, v25
    v_mfma_f32_16x16x32_bf16 v[120:123], a[204:207], v[16:19], v[120:123]
    v_exp_f32 v27, v27
    v_mfma_f32_16x16x32_bf16 v[124:127], a[216:219], v[16:19], v[124:127]
    v_add_f32 v6, v6, v26
    v_cvt_pk_bf16_f32 v14, v24, v25
    v_mfma_f32_16x16x32_bf16 v[20:23], a[232:235], a[64:67], 0
    v_exp_f32 v28, v28
    v_mfma_f32_16x16x32_bf16 v[20:23], a[104:107], a[68:71], v[20:23]
    ds_read_b64_tr_b16 a[126:127], v1 offset:17952
    v_add_f32 v6, v6, v27
    v_mfma_f32_16x16x32_bf16 v[20:23], a[108:111], a[72:75], v[20:23]
    v_exp_f32 v29, v29
    v_mfma_f32_16x16x32_bf16 v[20:23], a[116:119], a[76:79], v[20:23]
    v_cvt_pk_bf16_f32 v15, v26, v27
    v_add_f32 v7, v7, v28
    v_mfma_f32_16x16x32_bf16 v[24:27], a[244:247], a[64:67], 0
    s_add_u32 m0, s21, 19072
    v_exp_f32 v30, v30
    v_mfma_f32_16x16x32_bf16 v[24:27], a[200:203], a[68:71], v[24:27]
    buffer_load_dwordx4 v2, s[8:11], s20 offen offset:2048 nt lds
    v_add_f32 v7, v7, v29
    v_mfma_f32_16x16x32_bf16 v[24:27], a[248:251], a[72:75], v[24:27]
    v_exp_f32 v31, v31
    v_mfma_f32_16x16x32_bf16 v[24:27], a[240:243], a[76:79], v[24:27]
    v_add_f32 v7, v7, v30
    v_cvt_pk_bf16_f32 v16, v28, v29
    v_mfma_f32_16x16x32_bf16 a[128:131], a[120:123], v[12:15], a[128:131]
    v_exp_f32 v32, v32
    v_mfma_f32_16x16x32_bf16 a[132:135], a[220:223], v[12:15], a[132:135]
    ds_read_b128 a[112:115], v0 offset:17088
    v_add_f32 v7, v7, v31
    v_mfma_f32_16x16x32_bf16 a[136:139], a[224:227], v[12:15], a[136:139]
    v_exp_f32 v33, v33
    v_mfma_f32_16x16x32_bf16 a[140:143], a[228:231], v[12:15], a[140:143]
    v_add_f32 v7, v7, v32
    v_cvt_pk_bf16_f32 v17, v30, v31
    v_mfma_f32_16x16x32_bf16 a[144:147], a[252:255], v[12:15], a[144:147]
    v_exp_f32 v34, v34
    v_mfma_f32_16x16x32_bf16 a[148:151], a[196:199], v[12:15], a[148:151]
    ds_read_b64_tr_b16 a[208:209], v1 offset:17504
    v_add_f32 v7, v7, v33
    v_mfma_f32_16x16x32_bf16 a[152:155], a[204:207], v[12:15], a[152:155]
    v_exp_f32 v35, v35
    v_mfma_f32_16x16x32_bf16 a[156:159], a[216:219], v[12:15], a[156:159]
    v_add_f32 v7, v7, v34
    v_cvt_pk_bf16_f32 v18, v32, v33
    v_mfma_f32_16x16x32_bf16 v[28:31], a[232:235], a[80:83], 0
    v_exp_f32 v20, v20
    v_mfma_f32_16x16x32_bf16 v[28:31], a[104:107], a[84:87], v[28:31]
    ds_read_b64_tr_b16 a[210:211], v1 offset:18016
    v_add_f32 v7, v7, v35
    v_mfma_f32_16x16x32_bf16 v[28:31], a[108:111], a[88:91], v[28:31]
    v_exp_f32 v21, v21
    v_mfma_f32_16x16x32_bf16 v[28:31], a[116:119], a[92:95], v[28:31]
    v_cvt_pk_bf16_f32 v19, v34, v35
    v_add_f32 v8, v8, v20
    v_mfma_f32_16x16x32_bf16 v[32:35], a[244:247], a[80:83], 0
    s_add_u32 m0, s39, 85024
    s_add_u32 s25, s25, 8192
    v_exp_f32 v22, v22
    v_mfma_f32_16x16x32_bf16 v[32:35], a[200:203], a[84:87], v[32:35]
    buffer_load_dwordx4 v3, s[12:15], s25 offen nt lds
    v_add_f32 v8, v8, v21
    v_mfma_f32_16x16x32_bf16 v[32:35], a[248:251], a[88:91], v[32:35]
    v_exp_f32 v23, v23
    v_mfma_f32_16x16x32_bf16 v[32:35], a[240:243], a[92:95], v[32:35]
    v_add_f32 v8, v8, v22
    v_cvt_pk_bf16_f32 v12, v20, v21
    v_mfma_f32_16x16x32_bf16 a[160:163], a[120:123], v[16:19], a[160:163]
    v_exp_f32 v24, v24
    v_mfma_f32_16x16x32_bf16 a[164:167], a[220:223], v[16:19], a[164:167]
    ds_read_b128 a[212:215], v0 offset:17408
    v_add_f32 v8, v8, v23
    v_mfma_f32_16x16x32_bf16 a[168:171], a[224:227], v[16:19], a[168:171]
    v_exp_f32 v25, v25
    v_mfma_f32_16x16x32_bf16 a[172:175], a[228:231], v[16:19], a[172:175]
    v_add_f32 v8, v8, v24
    v_cvt_pk_bf16_f32 v13, v22, v23
    v_mfma_f32_16x16x32_bf16 a[176:179], a[252:255], v[16:19], a[176:179]
    v_exp_f32 v26, v26
    v_mfma_f32_16x16x32_bf16 a[180:183], a[196:199], v[16:19], a[180:183]
    ds_read_b64_tr_b16 a[236:237], v1 offset:17512
    v_add_f32 v8, v8, v25
    v_mfma_f32_16x16x32_bf16 a[184:187], a[204:207], v[16:19], a[184:187]
    v_exp_f32 v27, v27
    v_mfma_f32_16x16x32_bf16 a[188:191], a[216:219], v[16:19], a[188:191]
    v_add_f32 v8, v8, v26
    v_cvt_pk_bf16_f32 v14, v24, v25
    v_mfma_f32_16x16x32_bf16 v[20:23], a[232:235], a[96:99], 0
    v_exp_f32 v28, v28
    v_mfma_f32_16x16x32_bf16 v[20:23], a[104:107], v[36:39], v[20:23]
    ds_read_b64_tr_b16 a[238:239], v1 offset:18024
    v_add_f32 v8, v8, v27
    v_mfma_f32_16x16x32_bf16 v[20:23], a[108:111], v[40:43], v[20:23]
    v_exp_f32 v29, v29
    v_mfma_f32_16x16x32_bf16 v[20:23], a[116:119], v[44:47], v[20:23]
    v_cvt_pk_bf16_f32 v15, v26, v27
    v_add_f32 v9, v9, v28
    v_mfma_f32_16x16x32_bf16 v[24:27], a[244:247], a[96:99], 0
    s_add_u32 m0, s39, 88360
    v_exp_f32 v30, v30
    v_mfma_f32_16x16x32_bf16 v[24:27], a[200:203], v[36:39], v[24:27]
    buffer_load_dwordx4 v3, s[12:15], s25 offen offset:1024 nt lds
    v_add_f32 v9, v9, v29
    v_mfma_f32_16x16x32_bf16 v[24:27], a[248:251], v[40:43], v[24:27]
    v_exp_f32 v31, v31
    v_mfma_f32_16x16x32_bf16 v[24:27], a[240:243], v[44:47], v[24:27]
    v_add_f32 v9, v9, v30
    v_cvt_pk_bf16_f32 v16, v28, v29
    v_mfma_f32_16x16x32_bf16 v[128:131], a[120:123], v[12:15], v[128:131]
    s_add_u32 m0, s21, 25344
    s_add_u32 s20, s20, 8192
    v_exp_f32 v32, v32
    v_mfma_f32_16x16x32_bf16 v[132:135], a[220:223], v[12:15], v[132:135]
    buffer_load_dwordx4 v2, s[8:11], s20 offen nt lds
    v_add_f32 v9, v9, v31
    v_mfma_f32_16x16x32_bf16 v[136:139], a[224:227], v[12:15], v[136:139]
    v_exp_f32 v33, v33
    v_mfma_f32_16x16x32_bf16 v[140:143], a[228:231], v[12:15], v[140:143]
    v_add_f32 v9, v9, v32
    v_cvt_pk_bf16_f32 v17, v30, v31
    v_mfma_f32_16x16x32_bf16 v[144:147], a[252:255], v[12:15], v[144:147]
    s_add_u32 m0, s21, 27520
    v_exp_f32 v34, v34
    v_mfma_f32_16x16x32_bf16 v[148:151], a[196:199], v[12:15], v[148:151]
    buffer_load_dwordx4 v2, s[8:11], s20 offen offset:2048 nt lds
    v_add_f32 v9, v9, v33
    v_mfma_f32_16x16x32_bf16 v[152:155], a[204:207], v[12:15], v[152:155]
    v_exp_f32 v35, v35
    v_mfma_f32_16x16x32_bf16 v[156:159], a[216:219], v[12:15], v[156:159]
    v_add_f32 v9, v9, v34
    v_cvt_pk_bf16_f32 v18, v32, v33
    v_mfma_f32_16x16x32_bf16 v[28:31], a[232:235], v[48:51], 0
    v_exp_f32 v20, v20
    v_mfma_f32_16x16x32_bf16 v[28:31], a[104:107], v[52:55], v[28:31]
    ds_read_b128 a[104:107], v0 offset:16960
    v_add_f32 v9, v9, v35
    v_mfma_f32_16x16x32_bf16 v[28:31], a[108:111], v[56:59], v[28:31]
    v_exp_f32 v21, v21
    v_mfma_f32_16x16x32_bf16 v[28:31], a[116:119], v[60:63], v[28:31]
    v_cvt_pk_bf16_f32 v19, v34, v35
    v_add_f32 v10, v10, v20
    v_mfma_f32_16x16x32_bf16 v[32:35], a[244:247], v[48:51], 0
    v_exp_f32 v22, v22
    v_mfma_f32_16x16x32_bf16 v[32:35], a[200:203], v[52:55], v[32:35]
    ds_read_b128 a[200:203], v0 offset:17472
    v_add_f32 v10, v10, v21
    v_mfma_f32_16x16x32_bf16 v[32:35], a[248:251], v[56:59], v[32:35]
    v_exp_f32 v23, v23
    v_mfma_f32_16x16x32_bf16 v[32:35], a[240:243], v[60:63], v[32:35]
    v_add_f32 v10, v10, v22
    v_cvt_pk_bf16_f32 v12, v20, v21
    v_mfma_f32_16x16x32_bf16 v[160:163], a[120:123], v[16:19], v[160:163]
    v_exp_f32 v24, v24
    v_mfma_f32_16x16x32_bf16 v[164:167], a[220:223], v[16:19], v[164:167]
    ds_read_b128 a[108:111], v0 offset:17536
    v_add_f32 v10, v10, v23
    v_mfma_f32_16x16x32_bf16 v[168:171], a[224:227], v[16:19], v[168:171]
    v_exp_f32 v25, v25
    v_mfma_f32_16x16x32_bf16 v[172:175], a[228:231], v[16:19], v[172:175]
    v_add_f32 v10, v10, v24
    v_cvt_pk_bf16_f32 v13, v22, v23
    v_mfma_f32_16x16x32_bf16 v[176:179], a[252:255], v[16:19], v[176:179]
    v_exp_f32 v26, v26
    v_mfma_f32_16x16x32_bf16 v[180:183], a[196:199], v[16:19], v[180:183]
    ds_read_b128 a[116:119], v0 offset:17600
    v_add_f32 v10, v10, v25
    v_mfma_f32_16x16x32_bf16 v[184:187], a[204:207], v[16:19], v[184:187]
    v_exp_f32 v27, v27
    v_mfma_f32_16x16x32_bf16 v[188:191], a[216:219], v[16:19], v[188:191]
    s_waitcnt lgkmcnt(2)
    v_add_f32 v10, v10, v26
    v_cvt_pk_bf16_f32 v14, v24, v25
    v_mfma_f32_16x16x32_bf16 v[20:23], a[100:103], a[0:3], 0
    v_exp_f32 v28, v28
    v_mfma_f32_16x16x32_bf16 v[20:23], a[104:107], a[4:7], v[20:23]
    ds_read_b64_tr_b16 a[232:233], v1 offset:17568
    v_add_f32 v10, v10, v27
    v_mfma_f32_16x16x32_bf16 v[20:23], a[192:195], a[8:11], v[20:23]
    v_exp_f32 v29, v29
    v_mfma_f32_16x16x32_bf16 v[20:23], a[112:115], a[12:15], v[20:23]
    v_cvt_pk_bf16_f32 v15, v26, v27
    v_add_f32 v11, v11, v28
    v_mfma_f32_16x16x32_bf16 v[24:27], a[212:215], a[0:3], 0
    s_waitcnt lgkmcnt(2)
    v_exp_f32 v30, v30
    v_mfma_f32_16x16x32_bf16 v[24:27], a[200:203], a[4:7], v[24:27]
    ds_read_b64_tr_b16 a[234:235], v1 offset:18080
    v_add_f32 v11, v11, v29
    v_mfma_f32_16x16x32_bf16 v[24:27], a[108:111], a[8:11], v[24:27]
    s_waitcnt lgkmcnt(2)
    v_exp_f32 v31, v31
    v_mfma_f32_16x16x32_bf16 v[24:27], a[116:119], a[12:15], v[24:27]
    v_add_f32 v11, v11, v30
    v_cvt_pk_bf16_f32 v16, v28, v29
    v_mfma_f32_16x16x32_bf16 v[192:195], a[120:123], v[12:15], v[192:195]
    v_exp_f32 v32, v32
    v_mfma_f32_16x16x32_bf16 v[196:199], a[220:223], v[12:15], v[196:199]
    ds_read_b64_tr_b16 a[248:249], v1 offset:17576
    v_add_f32 v11, v11, v31
    v_mfma_f32_16x16x32_bf16 v[200:203], a[224:227], v[12:15], v[200:203]
    v_exp_f32 v33, v33
    v_mfma_f32_16x16x32_bf16 v[204:207], a[228:231], v[12:15], v[204:207]
    v_add_f32 v11, v11, v32
    v_cvt_pk_bf16_f32 v17, v30, v31
    v_mfma_f32_16x16x32_bf16 v[208:211], a[252:255], v[12:15], v[208:211]
    v_exp_f32 v34, v34
    v_mfma_f32_16x16x32_bf16 v[212:215], a[196:199], v[12:15], v[212:215]
    ds_read_b64_tr_b16 a[250:251], v1 offset:18088
    v_add_f32 v11, v11, v33
    v_mfma_f32_16x16x32_bf16 v[216:219], a[204:207], v[12:15], v[216:219]
    v_exp_f32 v35, v35
    v_mfma_f32_16x16x32_bf16 v[220:223], a[216:219], v[12:15], v[220:223]
    v_add_f32 v11, v11, v34
    v_cvt_pk_bf16_f32 v18, v32, v33
    v_mfma_f32_16x16x32_bf16 v[28:31], a[100:103], a[16:19], 0
    v_exp_f32 v20, v20
    v_mfma_f32_16x16x32_bf16 v[28:31], a[104:107], a[20:23], v[28:31]
    ds_read_b64_tr_b16 a[240:241], v1 offset:17632
    v_add_f32 v11, v11, v35
    v_mfma_f32_16x16x32_bf16 v[28:31], a[192:195], a[24:27], v[28:31]
    v_exp_f32 v21, v21
    v_mfma_f32_16x16x32_bf16 v[28:31], a[112:115], a[28:31], v[28:31]
    v_cvt_pk_bf16_f32 v19, v34, v35
    v_add_f32 v4, v4, v20
    v_mfma_f32_16x16x32_bf16 v[32:35], a[212:215], a[16:19], 0
    v_exp_f32 v22, v22
    v_mfma_f32_16x16x32_bf16 v[32:35], a[200:203], a[20:23], v[32:35]
    ds_read_b64_tr_b16 a[242:243], v1 offset:18144
    v_add_f32 v4, v4, v21
    v_mfma_f32_16x16x32_bf16 v[32:35], a[108:111], a[24:27], v[32:35]
    v_exp_f32 v23, v23
    v_mfma_f32_16x16x32_bf16 v[32:35], a[116:119], a[28:31], v[32:35]
    v_add_f32 v4, v4, v22
    v_cvt_pk_bf16_f32 v12, v20, v21
    v_mfma_f32_16x16x32_bf16 v[224:227], a[120:123], v[16:19], v[224:227]
    v_exp_f32 v24, v24
    v_mfma_f32_16x16x32_bf16 v[228:231], a[220:223], v[16:19], v[228:231]
    ds_read_b64_tr_b16 a[220:221], v1 offset:17448
    v_add_f32 v4, v4, v23
    v_mfma_f32_16x16x32_bf16 v[232:235], a[224:227], v[16:19], v[232:235]
    v_exp_f32 v25, v25
    v_mfma_f32_16x16x32_bf16 v[236:239], a[228:231], v[16:19], v[236:239]
    v_add_f32 v4, v4, v24
    v_cvt_pk_bf16_f32 v13, v22, v23
    v_mfma_f32_16x16x32_bf16 v[240:243], a[252:255], v[16:19], v[240:243]
    v_exp_f32 v26, v26
    v_mfma_f32_16x16x32_bf16 v[244:247], a[196:199], v[16:19], v[244:247]
    ds_read_b64_tr_b16 a[222:223], v1 offset:17960
    v_add_f32 v4, v4, v25
    v_mfma_f32_16x16x32_bf16 v[248:251], a[204:207], v[16:19], v[248:251]
    v_exp_f32 v27, v27
    v_mfma_f32_16x16x32_bf16 v[252:255], a[216:219], v[16:19], v[252:255]
    v_add_f32 v4, v4, v26
    v_cvt_pk_bf16_f32 v14, v24, v25
    v_mfma_f32_16x16x32_bf16 v[20:23], a[100:103], a[32:35], 0
    v_exp_f32 v28, v28
    v_mfma_f32_16x16x32_bf16 v[20:23], a[104:107], a[36:39], v[20:23]
    ds_read_b64_tr_b16 a[252:253], v1 offset:17640
    v_add_f32 v4, v4, v27
    v_mfma_f32_16x16x32_bf16 v[20:23], a[192:195], a[40:43], v[20:23]
    v_exp_f32 v29, v29
    v_mfma_f32_16x16x32_bf16 v[20:23], a[112:115], a[44:47], v[20:23]
    v_cvt_pk_bf16_f32 v15, v26, v27
    v_add_f32 v5, v5, v28
    v_mfma_f32_16x16x32_bf16 v[24:27], a[212:215], a[32:35], 0
    v_exp_f32 v30, v30
    v_mfma_f32_16x16x32_bf16 v[24:27], a[200:203], a[36:39], v[24:27]
    ds_read_b64_tr_b16 a[254:255], v1 offset:18152
    v_add_f32 v5, v5, v29
    v_mfma_f32_16x16x32_bf16 v[24:27], a[108:111], a[40:43], v[24:27]
    v_exp_f32 v31, v31
    v_mfma_f32_16x16x32_bf16 v[24:27], a[116:119], a[44:47], v[24:27]
    v_add_f32 v5, v5, v30
    v_cvt_pk_bf16_f32 v16, v28, v29
    v_mfma_f32_16x16x32_bf16 v[64:67], a[124:127], v[12:15], v[64:67]
    s_waitcnt lgkmcnt(2)
    s_add_u32 m0, s39, 93744
    s_add_u32 s25, s25, 8192
    v_exp_f32 v32, v32
    v_mfma_f32_16x16x32_bf16 v[68:71], a[220:223], v[12:15], v[68:71]
    buffer_load_dwordx4 v3, s[12:15], s25 offen nt lds
    v_add_f32 v5, v5, v31
    v_mfma_f32_16x16x32_bf16 v[72:75], a[208:211], v[12:15], v[72:75]
    v_exp_f32 v33, v33
    v_mfma_f32_16x16x32_bf16 v[76:79], a[236:239], v[12:15], v[76:79]
    v_add_f32 v5, v5, v32
    v_cvt_pk_bf16_f32 v17, v30, v31
    v_mfma_f32_16x16x32_bf16 v[80:83], a[232:235], v[12:15], v[80:83]
    s_add_u32 m0, s39, 97080
    v_exp_f32 v34, v34
    v_mfma_f32_16x16x32_bf16 v[84:87], a[248:251], v[12:15], v[84:87]
    buffer_load_dwordx4 v3, s[12:15], s25 offen offset:1024 nt lds
    v_add_f32 v5, v5, v33
    v_mfma_f32_16x16x32_bf16 v[88:91], a[240:243], v[12:15], v[88:91]
    s_waitcnt lgkmcnt(0)
    v_exp_f32 v35, v35
    v_mfma_f32_16x16x32_bf16 v[92:95], a[252:255], v[12:15], v[92:95]
    v_add_f32 v5, v5, v34
    v_cvt_pk_bf16_f32 v18, v32, v33
    v_mfma_f32_16x16x32_bf16 v[28:31], a[100:103], a[48:51], 0
    v_exp_f32 v20, v20
    v_mfma_f32_16x16x32_bf16 v[28:31], a[104:107], a[52:55], v[28:31]
    ds_read_b128 a[216:219], v0 offset:25344
    v_add_f32 v5, v5, v35
    v_mfma_f32_16x16x32_bf16 v[28:31], a[192:195], a[56:59], v[28:31]
    v_exp_f32 v21, v21
    v_mfma_f32_16x16x32_bf16 v[28:31], a[112:115], a[60:63], v[28:31]
    v_cvt_pk_bf16_f32 v19, v34, v35
    v_add_f32 v6, v6, v20
    v_mfma_f32_16x16x32_bf16 v[32:35], a[212:215], a[48:51], 0
    v_exp_f32 v22, v22
    v_mfma_f32_16x16x32_bf16 v[32:35], a[200:203], a[52:55], v[32:35]
    v_add_f32 v6, v6, v21
    v_mfma_f32_16x16x32_bf16 v[32:35], a[108:111], a[56:59], v[32:35]
    v_exp_f32 v23, v23
    v_mfma_f32_16x16x32_bf16 v[32:35], a[116:119], a[60:63], v[32:35]
    v_add_f32 v6, v6, v22
    v_cvt_pk_bf16_f32 v12, v20, v21
    v_mfma_f32_16x16x32_bf16 v[96:99], a[124:127], v[16:19], v[96:99]
    v_exp_f32 v24, v24
    v_mfma_f32_16x16x32_bf16 v[100:103], a[220:223], v[16:19], v[100:103]
    ds_read_b128 a[196:199], v0 offset:25472
    v_add_f32 v6, v6, v23
    v_mfma_f32_16x16x32_bf16 v[104:107], a[208:211], v[16:19], v[104:107]
    v_exp_f32 v25, v25
    v_mfma_f32_16x16x32_bf16 v[108:111], a[236:239], v[16:19], v[108:111]
    v_add_f32 v6, v6, v24
    v_cvt_pk_bf16_f32 v13, v22, v23
    v_mfma_f32_16x16x32_bf16 v[112:115], a[232:235], v[16:19], v[112:115]
    v_exp_f32 v26, v26
    v_mfma_f32_16x16x32_bf16 v[116:119], a[248:251], v[16:19], v[116:119]
    ds_read_b64_tr_b16 a[120:121], v1 offset:26160
    v_add_f32 v6, v6, v25
    v_mfma_f32_16x16x32_bf16 v[120:123], a[240:243], v[16:19], v[120:123]
    v_exp_f32 v27, v27
    v_mfma_f32_16x16x32_bf16 v[124:127], a[252:255], v[16:19], v[124:127]
    v_add_f32 v6, v6, v26
    v_cvt_pk_bf16_f32 v14, v24, v25
    v_mfma_f32_16x16x32_bf16 v[20:23], a[100:103], a[64:67], 0
    v_exp_f32 v28, v28
    v_mfma_f32_16x16x32_bf16 v[20:23], a[104:107], a[68:71], v[20:23]
    ds_read_b64_tr_b16 a[122:123], v1 offset:26672
    v_add_f32 v6, v6, v27
    v_mfma_f32_16x16x32_bf16 v[20:23], a[192:195], a[72:75], v[20:23]
    v_exp_f32 v29, v29
    v_mfma_f32_16x16x32_bf16 v[20:23], a[112:115], a[76:79], v[20:23]
    v_cvt_pk_bf16_f32 v15, v26, v27
    v_add_f32 v7, v7, v28
    v_mfma_f32_16x16x32_bf16 v[24:27], a[212:215], a[64:67], 0
    v_exp_f32 v30, v30
    v_mfma_f32_16x16x32_bf16 v[24:27], a[200:203], a[68:71], v[24:27]
    v_add_f32 v7, v7, v29
    v_mfma_f32_16x16x32_bf16 v[24:27], a[108:111], a[72:75], v[24:27]
    v_exp_f32 v31, v31
    v_mfma_f32_16x16x32_bf16 v[24:27], a[116:119], a[76:79], v[24:27]
    v_add_f32 v7, v7, v30
    v_cvt_pk_bf16_f32 v16, v28, v29
    v_mfma_f32_16x16x32_bf16 a[128:131], a[124:127], v[12:15], a[128:131]
    v_exp_f32 v32, v32
    v_mfma_f32_16x16x32_bf16 a[132:135], a[220:223], v[12:15], a[132:135]
    ds_read_b128 a[204:207], v0 offset:25536
    v_add_f32 v7, v7, v31
    v_mfma_f32_16x16x32_bf16 a[136:139], a[208:211], v[12:15], a[136:139]
    v_exp_f32 v33, v33
    v_mfma_f32_16x16x32_bf16 a[140:143], a[236:239], v[12:15], a[140:143]
    v_add_f32 v7, v7, v32
    v_cvt_pk_bf16_f32 v17, v30, v31
    v_mfma_f32_16x16x32_bf16 a[144:147], a[232:235], v[12:15], a[144:147]
    v_exp_f32 v34, v34
    v_mfma_f32_16x16x32_bf16 a[148:151], a[248:251], v[12:15], a[148:151]
    ds_read_b64_tr_b16 a[224:225], v1 offset:26224
    v_add_f32 v7, v7, v33
    v_mfma_f32_16x16x32_bf16 a[152:155], a[240:243], v[12:15], a[152:155]
    v_exp_f32 v35, v35
    v_mfma_f32_16x16x32_bf16 a[156:159], a[252:255], v[12:15], a[156:159]
    v_add_f32 v7, v7, v34
    v_cvt_pk_bf16_f32 v18, v32, v33
    v_mfma_f32_16x16x32_bf16 v[28:31], a[100:103], a[80:83], 0
    v_exp_f32 v20, v20
    v_mfma_f32_16x16x32_bf16 v[28:31], a[104:107], a[84:87], v[28:31]
    ds_read_b64_tr_b16 a[226:227], v1 offset:26736
    v_add_f32 v7, v7, v35
    v_mfma_f32_16x16x32_bf16 v[28:31], a[192:195], a[88:91], v[28:31]
    v_exp_f32 v21, v21
    v_mfma_f32_16x16x32_bf16 v[28:31], a[112:115], a[92:95], v[28:31]
    v_cvt_pk_bf16_f32 v19, v34, v35
    v_add_f32 v8, v8, v20
    v_mfma_f32_16x16x32_bf16 v[32:35], a[212:215], a[80:83], 0
    v_exp_f32 v22, v22
    v_mfma_f32_16x16x32_bf16 v[32:35], a[200:203], a[84:87], v[32:35]
    v_add_f32 v8, v8, v21
    v_mfma_f32_16x16x32_bf16 v[32:35], a[108:111], a[88:91], v[32:35]
    v_exp_f32 v23, v23
    v_mfma_f32_16x16x32_bf16 v[32:35], a[116:119], a[92:95], v[32:35]
    v_add_f32 v8, v8, v22
    v_cvt_pk_bf16_f32 v12, v20, v21
    v_mfma_f32_16x16x32_bf16 a[160:163], a[124:127], v[16:19], a[160:163]
    v_exp_f32 v24, v24
    v_mfma_f32_16x16x32_bf16 a[164:167], a[220:223], v[16:19], a[164:167]
    ds_read_b128 a[244:247], v0 offset:25856
    v_add_f32 v8, v8, v23
    v_mfma_f32_16x16x32_bf16 a[168:171], a[208:211], v[16:19], a[168:171]
    v_exp_f32 v25, v25
    v_mfma_f32_16x16x32_bf16 a[172:175], a[236:239], v[16:19], a[172:175]
    v_add_f32 v8, v8, v24
    v_cvt_pk_bf16_f32 v13, v22, v23
    v_mfma_f32_16x16x32_bf16 a[176:179], a[232:235], v[16:19], a[176:179]
    v_exp_f32 v26, v26
    v_mfma_f32_16x16x32_bf16 a[180:183], a[248:251], v[16:19], a[180:183]
    ds_read_b64_tr_b16 a[228:229], v1 offset:26232
    v_add_f32 v8, v8, v25
    v_mfma_f32_16x16x32_bf16 a[184:187], a[240:243], v[16:19], a[184:187]
    v_exp_f32 v27, v27
    v_mfma_f32_16x16x32_bf16 a[188:191], a[252:255], v[16:19], a[188:191]
    v_add_f32 v8, v8, v26
    v_cvt_pk_bf16_f32 v14, v24, v25
    v_mfma_f32_16x16x32_bf16 v[20:23], a[100:103], a[96:99], 0
    v_exp_f32 v28, v28
    v_mfma_f32_16x16x32_bf16 v[20:23], a[104:107], v[36:39], v[20:23]
    ds_read_b64_tr_b16 a[230:231], v1 offset:26744
    v_add_f32 v8, v8, v27
    v_mfma_f32_16x16x32_bf16 v[20:23], a[192:195], v[40:43], v[20:23]
    v_exp_f32 v29, v29
    v_mfma_f32_16x16x32_bf16 v[20:23], a[112:115], v[44:47], v[20:23]
    v_cvt_pk_bf16_f32 v15, v26, v27
    v_add_f32 v9, v9, v28
    v_mfma_f32_16x16x32_bf16 v[24:27], a[212:215], a[96:99], 0
    v_exp_f32 v30, v30
    v_mfma_f32_16x16x32_bf16 v[24:27], a[200:203], v[36:39], v[24:27]
    v_add_f32 v9, v9, v29
    v_mfma_f32_16x16x32_bf16 v[24:27], a[108:111], v[40:43], v[24:27]
    v_exp_f32 v31, v31
    v_mfma_f32_16x16x32_bf16 v[24:27], a[116:119], v[44:47], v[24:27]
    v_add_f32 v9, v9, v30
    v_cvt_pk_bf16_f32 v16, v28, v29
    v_mfma_f32_16x16x32_bf16 v[128:131], a[124:127], v[12:15], v[128:131]
    v_exp_f32 v32, v32
    v_mfma_f32_16x16x32_bf16 v[132:135], a[220:223], v[12:15], v[132:135]
    v_add_f32 v9, v9, v31
    v_mfma_f32_16x16x32_bf16 v[136:139], a[208:211], v[12:15], v[136:139]
    v_exp_f32 v33, v33
    v_mfma_f32_16x16x32_bf16 v[140:143], a[236:239], v[12:15], v[140:143]
    v_add_f32 v9, v9, v32
    v_cvt_pk_bf16_f32 v17, v30, v31
    v_mfma_f32_16x16x32_bf16 v[144:147], a[232:235], v[12:15], v[144:147]
    v_exp_f32 v34, v34
    v_mfma_f32_16x16x32_bf16 v[148:151], a[248:251], v[12:15], v[148:151]
    v_add_f32 v9, v9, v33
    v_mfma_f32_16x16x32_bf16 v[152:155], a[240:243], v[12:15], v[152:155]
    v_exp_f32 v35, v35
    v_mfma_f32_16x16x32_bf16 v[156:159], a[252:255], v[12:15], v[156:159]
    v_add_f32 v9, v9, v34
    v_cvt_pk_bf16_f32 v18, v32, v33
    v_mfma_f32_16x16x32_bf16 v[28:31], a[100:103], v[48:51], 0
    v_exp_f32 v20, v20
    v_mfma_f32_16x16x32_bf16 v[28:31], a[104:107], v[52:55], v[28:31]
    ds_read_b128 a[104:107], v0 offset:25408
    v_add_f32 v9, v9, v35
    v_mfma_f32_16x16x32_bf16 v[28:31], a[192:195], v[56:59], v[28:31]
    v_exp_f32 v21, v21
    v_mfma_f32_16x16x32_bf16 v[28:31], a[112:115], v[60:63], v[28:31]
    v_cvt_pk_bf16_f32 v19, v34, v35
    v_add_f32 v10, v10, v20
    v_mfma_f32_16x16x32_bf16 v[32:35], a[212:215], v[48:51], 0
    v_exp_f32 v22, v22
    v_mfma_f32_16x16x32_bf16 v[32:35], a[200:203], v[52:55], v[32:35]
    ds_read_b128 a[200:203], v0 offset:25920
    v_add_f32 v10, v10, v21
    v_mfma_f32_16x16x32_bf16 v[32:35], a[108:111], v[56:59], v[32:35]
    v_exp_f32 v23, v23
    v_mfma_f32_16x16x32_bf16 v[32:35], a[116:119], v[60:63], v[32:35]
    v_add_f32 v10, v10, v22
    v_cvt_pk_bf16_f32 v12, v20, v21
    v_mfma_f32_16x16x32_bf16 v[160:163], a[124:127], v[16:19], v[160:163]
    v_exp_f32 v24, v24
    v_mfma_f32_16x16x32_bf16 v[164:167], a[220:223], v[16:19], v[164:167]
    ds_read_b128 a[192:195], v0 offset:25984
    v_add_f32 v10, v10, v23
    v_mfma_f32_16x16x32_bf16 v[168:171], a[208:211], v[16:19], v[168:171]
    v_exp_f32 v25, v25
    v_mfma_f32_16x16x32_bf16 v[172:175], a[236:239], v[16:19], v[172:175]
    v_add_f32 v10, v10, v24
    v_cvt_pk_bf16_f32 v13, v22, v23
    v_mfma_f32_16x16x32_bf16 v[176:179], a[232:235], v[16:19], v[176:179]
    v_exp_f32 v26, v26
    v_mfma_f32_16x16x32_bf16 v[180:183], a[248:251], v[16:19], v[180:183]
    ds_read_b128 a[112:115], v0 offset:26048
    v_add_f32 v10, v10, v25
    v_mfma_f32_16x16x32_bf16 v[184:187], a[240:243], v[16:19], v[184:187]
    v_exp_f32 v27, v27
    v_mfma_f32_16x16x32_bf16 v[188:191], a[252:255], v[16:19], v[188:191]
    s_waitcnt lgkmcnt(2)
    v_add_f32 v10, v10, v26
    v_cvt_pk_bf16_f32 v14, v24, v25
    v_mfma_f32_16x16x32_bf16 v[20:23], a[216:219], a[0:3], 0
    v_exp_f32 v28, v28
    v_mfma_f32_16x16x32_bf16 v[20:23], a[104:107], a[4:7], v[20:23]
    ds_read_b64_tr_b16 a[100:101], v1 offset:26288
    v_add_f32 v10, v10, v27
    v_mfma_f32_16x16x32_bf16 v[20:23], a[196:199], a[8:11], v[20:23]
    v_exp_f32 v29, v29
    v_mfma_f32_16x16x32_bf16 v[20:23], a[204:207], a[12:15], v[20:23]
    v_cvt_pk_bf16_f32 v15, v26, v27
    v_add_f32 v11, v11, v28
    v_mfma_f32_16x16x32_bf16 v[24:27], a[244:247], a[0:3], 0
    s_waitcnt lgkmcnt(2)
    v_exp_f32 v30, v30
    v_mfma_f32_16x16x32_bf16 v[24:27], a[200:203], a[4:7], v[24:27]
    ds_read_b64_tr_b16 a[102:103], v1 offset:26800
    v_add_f32 v11, v11, v29
    v_mfma_f32_16x16x32_bf16 v[24:27], a[192:195], a[8:11], v[24:27]
    s_waitcnt lgkmcnt(2)
    v_exp_f32 v31, v31
    v_mfma_f32_16x16x32_bf16 v[24:27], a[112:115], a[12:15], v[24:27]
    v_add_f32 v11, v11, v30
    v_cvt_pk_bf16_f32 v16, v28, v29
    v_mfma_f32_16x16x32_bf16 v[192:195], a[124:127], v[12:15], v[192:195]
    v_exp_f32 v32, v32
    v_mfma_f32_16x16x32_bf16 v[196:199], a[220:223], v[12:15], v[196:199]
    ds_read_b64_tr_b16 a[108:109], v1 offset:26296
    v_add_f32 v11, v11, v31
    v_mfma_f32_16x16x32_bf16 v[200:203], a[208:211], v[12:15], v[200:203]
    v_exp_f32 v33, v33
    v_mfma_f32_16x16x32_bf16 v[204:207], a[236:239], v[12:15], v[204:207]
    v_add_f32 v11, v11, v32
    v_cvt_pk_bf16_f32 v17, v30, v31
    v_mfma_f32_16x16x32_bf16 v[208:211], a[232:235], v[12:15], v[208:211]
    v_exp_f32 v34, v34
    v_mfma_f32_16x16x32_bf16 v[212:215], a[248:251], v[12:15], v[212:215]
    ds_read_b64_tr_b16 a[110:111], v1 offset:26808
    v_add_f32 v11, v11, v33
    v_mfma_f32_16x16x32_bf16 v[216:219], a[240:243], v[12:15], v[216:219]
    v_exp_f32 v35, v35
    v_mfma_f32_16x16x32_bf16 v[220:223], a[252:255], v[12:15], v[220:223]
    v_add_f32 v11, v11, v34
    v_cvt_pk_bf16_f32 v18, v32, v33
    v_mfma_f32_16x16x32_bf16 v[28:31], a[216:219], a[16:19], 0
    v_exp_f32 v20, v20
    v_mfma_f32_16x16x32_bf16 v[28:31], a[104:107], a[20:23], v[28:31]
    ds_read_b64_tr_b16 a[116:117], v1 offset:26352
    v_add_f32 v11, v11, v35
    v_mfma_f32_16x16x32_bf16 v[28:31], a[196:199], a[24:27], v[28:31]
    v_exp_f32 v21, v21
    v_mfma_f32_16x16x32_bf16 v[28:31], a[204:207], a[28:31], v[28:31]
    v_cvt_pk_bf16_f32 v19, v34, v35
    v_add_f32 v4, v4, v20
    v_mfma_f32_16x16x32_bf16 v[32:35], a[244:247], a[16:19], 0
    v_exp_f32 v22, v22
    v_mfma_f32_16x16x32_bf16 v[32:35], a[200:203], a[20:23], v[32:35]
    ds_read_b64_tr_b16 a[118:119], v1 offset:26864
    v_add_f32 v4, v4, v21
    v_mfma_f32_16x16x32_bf16 v[32:35], a[192:195], a[24:27], v[32:35]
    v_exp_f32 v23, v23
    v_mfma_f32_16x16x32_bf16 v[32:35], a[112:115], a[28:31], v[32:35]
    v_add_f32 v4, v4, v22
    v_cvt_pk_bf16_f32 v12, v20, v21
    v_mfma_f32_16x16x32_bf16 v[224:227], a[124:127], v[16:19], v[224:227]
    v_exp_f32 v24, v24
    v_mfma_f32_16x16x32_bf16 v[228:231], a[220:223], v[16:19], v[228:231]
    ds_read_b64_tr_b16 a[220:221], v1 offset:26168
    v_add_f32 v4, v4, v23
    v_mfma_f32_16x16x32_bf16 v[232:235], a[208:211], v[16:19], v[232:235]
    v_exp_f32 v25, v25
    v_mfma_f32_16x16x32_bf16 v[236:239], a[236:239], v[16:19], v[236:239]
    v_add_f32 v4, v4, v24
    v_cvt_pk_bf16_f32 v13, v22, v23
    v_mfma_f32_16x16x32_bf16 v[240:243], a[232:235], v[16:19], v[240:243]
    v_exp_f32 v26, v26
    v_mfma_f32_16x16x32_bf16 v[244:247], a[248:251], v[16:19], v[244:247]
    ds_read_b64_tr_b16 a[222:223], v1 offset:26680
    v_add_f32 v4, v4, v25
    v_mfma_f32_16x16x32_bf16 v[248:251], a[240:243], v[16:19], v[248:251]
    v_exp_f32 v27, v27
    v_mfma_f32_16x16x32_bf16 v[252:255], a[252:255], v[16:19], v[252:255]
    v_add_f32 v4, v4, v26
    v_cvt_pk_bf16_f32 v14, v24, v25
    v_mfma_f32_16x16x32_bf16 v[20:23], a[216:219], a[32:35], 0
    v_exp_f32 v28, v28
    v_mfma_f32_16x16x32_bf16 v[20:23], a[104:107], a[36:39], v[20:23]
    ds_read_b64_tr_b16 a[232:233], v1 offset:26360
    v_add_f32 v4, v4, v27
    v_mfma_f32_16x16x32_bf16 v[20:23], a[196:199], a[40:43], v[20:23]
    v_exp_f32 v29, v29
    v_mfma_f32_16x16x32_bf16 v[20:23], a[204:207], a[44:47], v[20:23]
    v_cvt_pk_bf16_f32 v15, v26, v27
    v_add_f32 v5, v5, v28
    v_mfma_f32_16x16x32_bf16 v[24:27], a[244:247], a[32:35], 0
    v_exp_f32 v30, v30
    v_mfma_f32_16x16x32_bf16 v[24:27], a[200:203], a[36:39], v[24:27]
    ds_read_b64_tr_b16 a[234:235], v1 offset:26872
    v_add_f32 v5, v5, v29
    v_mfma_f32_16x16x32_bf16 v[24:27], a[192:195], a[40:43], v[24:27]
    v_exp_f32 v31, v31
    v_mfma_f32_16x16x32_bf16 v[24:27], a[112:115], a[44:47], v[24:27]
    v_add_f32 v5, v5, v30
    v_cvt_pk_bf16_f32 v16, v28, v29
    v_mfma_f32_16x16x32_bf16 v[64:67], a[120:123], v[12:15], v[64:67]
    s_waitcnt lgkmcnt(2)
    v_exp_f32 v32, v32
    v_mfma_f32_16x16x32_bf16 v[68:71], a[220:223], v[12:15], v[68:71]
    v_add_f32 v5, v5, v31
    v_add_u32 v0, s40, v0
    v_mfma_f32_16x16x32_bf16 v[72:75], a[224:227], v[12:15], v[72:75]
    v_exp_f32 v33, v33
    v_mfma_f32_16x16x32_bf16 v[76:79], a[228:231], v[12:15], v[76:79]
    v_add_f32 v5, v5, v32
    v_cvt_pk_bf16_f32 v17, v30, v31
    v_mfma_f32_16x16x32_bf16 v[80:83], a[100:103], v[12:15], v[80:83]
    v_exp_f32 v34, v34
    v_mfma_f32_16x16x32_bf16 v[84:87], a[108:111], v[12:15], v[84:87]
    v_add_f32 v5, v5, v33
    v_add_u32 v1, s41, v1
    v_mfma_f32_16x16x32_bf16 v[88:91], a[116:119], v[12:15], v[88:91]
    s_waitcnt lgkmcnt(0)
    s_sub_u32 s40, 0, s40
    v_exp_f32 v35, v35
    v_mfma_f32_16x16x32_bf16 v[92:95], a[232:235], v[12:15], v[92:95]
    s_sub_u32 s41, 0, s41
    v_add_f32 v5, v5, v34
    v_cvt_pk_bf16_f32 v18, v32, v33
    v_mfma_f32_16x16x32_bf16 v[28:31], a[216:219], a[48:51], 0
    s_cmp_lt_u32 s25, 253952
    s_cbranch_scc1 L_loop
    s_waitcnt vmcnt(4)
    s_barrier
    v_exp_f32 v20, v20
    v_mfma_f32_16x16x32_bf16 v[28:31], a[104:107], a[52:55], v[28:31]
    ds_read_b128 a[252:255], v0 offset:0
    v_add_f32 v5, v5, v35
    v_mfma_f32_16x16x32_bf16 v[28:31], a[196:199], a[56:59], v[28:31]
    v_exp_f32 v21, v21
    v_mfma_f32_16x16x32_bf16 v[28:31], a[204:207], a[60:63], v[28:31]
    v_cvt_pk_bf16_f32 v19, v34, v35
    v_add_f32 v6, v6, v20
    v_mfma_f32_16x16x32_bf16 v[32:35], a[244:247], a[48:51], 0
    v_exp_f32 v22, v22
    v_mfma_f32_16x16x32_bf16 v[32:35], a[200:203], a[52:55], v[32:35]
    v_add_f32 v6, v6, v21
    v_mfma_f32_16x16x32_bf16 v[32:35], a[192:195], a[56:59], v[32:35]
    v_exp_f32 v23, v23
    v_mfma_f32_16x16x32_bf16 v[32:35], a[112:115], a[60:63], v[32:35]
    v_add_f32 v6, v6, v22
    v_cvt_pk_bf16_f32 v12, v20, v21
    v_mfma_f32_16x16x32_bf16 v[96:99], a[120:123], v[16:19], v[96:99]
    v_exp_f32 v24, v24
    v_mfma_f32_16x16x32_bf16 v[100:103], a[220:223], v[16:19], v[100:103]
    ds_read_b128 a[248:251], v0 offset:128
    v_add_f32 v6, v6, v23
    v_mfma_f32_16x16x32_bf16 v[104:107], a[224:227], v[16:19], v[104:107]
    v_exp_f32 v25, v25
    v_mfma_f32_16x16x32_bf16 v[108:111], a[228:231], v[16:19], v[108:111]
    v_add_f32 v6, v6, v24
    v_cvt_pk_bf16_f32 v13, v22, v23
    v_mfma_f32_16x16x32_bf16 v[112:115], a[100:103], v[16:19], v[112:115]
    v_exp_f32 v26, v26
    v_mfma_f32_16x16x32_bf16 v[116:119], a[108:111], v[16:19], v[116:119]
    ds_read_b64_tr_b16 a[124:125], v1 offset:0
    v_add_f32 v6, v6, v25
    v_mfma_f32_16x16x32_bf16 v[120:123], a[116:119], v[16:19], v[120:123]
    v_exp_f32 v27, v27
    v_mfma_f32_16x16x32_bf16 v[124:127], a[232:235], v[16:19], v[124:127]
    v_add_f32 v6, v6, v26
    v_cvt_pk_bf16_f32 v14, v24, v25
    v_mfma_f32_16x16x32_bf16 v[20:23], a[216:219], a[64:67], 0
    v_exp_f32 v28, v28
    v_mfma_f32_16x16x32_bf16 v[20:23], a[104:107], a[68:71], v[20:23]
    ds_read_b64_tr_b16 a[126:127], v1 offset:512
    v_add_f32 v6, v6, v27
    v_mfma_f32_16x16x32_bf16 v[20:23], a[196:199], a[72:75], v[20:23]
    v_exp_f32 v29, v29
    v_mfma_f32_16x16x32_bf16 v[20:23], a[204:207], a[76:79], v[20:23]
    v_cvt_pk_bf16_f32 v15, v26, v27
    v_add_f32 v7, v7, v28
    v_mfma_f32_16x16x32_bf16 v[24:27], a[244:247], a[64:67], 0
    v_exp_f32 v30, v30
    v_mfma_f32_16x16x32_bf16 v[24:27], a[200:203], a[68:71], v[24:27]
    v_add_f32 v7, v7, v29
    v_mfma_f32_16x16x32_bf16 v[24:27], a[192:195], a[72:75], v[24:27]
    v_exp_f32 v31, v31
    v_mfma_f32_16x16x32_bf16 v[24:27], a[112:115], a[76:79], v[24:27]
    v_add_f32 v7, v7, v30
    v_cvt_pk_bf16_f32 v16, v28, v29
    v_mfma_f32_16x16x32_bf16 a[128:131], a[120:123], v[12:15], a[128:131]
    v_exp_f32 v32, v32
    v_mfma_f32_16x16x32_bf16 a[132:135], a[220:223], v[12:15], a[132:135]
    ds_read_b128 a[240:243], v0 offset:192
    v_add_f32 v7, v7, v31
    v_mfma_f32_16x16x32_bf16 a[136:139], a[224:227], v[12:15], a[136:139]
    v_exp_f32 v33, v33
    v_mfma_f32_16x16x32_bf16 a[140:143], a[228:231], v[12:15], a[140:143]
    v_add_f32 v7, v7, v32
    v_cvt_pk_bf16_f32 v17, v30, v31
    v_mfma_f32_16x16x32_bf16 a[144:147], a[100:103], v[12:15], a[144:147]
    v_exp_f32 v34, v34
    v_mfma_f32_16x16x32_bf16 a[148:151], a[108:111], v[12:15], a[148:151]
    ds_read_b64_tr_b16 a[208:209], v1 offset:64
    v_add_f32 v7, v7, v33
    v_mfma_f32_16x16x32_bf16 a[152:155], a[116:119], v[12:15], a[152:155]
    v_exp_f32 v35, v35
    v_mfma_f32_16x16x32_bf16 a[156:159], a[232:235], v[12:15], a[156:159]
    v_add_f32 v7, v7, v34
    v_cvt_pk_bf16_f32 v18, v32, v33
    v_mfma_f32_16x16x32_bf16 v[28:31], a[216:219], a[80:83], 0
    v_exp_f32 v20, v20
    v_mfma_f32_16x16x32_bf16 v[28:31], a[104:107], a[84:87], v[28:31]
    ds_read_b64_tr_b16 a[210:211], v1 offset:576
    v_add_f32 v7, v7, v35
    v_mfma_f32_16x16x32_bf16 v[28:31], a[196:199], a[88:91], v[28:31]
    v_exp_f32 v21, v21
    v_mfma_f32_16x16x32_bf16 v[28:31], a[204:207], a[92:95], v[28:31]
    v_cvt_pk_bf16_f32 v19, v34, v35
    v_add_f32 v8, v8, v20
    v_mfma_f32_16x16x32_bf16 v[32:35], a[244:247], a[80:83], 0
    v_exp_f32 v22, v22
    v_mfma_f32_16x16x32_bf16 v[32:35], a[200:203], a[84:87], v[32:35]
    v_add_f32 v8, v8, v21
    v_mfma_f32_16x16x32_bf16 v[32:35], a[192:195], a[88:91], v[32:35]
    v_exp_f32 v23, v23
    v_mfma_f32_16x16x32_bf16 v[32:35], a[112:115], a[92:95], v[32:35]
    v_add_f32 v8, v8, v22
    v_cvt_pk_bf16_f32 v12, v20, v21
    v_mfma_f32_16x16x32_bf16 a[160:163], a[120:123], v[16:19], a[160:163]
    v_exp_f32 v24, v24
    v_mfma_f32_16x16x32_bf16 a[164:167], a[220:223], v[16:19], a[164:167]
    ds_read_b128 a[212:215], v0 offset:512
    v_add_f32 v8, v8, v23
    v_mfma_f32_16x16x32_bf16 a[168:171], a[224:227], v[16:19], a[168:171]
    v_exp_f32 v25, v25
    v_mfma_f32_16x16x32_bf16 a[172:175], a[228:231], v[16:19], a[172:175]
    v_add_f32 v8, v8, v24
    v_cvt_pk_bf16_f32 v13, v22, v23
    v_mfma_f32_16x16x32_bf16 a[176:179], a[100:103], v[16:19], a[176:179]
    v_exp_f32 v26, v26
    v_mfma_f32_16x16x32_bf16 a[180:183], a[108:111], v[16:19], a[180:183]
    ds_read_b64_tr_b16 a[236:237], v1 offset:72
    v_add_f32 v8, v8, v25
    v_mfma_f32_16x16x32_bf16 a[184:187], a[116:119], v[16:19], a[184:187]
    v_exp_f32 v27, v27
    v_mfma_f32_16x16x32_bf16 a[188:191], a[232:235], v[16:19], a[188:191]
    v_add_f32 v8, v8, v26
    v_cvt_pk_bf16_f32 v14, v24, v25
    v_mfma_f32_16x16x32_bf16 v[20:23], a[216:219], a[96:99], 0
    v_exp_f32 v28, v28
    v_mfma_f32_16x16x32_bf16 v[20:23], a[104:107], v[36:39], v[20:23]
    ds_read_b64_tr_b16 a[238:239], v1 offset:584
    v_add_f32 v8, v8, v27
    v_mfma_f32_16x16x32_bf16 v[20:23], a[196:199], v[40:43], v[20:23]
    v_exp_f32 v29, v29
    v_mfma_f32_16x16x32_bf16 v[20:23], a[204:207], v[44:47], v[20:23]
    v_cvt_pk_bf16_f32 v15, v26, v27
    v_add_f32 v9, v9, v28
    v_mfma_f32_16x16x32_bf16 v[24:27], a[244:247], a[96:99], 0
    v_exp_f32 v30, v30
    v_mfma_f32_16x16x32_bf16 v[24:27], a[200:203], v[36:39], v[24:27]
    v_add_f32 v9, v9, v29
    v_mfma_f32_16x16x32_bf16 v[24:27], a[192:195], v[40:43], v[24:27]
    v_exp_f32 v31, v31
    v_mfma_f32_16x16x32_bf16 v[24:27], a[112:115], v[44:47], v[24:27]
    v_add_f32 v9, v9, v30
    v_cvt_pk_bf16_f32 v16, v28, v29
    v_mfma_f32_16x16x32_bf16 v[128:131], a[120:123], v[12:15], v[128:131]
    v_exp_f32 v32, v32
    v_mfma_f32_16x16x32_bf16 v[132:135], a[220:223], v[12:15], v[132:135]
    v_add_f32 v9, v9, v31
    v_mfma_f32_16x16x32_bf16 v[136:139], a[224:227], v[12:15], v[136:139]
    v_exp_f32 v33, v33
    v_mfma_f32_16x16x32_bf16 v[140:143], a[228:231], v[12:15], v[140:143]
    v_add_f32 v9, v9, v32
    v_cvt_pk_bf16_f32 v17, v30, v31
    v_mfma_f32_16x16x32_bf16 v[144:147], a[100:103], v[12:15], v[144:147]
    v_exp_f32 v34, v34
    v_mfma_f32_16x16x32_bf16 v[148:151], a[108:111], v[12:15], v[148:151]
    v_add_f32 v9, v9, v33
    v_mfma_f32_16x16x32_bf16 v[152:155], a[116:119], v[12:15], v[152:155]
    v_exp_f32 v35, v35
    v_mfma_f32_16x16x32_bf16 v[156:159], a[232:235], v[12:15], v[156:159]
    v_add_f32 v9, v9, v34
    v_cvt_pk_bf16_f32 v18, v32, v33
    v_mfma_f32_16x16x32_bf16 v[28:31], a[216:219], v[48:51], 0
    v_exp_f32 v20, v20
    v_mfma_f32_16x16x32_bf16 v[28:31], a[104:107], v[52:55], v[28:31]
    ds_read_b128 a[104:107], v0 offset:64
    v_add_f32 v9, v9, v35
    v_mfma_f32_16x16x32_bf16 v[28:31], a[196:199], v[56:59], v[28:31]
    v_exp_f32 v21, v21
    v_mfma_f32_16x16x32_bf16 v[28:31], a[204:207], v[60:63], v[28:31]
    v_cvt_pk_bf16_f32 v19, v34, v35
    v_add_f32 v10, v10, v20
    v_mfma_f32_16x16x32_bf16 v[32:35], a[244:247], v[48:51], 0
    v_exp_f32 v22, v22
    v_mfma_f32_16x16x32_bf16 v[32:35], a[200:203], v[52:55], v[32:35]
    ds_read_b128 a[200:203], v0 offset:576
    v_add_f32 v10, v10, v21
    v_mfma_f32_16x16x32_bf16 v[32:35], a[192:195], v[56:59], v[32:35]
    v_exp_f32 v23, v23
    v_mfma_f32_16x16x32_bf16 v[32:35], a[112:115], v[60:63], v[32:35]
    v_add_f32 v10, v10, v22
    v_cvt_pk_bf16_f32 v12, v20, v21
    v_mfma_f32_16x16x32_bf16 v[160:163], a[120:123], v[16:19], v[160:163]
    v_exp_f32 v24, v24
    v_mfma_f32_16x16x32_bf16 v[164:167], a[220:223], v[16:19], v[164:167]
    ds_read_b128 a[196:199], v0 offset:640
    v_add_f32 v10, v10, v23
    v_mfma_f32_16x16x32_bf16 v[168:171], a[224:227], v[16:19], v[168:171]
    v_exp_f32 v25, v25
    v_mfma_f32_16x16x32_bf16 v[172:175], a[228:231], v[16:19], v[172:175]
    v_add_f32 v10, v10, v24
    v_cvt_pk_bf16_f32 v13, v22, v23
    v_mfma_f32_16x16x32_bf16 v[176:179], a[100:103], v[16:19], v[176:179]
    v_exp_f32 v26, v26
    v_mfma_f32_16x16x32_bf16 v[180:183], a[108:111], v[16:19], v[180:183]
    ds_read_b128 a[204:207], v0 offset:704
    v_add_f32 v10, v10, v25
    v_mfma_f32_16x16x32_bf16 v[184:187], a[116:119], v[16:19], v[184:187]
    v_exp_f32 v27, v27
    v_mfma_f32_16x16x32_bf16 v[188:191], a[232:235], v[16:19], v[188:191]
    s_waitcnt lgkmcnt(2)
    v_add_f32 v10, v10, v26
    v_cvt_pk_bf16_f32 v14, v24, v25
    v_mfma_f32_16x16x32_bf16 v[20:23], a[252:255], a[0:3], 0
    v_exp_f32 v28, v28
    v_mfma_f32_16x16x32_bf16 v[20:23], a[104:107], a[4:7], v[20:23]
    ds_read_b64_tr_b16 a[216:217], v1 offset:128
    v_add_f32 v10, v10, v27
    v_mfma_f32_16x16x32_bf16 v[20:23], a[248:251], a[8:11], v[20:23]
    v_exp_f32 v29, v29
    v_mfma_f32_16x16x32_bf16 v[20:23], a[240:243], a[12:15], v[20:23]
    v_cvt_pk_bf16_f32 v15, v26, v27
    v_add_f32 v11, v11, v28
    v_mfma_f32_16x16x32_bf16 v[24:27], a[212:215], a[0:3], 0
    s_waitcnt lgkmcnt(2)
    v_exp_f32 v30, v30
    v_mfma_f32_16x16x32_bf16 v[24:27], a[200:203], a[4:7], v[24:27]
    ds_read_b64_tr_b16 a[218:219], v1 offset:640
    v_add_f32 v11, v11, v29
    v_mfma_f32_16x16x32_bf16 v[24:27], a[196:199], a[8:11], v[24:27]
    s_waitcnt lgkmcnt(2)
    v_exp_f32 v31, v31
    v_mfma_f32_16x16x32_bf16 v[24:27], a[204:207], a[12:15], v[24:27]
    v_add_f32 v11, v11, v30
    v_cvt_pk_bf16_f32 v16, v28, v29
    v_mfma_f32_16x16x32_bf16 v[192:195], a[120:123], v[12:15], v[192:195]
    v_exp_f32 v32, v32
    v_mfma_f32_16x16x32_bf16 v[196:199], a[220:223], v[12:15], v[196:199]
    ds_read_b64_tr_b16 a[192:193], v1 offset:136
    v_add_f32 v11, v11, v31
    v_mfma_f32_16x16x32_bf16 v[200:203], a[224:227], v[12:15], v[200:203]
    v_exp_f32 v33, v33
    v_mfma_f32_16x16x32_bf16 v[204:207], a[228:231], v[12:15], v[204:207]
    v_add_f32 v11, v11, v32
    v_cvt_pk_bf16_f32 v17, v30, v31
    v_mfma_f32_16x16x32_bf16 v[208:211], a[100:103], v[12:15], v[208:211]
    v_exp_f32 v34, v34
    v_mfma_f32_16x16x32_bf16 v[212:215], a[108:111], v[12:15], v[212:215]
    ds_read_b64_tr_b16 a[194:195], v1 offset:648
    v_add_f32 v11, v11, v33
    v_mfma_f32_16x16x32_bf16 v[216:219], a[116:119], v[12:15], v[216:219]
    v_exp_f32 v35, v35
    v_mfma_f32_16x16x32_bf16 v[220:223], a[232:235], v[12:15], v[220:223]
    v_add_f32 v11, v11, v34
    v_cvt_pk_bf16_f32 v18, v32, v33
    v_mfma_f32_16x16x32_bf16 v[28:31], a[252:255], a[16:19], 0
    v_exp_f32 v20, v20
    v_mfma_f32_16x16x32_bf16 v[28:31], a[104:107], a[20:23], v[28:31]
    ds_read_b64_tr_b16 a[112:113], v1 offset:192
    v_add_f32 v11, v11, v35
    v_mfma_f32_16x16x32_bf16 v[28:31], a[248:251], a[24:27], v[28:31]
    v_exp_f32 v21, v21
    v_mfma_f32_16x16x32_bf16 v[28:31], a[240:243], a[28:31], v[28:31]
    v_cvt_pk_bf16_f32 v19, v34, v35
    v_add_f32 v4, v4, v20
    v_mfma_f32_16x16x32_bf16 v[32:35], a[212:215], a[16:19], 0
    v_exp_f32 v22, v22
    v_mfma_f32_16x16x32_bf16 v[32:35], a[200:203], a[20:23], v[32:35]
    ds_read_b64_tr_b16 a[114:115], v1 offset:704
    v_add_f32 v4, v4, v21
    v_mfma_f32_16x16x32_bf16 v[32:35], a[196:199], a[24:27], v[32:35]
    v_exp_f32 v23, v23
    v_mfma_f32_16x16x32_bf16 v[32:35], a[204:207], a[28:31], v[32:35]
    ds_read_b128 a[244:247], v0 offset:8448
    v_add_f32 v4, v4, v22
    v_cvt_pk_bf16_f32 v12, v20, v21
    v_mfma_f32_16x16x32_bf16 v[224:227], a[120:123], v[16:19], v[224:227]
    v_exp_f32 v24, v24
    v_mfma_f32_16x16x32_bf16 v[228:231], a[220:223], v[16:19], v[228:231]
    ds_read_b64_tr_b16 a[220:221], v1 offset:8
    ds_read_b128 a[252:255], v0 offset:8512
    ds_read_b128 a[104:107], v0 offset:8576
    v_add_f32 v4, v4, v23
    v_mfma_f32_16x16x32_bf16 v[232:235], a[224:227], v[16:19], v[232:235]
    v_exp_f32 v25, v25
    v_mfma_f32_16x16x32_bf16 v[236:239], a[228:231], v[16:19], v[236:239]
    ds_read_b128 a[248:251], v0 offset:8640
    ds_read_b128 a[240:243], v0 offset:8960
    v_add_f32 v4, v4, v24
    v_cvt_pk_bf16_f32 v13, v22, v23
    v_mfma_f32_16x16x32_bf16 v[240:243], a[100:103], v[16:19], v[240:243]
    v_exp_f32 v26, v26
    v_mfma_f32_16x16x32_bf16 v[244:247], a[108:111], v[16:19], v[244:247]
    ds_read_b64_tr_b16 a[222:223], v1 offset:520
    ds_read_b128 a[212:215], v0 offset:9024
    ds_read_b128 a[200:203], v0 offset:9088
    v_add_f32 v4, v4, v25
    v_mfma_f32_16x16x32_bf16 v[248:251], a[116:119], v[16:19], v[248:251]
    s_waitcnt lgkmcnt(8)
    v_exp_f32 v27, v27
    v_mfma_f32_16x16x32_bf16 v[252:255], a[232:235], v[16:19], v[252:255]
    ds_read_b128 a[196:199], v0 offset:9152
    v_add_f32 v4, v4, v26
    v_cvt_pk_bf16_f32 v14, v24, v25
    v_mfma_f32_16x16x32_bf16 v[20:23], a[244:247], a[0:3], 0
    s_waitcnt lgkmcnt(6)
    v_exp_f32 v28, v28
    v_mfma_f32_16x16x32_bf16 v[20:23], a[252:255], a[4:7], v[20:23]
    ds_read_b64_tr_b16 a[100:101], v1 offset:200
    v_add_f32 v4, v4, v27
    v_mfma_f32_16x16x32_bf16 v[20:23], a[104:107], a[8:11], v[20:23]
    s_waitcnt lgkmcnt(6)
    v_exp_f32 v29, v29
    v_mfma_f32_16x16x32_bf16 v[20:23], a[248:251], a[12:15], v[20:23]
    s_waitcnt lgkmcnt(5)
    v_cvt_pk_bf16_f32 v15, v26, v27
    v_add_f32 v5, v5, v28
    v_mfma_f32_16x16x32_bf16 v[24:27], a[240:243], a[0:3], 0
    s_waitcnt lgkmcnt(2)
    v_exp_f32 v30, v30
    v_mfma_f32_16x16x32_bf16 v[24:27], a[212:215], a[4:7], v[24:27]
    ds_read_b64_tr_b16 a[102:103], v1 offset:712
    v_add_f32 v5, v5, v29
    v_mfma_f32_16x16x32_bf16 v[24:27], a[200:203], a[8:11], v[24:27]
    s_waitcnt lgkmcnt(2)
    v_exp_f32 v31, v31
    v_mfma_f32_16x16x32_bf16 v[24:27], a[196:199], a[12:15], v[24:27]
    v_add_f32 v5, v5, v30
    v_cvt_pk_bf16_f32 v16, v28, v29
    v_mfma_f32_16x16x32_bf16 v[64:67], a[124:127], v[12:15], v[64:67]
    v_exp_f32 v32, v32
    v_mfma_f32_16x16x32_bf16 v[68:71], a[220:223], v[12:15], v[68:71]
    ds_read_b128 a[204:207], v0 offset:16896
    v_add_f32 v5, v5, v31
    v_mfma_f32_16x16x32_bf16 v[72:75], a[208:211], v[12:15], v[72:75]
    v_exp_f32 v33, v33
    v_mfma_f32_16x16x32_bf16 v[76:79], a[236:239], v[12:15], v[76:79]
    v_add_f32 v5, v5, v32
    v_cvt_pk_bf16_f32 v17, v30, v31
    v_mfma_f32_16x16x32_bf16 v[80:83], a[216:219], v[12:15], v[80:83]
    v_exp_f32 v34, v34
    v_mfma_f32_16x16x32_bf16 v[84:87], a[192:195], v[12:15], v[84:87]
    ds_read_b128 a[120:123], v0 offset:16960
    v_add_f32 v5, v5, v33
    v_mfma_f32_16x16x32_bf16 v[88:91], a[112:115], v[12:15], v[88:91]
    s_waitcnt lgkmcnt(2)
    v_exp_f32 v35, v35
    v_mfma_f32_16x16x32_bf16 v[92:95], a[100:103], v[12:15], v[92:95]
    v_add_f32 v5, v5, v34
    v_cvt_pk_bf16_f32 v18, v32, v33
    v_mfma_f32_16x16x32_bf16 v[28:31], a[244:247], a[16:19], 0
    v_exp_f32 v20, v20
    v_mfma_f32_16x16x32_bf16 v[28:31], a[252:255], a[20:23], v[28:31]
    ds_read_b128 a[224:227], v0 offset:17024
    v_add_f32 v5, v5, v35
    v_mfma_f32_16x16x32_bf16 v[28:31], a[104:107], a[24:27], v[28:31]
    v_exp_f32 v21, v21
    v_mfma_f32_16x16x32_bf16 v[28:31], a[248:251], a[28:31], v[28:31]
    v_cvt_pk_bf16_f32 v19, v34, v35
    v_add_f32 v4, v4, v20
    v_mfma_f32_16x16x32_bf16 v[32:35], a[240:243], a[16:19], 0
    v_exp_f32 v22, v22
    v_mfma_f32_16x16x32_bf16 v[32:35], a[212:215], a[20:23], v[32:35]
    ds_read_b128 a[228:231], v0 offset:17088
    v_add_f32 v4, v4, v21
    v_mfma_f32_16x16x32_bf16 v[32:35], a[200:203], a[24:27], v[32:35]
    v_exp_f32 v23, v23
    v_mfma_f32_16x16x32_bf16 v[32:35], a[196:199], a[28:31], v[32:35]
    v_add_f32 v4, v4, v22
    v_cvt_pk_bf16_f32 v12, v20, v21
    v_mfma_f32_16x16x32_bf16 v[96:99], a[124:127], v[16:19], v[96:99]
    s_waitcnt vmcnt(0)
    s_barrier
    v_exp_f32 v24, v24
    v_mfma_f32_16x16x32_bf16 v[100:103], a[220:223], v[16:19], v[100:103]
    ds_read_b128 a[108:111], v0 offset:17408
    ds_read_b128 a[116:119], v0 offset:17472
    ds_read_b128 a[232:235], v0 offset:17536
    v_add_f32 v4, v4, v23
    v_mfma_f32_16x16x32_bf16 v[104:107], a[208:211], v[16:19], v[104:107]
    v_exp_f32 v25, v25
    v_mfma_f32_16x16x32_bf16 v[108:111], a[236:239], v[16:19], v[108:111]
    ds_read_b128 a[244:247], v0 offset:17600
    ds_read_b64_tr_b16 a[252:253], v1 offset:8720
    v_add_f32 v4, v4, v24
    v_cvt_pk_bf16_f32 v13, v22, v23
    v_mfma_f32_16x16x32_bf16 v[112:115], a[216:219], v[16:19], v[112:115]
    v_exp_f32 v26, v26
    v_mfma_f32_16x16x32_bf16 v[116:119], a[192:195], v[16:19], v[116:119]
    ds_read_b64_tr_b16 a[254:255], v1 offset:9232
    ds_read_b64_tr_b16 a[104:105], v1 offset:8728
    ds_read_b64_tr_b16 a[106:107], v1 offset:9240
    v_add_f32 v4, v4, v25
    v_mfma_f32_16x16x32_bf16 v[120:123], a[112:115], v[16:19], v[120:123]
    s_waitcnt lgkmcnt(8)
    v_exp_f32 v27, v27
    v_mfma_f32_16x16x32_bf16 v[124:127], a[100:103], v[16:19], v[124:127]
    ds_read_b64_tr_b16 a[248:249], v1 offset:8784
    ds_read_b64_tr_b16 a[250:251], v1 offset:9296
    v_add_f32 v4, v4, v26
    v_cvt_pk_bf16_f32 v14, v24, v25
    v_mfma_f32_16x16x32_bf16 v[20:23], a[204:207], a[0:3], 0
    v_exp_f32 v28, v28
    v_mfma_f32_16x16x32_bf16 v[20:23], a[120:123], a[4:7], v[20:23]
    ds_read_b64_tr_b16 a[240:241], v1 offset:8792
    ds_read_b64_tr_b16 a[242:243], v1 offset:9304
    ds_read_b64_tr_b16 a[212:213], v1 offset:8848
    v_add_f32 v4, v4, v27
    v_mfma_f32_16x16x32_bf16 v[20:23], a[224:227], a[8:11], v[20:23]
    s_waitcnt lgkmcnt(10)
    v_exp_f32 v29, v29
    v_mfma_f32_16x16x32_bf16 v[20:23], a[228:231], a[12:15], v[20:23]
    ds_read_b64_tr_b16 a[214:215], v1 offset:9360
    ds_read_b64_tr_b16 a[200:201], v1 offset:8856
    v_cvt_pk_bf16_f32 v15, v26, v27
    v_add_f32 v5, v5, v28
    v_mfma_f32_16x16x32_bf16 v[24:27], a[108:111], a[0:3], 0
    v_exp_f32 v30, v30
    v_mfma_f32_16x16x32_bf16 v[24:27], a[116:119], a[4:7], v[24:27]
    ds_read_b64_tr_b16 a[202:203], v1 offset:9368
    ds_read_b64_tr_b16 a[196:197], v1 offset:8912
    ds_read_b64_tr_b16 a[198:199], v1 offset:9424
    v_add_f32 v5, v5, v29
    v_mfma_f32_16x16x32_bf16 v[24:27], a[232:235], a[8:11], v[24:27]
    s_waitcnt lgkmcnt(10)
    v_exp_f32 v31, v31
    v_mfma_f32_16x16x32_bf16 v[24:27], a[244:247], a[12:15], v[24:27]
    ds_read_b64_tr_b16 a[124:125], v1 offset:8920
    ds_read_b64_tr_b16 a[126:127], v1 offset:9432
    v_add_f32 v5, v5, v30
    v_cvt_pk_bf16_f32 v16, v28, v29
    v_mfma_f32_16x16x32_bf16 v[64:67], a[252:255], v[12:15], v[64:67]
    s_waitcnt lgkmcnt(10)
    v_exp_f32 v32, v32
    v_mfma_f32_16x16x32_bf16 v[68:71], a[104:107], v[12:15], v[68:71]
    ds_read_b128 a[220:223], v0 offset:25344
    v_add_f32 v5, v5, v31
    v_mfma_f32_16x16x32_bf16 v[72:75], a[248:251], v[12:15], v[72:75]
    s_waitcnt lgkmcnt(8)
    v_exp_f32 v33, v33
    v_mfma_f32_16x16x32_bf16 v[76:79], a[240:243], v[12:15], v[76:79]
    s_waitcnt lgkmcnt(6)
    v_add_f32 v5, v5, v32
    v_cvt_pk_bf16_f32 v17, v30, v31
    v_mfma_f32_16x16x32_bf16 v[80:83], a[212:215], v[12:15], v[80:83]
    s_waitcnt lgkmcnt(3)
    v_exp_f32 v34, v34
    v_mfma_f32_16x16x32_bf16 v[84:87], a[200:203], v[12:15], v[84:87]
    ds_read_b128 a[208:211], v0 offset:25408
    v_add_f32 v5, v5, v33
    v_mfma_f32_16x16x32_bf16 v[88:91], a[196:199], v[12:15], v[88:91]
    s_waitcnt lgkmcnt(2)
    v_exp_f32 v35, v35
    v_mfma_f32_16x16x32_bf16 v[92:95], a[124:127], v[12:15], v[92:95]
    v_add_f32 v5, v5, v34
    v_cvt_pk_bf16_f32 v18, v32, v33
    v_mfma_f32_16x16x32_bf16 v[28:31], a[204:207], a[16:19], 0
    v_exp_f32 v20, v20
    v_mbcnt_lo_u32_b32 v3, -1, 0
    v_mbcnt_hi_u32_b32 v3, -1, v3
    v_mfma_f32_16x16x32_bf16 v[28:31], a[120:123], a[20:23], v[28:31]
    ds_read_b128 a[236:239], v0 offset:25472
    v_add_f32 v5, v5, v35
    v_and_b32 v2, 15, v3
    v_lshrrev_b32 v3, 4, v3
    v_mfma_f32_16x16x32_bf16 v[28:31], a[224:227], a[24:27], v[28:31]
    v_exp_f32 v21, v21
    s_lshl_b32 s28, s3, 7
    v_add_u32 v2, s28, v2
    v_mfma_f32_16x16x32_bf16 v[28:31], a[228:231], a[28:31], v[28:31]
    v_cvt_pk_bf16_f32 v19, v34, v35
    v_add_f32 v4, v4, v20
    v_lshlrev_b32 v2, 8, v2
    v_lshl_add_u32 v2, v3, 4, v2
    v_mfma_f32_16x16x32_bf16 v[32:35], a[108:111], a[16:19], 0
    v_exp_f32 v22, v22
    v_mfma_f32_16x16x32_bf16 v[32:35], a[116:119], a[20:23], v[32:35]
    ds_read_b128 a[216:219], v0 offset:25536
    v_add_f32 v4, v4, v21
    v_mfma_f32_16x16x32_bf16 v[32:35], a[232:235], a[24:27], v[32:35]
    v_exp_f32 v23, v23
    v_mfma_f32_16x16x32_bf16 v[32:35], a[244:247], a[28:31], v[32:35]
    v_add_f32 v4, v4, v22
    v_cvt_pk_bf16_f32 v12, v20, v21
    v_mfma_f32_16x16x32_bf16 v[96:99], a[252:255], v[16:19], v[96:99]
    v_exp_f32 v24, v24
    v_mfma_f32_16x16x32_bf16 v[100:103], a[104:107], v[16:19], v[100:103]
    ds_read_b128 a[192:195], v0 offset:25856
    ds_read_b128 a[112:115], v0 offset:25920
    ds_read_b128 a[100:103], v0 offset:25984
    v_add_f32 v4, v4, v23
    v_mfma_f32_16x16x32_bf16 v[104:107], a[248:251], v[16:19], v[104:107]
    v_exp_f32 v25, v25
    v_mfma_f32_16x16x32_bf16 v[108:111], a[240:243], v[16:19], v[108:111]
    ds_read_b128 a[204:207], v0 offset:26048
    ds_read_b64_tr_b16 a[120:121], v1 offset:17440
    v_add_f32 v4, v4, v24
    v_cvt_pk_bf16_f32 v13, v22, v23
    v_mfma_f32_16x16x32_bf16 v[112:115], a[212:215], v[16:19], v[112:115]
    v_exp_f32 v26, v26
    v_mfma_f32_16x16x32_bf16 v[116:119], a[200:203], v[16:19], v[116:119]
    ds_read_b64_tr_b16 a[122:123], v1 offset:17952
    ds_read_b64_tr_b16 a[224:225], v1 offset:17448
    ds_read_b64_tr_b16 a[226:227], v1 offset:17960
    v_add_f32 v4, v4, v25
    v_mfma_f32_16x16x32_bf16 v[120:123], a[196:199], v[16:19], v[120:123]
    s_waitcnt lgkmcnt(8)
    v_exp_f32 v27, v27
    v_mfma_f32_16x16x32_bf16 v[124:127], a[124:127], v[16:19], v[124:127]
    ds_read_b64_tr_b16 a[228:229], v1 offset:17504
    ds_read_b64_tr_b16 a[230:231], v1 offset:18016
    v_add_f32 v4, v4, v26
    v_cvt_pk_bf16_f32 v14, v24, v25
    v_mfma_f32_16x16x32_bf16 v[20:23], a[220:223], a[0:3], 0
    v_exp_f32 v28, v28
    v_mfma_f32_16x16x32_bf16 v[20:23], a[208:211], a[4:7], v[20:23]
    ds_read_b64_tr_b16 a[108:109], v1 offset:17512
    ds_read_b64_tr_b16 a[110:111], v1 offset:18024
    ds_read_b64_tr_b16 a[116:117], v1 offset:17568
    v_add_f32 v4, v4, v27
    v_mfma_f32_16x16x32_bf16 v[20:23], a[236:239], a[8:11], v[20:23]
    s_waitcnt lgkmcnt(10)
    v_exp_f32 v29, v29
    v_mfma_f32_16x16x32_bf16 v[20:23], a[216:219], a[12:15], v[20:23]
    ds_read_b64_tr_b16 a[118:119], v1 offset:18080
    ds_read_b64_tr_b16 a[232:233], v1 offset:17576
    v_cvt_pk_bf16_f32 v15, v26, v27
    v_add_f32 v5, v5, v28
    v_mfma_f32_16x16x32_bf16 v[24:27], a[192:195], a[0:3], 0
    v_exp_f32 v30, v30
    v_mfma_f32_16x16x32_bf16 v[24:27], a[112:115], a[4:7], v[24:27]
    ds_read_b64_tr_b16 a[234:235], v1 offset:18088
    ds_read_b64_tr_b16 a[244:245], v1 offset:17632
    ds_read_b64_tr_b16 a[246:247], v1 offset:18144
    v_add_f32 v5, v5, v29
    v_mfma_f32_16x16x32_bf16 v[24:27], a[100:103], a[8:11], v[24:27]
    s_waitcnt lgkmcnt(10)
    v_exp_f32 v31, v31
    v_mfma_f32_16x16x32_bf16 v[24:27], a[204:207], a[12:15], v[24:27]
    ds_read_b64_tr_b16 a[252:253], v1 offset:17640
    ds_read_b64_tr_b16 a[254:255], v1 offset:18152
    v_add_f32 v5, v5, v30
    v_cvt_pk_bf16_f32 v16, v28, v29
    v_mfma_f32_16x16x32_bf16 v[64:67], a[120:123], v[12:15], v[64:67]
    s_waitcnt lgkmcnt(10)
    v_exp_f32 v32, v32
    v_mov_b32 v3, 0x3f803f80
    v_accvgpr_write_b32 a4, v3
    v_mfma_f32_16x16x32_bf16 v[68:71], a[224:227], v[12:15], v[68:71]
    ds_read_b64_tr_b16 a[104:105], v1 offset:26160
    v_add_f32 v5, v5, v31
    v_accvgpr_write_b32 a5, v3
    v_accvgpr_write_b32 a6, v3
    v_mfma_f32_16x16x32_bf16 v[72:75], a[228:231], v[12:15], v[72:75]
    s_waitcnt lgkmcnt(8)
    v_exp_f32 v33, v33
    v_accvgpr_write_b32 a7, v3
    v_mfma_f32_16x16x32_bf16 v[76:79], a[108:111], v[12:15], v[76:79]
    s_waitcnt lgkmcnt(6)
    v_add_f32 v5, v5, v32
    v_cvt_pk_bf16_f32 v17, v30, v31
    v_mfma_f32_16x16x32_bf16 v[80:83], a[116:119], v[12:15], v[80:83]
    s_waitcnt lgkmcnt(3)
    v_exp_f32 v34, v34
    v_mfma_f32_16x16x32_bf16 v[84:87], a[232:235], v[12:15], v[84:87]
    ds_read_b64_tr_b16 a[106:107], v1 offset:26672
    v_add_f32 v5, v5, v33
    v_mfma_f32_16x16x32_bf16 v[88:91], a[244:247], v[12:15], v[88:91]
    s_waitcnt lgkmcnt(2)
    v_exp_f32 v35, v35
    v_mfma_f32_16x16x32_bf16 v[92:95], a[252:255], v[12:15], v[92:95]
    v_add_f32 v5, v5, v34
    v_cvt_pk_bf16_f32 v18, v32, v33
    v_mfma_f32_16x16x32_bf16 v[28:31], a[220:223], a[16:19], 0
    v_exp_f32 v20, v20
    v_mfma_f32_16x16x32_bf16 v[28:31], a[208:211], a[20:23], v[28:31]
    ds_read_b64_tr_b16 a[248:249], v1 offset:26168
    v_add_f32 v5, v5, v35
    v_mfma_f32_16x16x32_bf16 v[28:31], a[236:239], a[24:27], v[28:31]
    v_exp_f32 v21, v21
    v_mfma_f32_16x16x32_bf16 v[28:31], a[216:219], a[28:31], v[28:31]
    v_cvt_pk_bf16_f32 v19, v34, v35
    v_add_f32 v4, v4, v20
    v_mfma_f32_16x16x32_bf16 v[32:35], a[192:195], a[16:19], 0
    v_exp_f32 v22, v22
    v_mfma_f32_16x16x32_bf16 v[32:35], a[112:115], a[20:23], v[32:35]
    ds_read_b64_tr_b16 a[250:251], v1 offset:26680
    v_add_f32 v4, v4, v21
    v_mfma_f32_16x16x32_bf16 v[32:35], a[100:103], a[24:27], v[32:35]
    v_exp_f32 v23, v23
    v_mfma_f32_16x16x32_bf16 v[32:35], a[204:207], a[28:31], v[32:35]
    v_add_f32 v4, v4, v22
    v_cvt_pk_bf16_f32 v12, v20, v21
    v_mfma_f32_16x16x32_bf16 v[96:99], a[120:123], v[16:19], v[96:99]
    v_exp_f32 v24, v24
    v_mfma_f32_16x16x32_bf16 v[100:103], a[224:227], v[16:19], v[100:103]
    ds_read_b64_tr_b16 a[240:241], v1 offset:26224
    v_add_f32 v4, v4, v23
    v_mfma_f32_16x16x32_bf16 v[104:107], a[228:231], v[16:19], v[104:107]
    v_exp_f32 v25, v25
    v_mfma_f32_16x16x32_bf16 v[108:111], a[108:111], v[16:19], v[108:111]
    v_add_f32 v4, v4, v24
    v_cvt_pk_bf16_f32 v13, v22, v23
    v_mfma_f32_16x16x32_bf16 v[112:115], a[116:119], v[16:19], v[112:115]
    v_exp_f32 v26, v26
    v_mfma_f32_16x16x32_bf16 v[116:119], a[232:235], v[16:19], v[116:119]
    ds_read_b64_tr_b16 a[242:243], v1 offset:26736
    v_add_f32 v4, v4, v25
    v_mfma_f32_16x16x32_bf16 v[120:123], a[244:247], v[16:19], v[120:123]
    v_exp_f32 v27, v27
    v_mfma_f32_16x16x32_bf16 v[124:127], a[252:255], v[16:19], v[124:127]
    v_add_f32 v4, v4, v26
    v_cvt_pk_bf16_f32 v14, v24, v25
    v_mfma_f32_16x16x32_bf16 v[20:23], a[220:223], a[32:35], 0
    v_exp_f32 v28, v28
    v_mfma_f32_16x16x32_bf16 v[20:23], a[208:211], a[36:39], v[20:23]
    ds_read_b64_tr_b16 a[212:213], v1 offset:26232
    ds_read_b64_tr_b16 a[214:215], v1 offset:26744
    ds_read_b64_tr_b16 a[200:201], v1 offset:26288
    v_add_f32 v4, v4, v27
    v_mfma_f32_16x16x32_bf16 v[20:23], a[236:239], a[40:43], v[20:23]
    v_exp_f32 v29, v29
    v_mov_b32 v3, v4
    s_nop 1
    v_permlane32_swap_b32 v3, v4
    v_mfma_f32_16x16x32_bf16 v[20:23], a[216:219], a[44:47], v[20:23]
    ds_read_b64_tr_b16 a[202:203], v1 offset:26800
    ds_read_b64_tr_b16 a[196:197], v1 offset:26296
    v_cvt_pk_bf16_f32 v15, v26, v27
    v_add_f32 v5, v5, v28
    v_mfma_f32_16x16x32_bf16 v[24:27], a[192:195], a[32:35], 0
    v_exp_f32 v30, v30
    v_add_f32 v4, v4, v3
    v_mfma_f32_16x16x32_bf16 v[24:27], a[112:115], a[36:39], v[24:27]
    ds_read_b64_tr_b16 a[198:199], v1 offset:26808
    ds_read_b64_tr_b16 a[124:125], v1 offset:26352
    ds_read_b64_tr_b16 a[126:127], v1 offset:26864
    v_add_f32 v5, v5, v29
    v_mov_b32 v3, v4
    v_mfma_f32_16x16x32_bf16 v[24:27], a[100:103], a[40:43], v[24:27]
    s_waitcnt lgkmcnt(8)
    v_exp_f32 v31, v31
    v_permlane16_swap_b32 v3, v4
    v_mfma_f32_16x16x32_bf16 v[24:27], a[204:207], a[44:47], v[24:27]
    ds_read_b64_tr_b16 a[16:17], v1 offset:26360
    ds_read_b64_tr_b16 a[18:19], v1 offset:26872
    v_add_f32 v5, v5, v30
    v_cvt_pk_bf16_f32 v16, v28, v29
    v_mfma_f32_16x16x32_bf16 v[64:67], a[104:107], v[12:15], v[64:67]
    v_exp_f32 v32, v32
    v_add_f32 v4, v4, v3
    v_mfma_f32_16x16x32_bf16 v[68:71], a[248:251], v[12:15], v[68:71]
    ds_read_b128 a[20:23], v0 offset:16896
    v_add_f32 v5, v5, v31
    v_subrev_u32 v3, s36, v4
    v_mfma_f32_16x16x32_bf16 v[72:75], a[240:243], v[12:15], v[72:75]
    s_waitcnt lgkmcnt(8)
    v_exp_f32 v33, v33
    v_cmp_le_u32 vcc, s37, v3
    v_mfma_f32_16x16x32_bf16 v[76:79], a[212:215], v[12:15], v[76:79]
    s_waitcnt lgkmcnt(6)
    v_add_f32 v5, v5, v32
    v_cvt_pk_bf16_f32 v17, v30, v31
    v_rcp_f32 v4, v4
    v_mfma_f32_16x16x32_bf16 v[80:83], a[200:203], v[12:15], v[80:83]
    s_waitcnt lgkmcnt(3)
    v_exp_f32 v34, v34
    v_mfma_f32_16x16x32_bf16 v[84:87], a[196:199], v[12:15], v[84:87]
    ds_read_b128 a[24:27], v0 offset:16960
    v_add_f32 v5, v5, v33
    s_or_b64 s[26:27], s[26:27], vcc
    v_mul_f32 v64, v64, v4
    v_mfma_f32_16x16x32_bf16 v[88:91], a[124:127], v[12:15], v[88:91]
    s_waitcnt lgkmcnt(2)
    v_exp_f32 v35, v35
    v_mul_f32 v65, v65, v4
    v_mfma_f32_16x16x32_bf16 v[92:95], a[16:19], v[12:15], v[92:95]
    v_add_f32 v5, v5, v34
    v_cvt_pk_bf16_f32 v18, v32, v33
    v_mul_f32 v66, v66, v4
    v_mfma_f32_16x16x32_bf16 v[28:31], a[220:223], a[48:51], 0
    v_exp_f32 v20, v20
    v_mul_f32 v67, v67, v4
    v_mfma_f32_16x16x32_bf16 v[28:31], a[208:211], a[52:55], v[28:31]
    ds_read_b128 a[28:31], v0 offset:17024
    v_add_f32 v5, v5, v35
    v_mul_f32 v68, v68, v4
    v_mfma_f32_16x16x32_bf16 v[28:31], a[236:239], a[56:59], v[28:31]
    v_exp_f32 v21, v21
    v_mul_f32 v69, v69, v4
    v_mfma_f32_16x16x32_bf16 v[28:31], a[216:219], a[60:63], v[28:31]
    ds_read_b128 a[120:123], v0 offset:17088
    v_cvt_pk_bf16_f32 v19, v34, v35
    v_mul_f32 v70, v70, v4
    v_mfma_f32_16x16x32_bf16 v[32:35], a[192:195], a[48:51], 0
    v_exp_f32 v22, v22
    v_mul_f32 v71, v71, v4
    v_mfma_f32_16x16x32_bf16 v[32:35], a[112:115], a[52:55], v[32:35]
    ds_read_b128 a[224:227], v0 offset:17408
    ds_read_b128 a[228:231], v0 offset:17472
    v_cvt_pk_bf16_f32 v64, v64, v65
    v_mfma_f32_16x16x32_bf16 v[32:35], a[100:103], a[56:59], v[32:35]
    v_exp_f32 v23, v23
    v_cvt_pk_bf16_f32 v65, v66, v67
    v_mfma_f32_16x16x32_bf16 v[32:35], a[204:207], a[60:63], v[32:35]
    ds_read_b128 a[108:111], v0 offset:17536
    v_cvt_pk_bf16_f32 v12, v20, v21
    v_cvt_pk_bf16_f32 v66, v68, v69
    v_mfma_f32_16x16x32_bf16 v[96:99], a[104:107], v[16:19], v[96:99]
    v_exp_f32 v24, v24
    v_cvt_pk_bf16_f32 v67, v70, v71
    v_mfma_f32_16x16x32_bf16 v[100:103], a[248:251], v[16:19], v[100:103]
    ds_read_b128 a[116:119], v0 offset:17600
    ds_read_b128 a[232:235], v0 offset:8448
    v_mul_f32 v72, v72, v4
    v_mfma_f32_16x16x32_bf16 v[104:107], a[240:243], v[16:19], v[104:107]
    v_exp_f32 v25, v25
    v_mul_f32 v73, v73, v4
    v_mfma_f32_16x16x32_bf16 v[108:111], a[212:215], v[16:19], v[108:111]
    ds_read_b128 a[244:247], v0 offset:8512
    v_cvt_pk_bf16_f32 v13, v22, v23
    v_mul_f32 v74, v74, v4
    v_mfma_f32_16x16x32_bf16 v[112:115], a[200:203], v[16:19], v[112:115]
    s_add_u32 s24, s43, 0
    s_and_b32 s24, s24, 0x7fff
    v_exp_f32 v26, v26
    v_mul_f32 v75, v75, v4
    v_mfma_f32_16x16x32_bf16 v[116:119], a[196:199], v[16:19], v[116:119]
    ds_read_b128 a[252:255], v0 offset:8576
    ds_read_b128 a[220:223], v0 offset:8640
    buffer_store_dwordx4 v[64:67], v2, s[16:19], s24 offen offset:0 sc1
    v_mul_f32 v76, v76, v4
    v_mfma_f32_16x16x32_bf16 v[120:123], a[124:127], v[16:19], v[120:123]
    s_waitcnt lgkmcnt(6)
    v_exp_f32 v27, v27
    v_mul_f32 v77, v77, v4
    v_mfma_f32_16x16x32_bf16 v[124:127], a[16:19], v[16:19], v[124:127]
    ds_read_b128 a[208:211], v0 offset:8960
    v_cvt_pk_bf16_f32 v14, v24, v25
    v_mul_f32 v78, v78, v4
    v_mfma_f32_16x16x32_bf16 v[20:23], a[20:23], a[32:35], 0
    v_exp_f32 v28, v28
    v_mul_f32 v79, v79, v4
    v_mfma_f32_16x16x32_bf16 v[20:23], a[24:27], a[36:39], v[20:23]
    ds_read_b128 a[236:239], v0 offset:9024
    ds_read_b128 a[216:219], v0 offset:9088
    v_cvt_pk_bf16_f32 v72, v72, v73
    v_mfma_f32_16x16x32_bf16 v[20:23], a[28:31], a[40:43], v[20:23]
    v_exp_f32 v29, v29
    v_cvt_pk_bf16_f32 v73, v74, v75
    v_mfma_f32_16x16x32_bf16 v[20:23], a[120:123], a[44:47], v[20:23]
    ds_read_b128 a[192:195], v0 offset:9152
    v_cvt_pk_bf16_f32 v15, v26, v27
    v_cvt_pk_bf16_f32 v74, v76, v77
    v_mfma_f32_16x16x32_bf16 v[24:27], a[224:227], a[32:35], 0
    v_exp_f32 v30, v30
    v_cvt_pk_bf16_f32 v75, v78, v79
    v_mfma_f32_16x16x32_bf16 v[24:27], a[228:231], a[36:39], v[24:27]
    ds_read_b64_tr_b16 a[112:113], v1 offset:17440
    ds_read_b64_tr_b16 a[114:115], v1 offset:17952
    v_mfma_f32_16x16x32_bf16 a[8:11], a[4:7], v[12:15], 0
    ds_read_b64_tr_b16 a[100:101], v1 offset:17448
    ds_read_b64_tr_b16 a[102:103], v1 offset:17960
    ds_read_b64_tr_b16 a[204:205], v1 offset:17504
    v_mfma_f32_16x16x32_bf16 a[0:3], v[64:67], v[72:75], 0
    s_waitcnt lgkmcnt(8)
    v_mfma_f32_16x16x32_bf16 v[24:27], a[108:111], a[40:43], v[24:27]
    v_exp_f32 v31, v31
    v_mfma_f32_16x16x32_bf16 v[24:27], a[116:119], a[44:47], v[24:27]
    ds_read_b64_tr_b16 a[206:207], v1 offset:18016
    v_cvt_pk_bf16_f32 v16, v28, v29
    v_mfma_f32_16x16x32_bf16 a[128:131], a[104:107], v[12:15], a[128:131]
    v_exp_f32 v32, v32
    v_mfma_f32_16x16x32_bf16 a[132:135], a[248:251], v[12:15], a[132:135]
    buffer_store_dwordx4 v[72:75], v2, s[16:19], s24 offen offset:64 sc1
    v_mul_f32 v80, v80, v4
    v_mul_f32 v81, v81, v4
    v_mfma_f32_16x16x32_bf16 a[136:139], a[240:243], v[12:15], a[136:139]
    v_exp_f32 v33, v33
    v_mul_f32 v82, v82, v4
    v_mfma_f32_16x16x32_bf16 a[140:143], a[212:215], v[12:15], a[140:143]
    v_cvt_pk_bf16_f32 v17, v30, v31
    v_mul_f32 v83, v83, v4
    v_mul_f32 v84, v84, v4
    v_mfma_f32_16x16x32_bf16 a[144:147], a[200:203], v[12:15], a[144:147]
    v_exp_f32 v34, v34
    v_mul_f32 v85, v85, v4
    v_mfma_f32_16x16x32_bf16 a[148:151], a[196:199], v[12:15], a[148:151]
    v_mul_f32 v86, v86, v4
    v_mul_f32 v87, v87, v4
    v_cvt_pk_bf16_f32 v80, v80, v81
    v_mfma_f32_16x16x32_bf16 a[152:155], a[124:127], v[12:15], a[152:155]
    v_exp_f32 v35, v35
    v_cvt_pk_bf16_f32 v81, v82, v83
    v_mfma_f32_16x16x32_bf16 a[156:159], a[16:19], v[12:15], a[156:159]
    v_cvt_pk_bf16_f32 v18, v32, v33
    v_cvt_pk_bf16_f32 v82, v84, v85
    v_cvt_pk_bf16_f32 v83, v86, v87
    v_mfma_f32_16x16x32_bf16 v[28:31], a[20:23], a[48:51], 0
    v_exp_f32 v20, v20
    v_mul_f32 v88, v88, v4
    v_mfma_f32_16x16x32_bf16 v[28:31], a[24:27], a[52:55], v[28:31]
    ds_read_b64_tr_b16 a[20:21], v1 offset:17512
    ds_read_b64_tr_b16 a[22:23], v1 offset:18024
    v_mul_f32 v89, v89, v4
    v_mfma_f32_16x16x32_bf16 v[28:31], a[28:31], a[56:59], v[28:31]
    v_exp_f32 v21, v21
    v_mul_f32 v90, v90, v4
    v_mfma_f32_16x16x32_bf16 v[28:31], a[120:123], a[60:63], v[28:31]
    ds_read_b64_tr_b16 a[24:25], v1 offset:17568
    v_cvt_pk_bf16_f32 v19, v34, v35
    v_mul_f32 v91, v91, v4
    v_mfma_f32_16x16x32_bf16 v[32:35], a[224:227], a[48:51], 0
    v_exp_f32 v22, v22
    v_mul_f32 v92, v92, v4
    v_mfma_f32_16x16x32_bf16 v[32:35], a[228:231], a[52:55], v[32:35]
    ds_read_b64_tr_b16 a[26:27], v1 offset:18080
    ds_read_b64_tr_b16 a[28:29], v1 offset:17576
    v_mfma_f32_16x16x32_bf16 a[12:15], a[4:7], v[16:19], 0
    ds_read_b64_tr_b16 a[30:31], v1 offset:18088
    ds_read_b64_tr_b16 a[120:121], v1 offset:17632
    ds_read_b64_tr_b16 a[122:123], v1 offset:18144
    v_mul_f32 v93, v93, v4
    v_mfma_f32_16x16x32_bf16 v[32:35], a[108:111], a[56:59], v[32:35]
    v_exp_f32 v23, v23
    v_mul_f32 v94, v94, v4
    v_mfma_f32_16x16x32_bf16 v[32:35], a[116:119], a[60:63], v[32:35]
    ds_read_b64_tr_b16 a[224:225], v1 offset:17640
    v_cvt_pk_bf16_f32 v12, v20, v21
    v_mul_f32 v95, v95, v4
    v_mfma_f32_16x16x32_bf16 a[160:163], a[104:107], v[16:19], a[160:163]
    buffer_store_dwordx4 v[80:83], v2, s[16:19], s24 offen offset:128 sc1
    v_exp_f32 v24, v24
    v_cvt_pk_bf16_f32 v88, v88, v89
    v_mfma_f32_16x16x32_bf16 a[164:167], a[248:251], v[16:19], a[164:167]
    ds_read_b64_tr_b16 a[226:227], v1 offset:18152
    ds_read_b128 a[228:231], v0 offset:0
    v_cvt_pk_bf16_f32 v89, v90, v91
    v_mfma_f32_16x16x32_bf16 a[168:171], a[240:243], v[16:19], a[168:171]
    v_exp_f32 v25, v25
    v_cvt_pk_bf16_f32 v90, v92, v93
    v_mfma_f32_16x16x32_bf16 a[172:175], a[212:215], v[16:19], a[172:175]
    ds_read_b128 a[108:111], v0 offset:64
    v_cvt_pk_bf16_f32 v13, v22, v23
    v_cvt_pk_bf16_f32 v91, v94, v95
    v_mfma_f32_16x16x32_bf16 a[176:179], a[200:203], v[16:19], a[176:179]
    v_exp_f32 v26, v26
    v_mfma_f32_16x16x32_bf16 a[0:3], v[80:83], v[88:91], a[0:3]
    v_mfma_f32_16x16x32_bf16 a[180:183], a[196:199], v[16:19], a[180:183]
    ds_read_b128 a[116:119], v0 offset:128
    ds_read_b128 a[104:107], v0 offset:192
    v_mfma_f32_16x16x32_bf16 a[184:187], a[124:127], v[16:19], a[184:187]
    v_exp_f32 v27, v27
    v_mfma_f32_16x16x32_bf16 a[188:191], a[16:19], v[16:19], a[188:191]
    ds_read_b128 a[248:251], v0 offset:512
    v_cvt_pk_bf16_f32 v14, v24, v25
    v_mfma_f32_16x16x32_bf16 v[20:23], a[232:235], a[32:35], 0
    v_exp_f32 v28, v28
    v_mov_b32 v3, v5
    v_mfma_f32_16x16x32_bf16 v[20:23], a[244:247], a[36:39], v[20:23]
    ds_read_b128 a[240:243], v0 offset:576
    ds_read_b128 a[212:215], v0 offset:640
    v_permlane32_swap_b32 v3, v5
    v_mfma_f32_16x16x32_bf16 v[20:23], a[252:255], a[40:43], v[20:23]
    v_exp_f32 v29, v29
    v_mfma_f32_16x16x32_bf16 v[20:23], a[220:223], a[44:47], v[20:23]
    ds_read_b128 a[200:203], v0 offset:704
    v_cvt_pk_bf16_f32 v15, v26, v27
    v_add_f32 v5, v5, v3
    v_mfma_f32_16x16x32_bf16 v[24:27], a[208:211], a[32:35], 0
    s_waitcnt lgkmcnt(6)
    v_exp_f32 v30, v30
    v_mov_b32 v3, v5
    v_mfma_f32_16x16x32_bf16 v[24:27], a[236:239], a[36:39], v[24:27]
    ds_read_b64_tr_b16 a[196:197], v1 offset:8720
    ds_read_b64_tr_b16 a[198:199], v1 offset:9232
    v_mfma_f32_16x16x32_bf16 a[8:11], a[4:7], v[12:15], a[8:11]
    ds_read_b64_tr_b16 a[124:125], v1 offset:8728
    ds_read_b64_tr_b16 a[126:127], v1 offset:9240
    ds_read_b64_tr_b16 a[16:17], v1 offset:8784
    v_permlane16_swap_b32 v3, v5
    v_mfma_f32_16x16x32_bf16 v[24:27], a[216:219], a[40:43], v[24:27]
    v_exp_f32 v31, v31
    v_mfma_f32_16x16x32_bf16 v[24:27], a[192:195], a[44:47], v[24:27]
    ds_read_b64_tr_b16 a[18:19], v1 offset:9296
    buffer_store_dwordx4 v[88:91], v2, s[16:19], s24 offen offset:192 sc1
    v_cvt_pk_bf16_f32 v16, v28, v29
    v_add_f32 v5, v5, v3
    v_mfma_f32_16x16x32_bf16 a[128:131], a[112:115], v[12:15], a[128:131]
    v_exp_f32 v32, v32
    v_subrev_u32 v3, s36, v5
    v_mfma_f32_16x16x32_bf16 a[132:135], a[100:103], v[12:15], a[132:135]
    v_cmp_le_u32 vcc, s37, v3
    v_rcp_f32 v5, v5
    v_mfma_f32_16x16x32_bf16 a[136:139], a[204:207], v[12:15], a[136:139]
    v_exp_f32 v33, v33
    s_or_b64 s[26:27], s[26:27], vcc
    v_mul_f32 v96, v96, v5
    v_mfma_f32_16x16x32_bf16 a[140:143], a[20:23], v[12:15], a[140:143]
    v_cvt_pk_bf16_f32 v17, v30, v31
    v_mul_f32 v97, v97, v5
    v_mul_f32 v98, v98, v5
    v_mfma_f32_16x16x32_bf16 a[144:147], a[24:27], v[12:15], a[144:147]
    v_exp_f32 v34, v34
    v_mul_f32 v99, v99, v5
    v_mfma_f32_16x16x32_bf16 a[148:151], a[28:31], v[12:15], a[148:151]
    v_mul_f32 v100, v100, v5
    v_mul_f32 v101, v101, v5
    v_mul_f32 v102, v102, v5
    v_mfma_f32_16x16x32_bf16 a[152:155], a[120:123], v[12:15], a[152:155]
    v_exp_f32 v35, v35
    v_mul_f32 v103, v103, v5
    v_mfma_f32_16x16x32_bf16 a[156:159], a[224:227], v[12:15], a[156:159]
    v_cvt_pk_bf16_f32 v18, v32, v33
    v_cvt_pk_bf16_f32 v96, v96, v97
    v_cvt_pk_bf16_f32 v97, v98, v99
    v_mfma_f32_16x16x32_bf16 v[28:31], a[232:235], a[48:51], 0
    v_exp_f32 v20, v20
    v_cvt_pk_bf16_f32 v98, v100, v101
    v_mfma_f32_16x16x32_bf16 v[28:31], a[244:247], a[52:55], v[28:31]
    v_cvt_pk_bf16_f32 v99, v102, v103
    v_mul_f32 v104, v104, v5
    v_mul_f32 v105, v105, v5
    v_mfma_f32_16x16x32_bf16 v[28:31], a[252:255], a[56:59], v[28:31]
    s_add_u32 s24, s43, 4096
    s_and_b32 s24, s24, 0x7fff
    v_exp_f32 v21, v21
    v_mul_f32 v106, v106, v5
    v_mfma_f32_16x16x32_bf16 v[28:31], a[220:223], a[60:63], v[28:31]
    buffer_store_dwordx4 v[96:99], v2, s[16:19], s24 offen offset:0 sc1
    v_cvt_pk_bf16_f32 v19, v34, v35
    v_mul_f32 v107, v107, v5
    v_mfma_f32_16x16x32_bf16 v[32:35], a[208:211], a[48:51], 0
    v_exp_f32 v22, v22
    v_mul_f32 v108, v108, v5
    v_mfma_f32_16x16x32_bf16 v[32:35], a[236:239], a[52:55], v[32:35]
    v_mul_f32 v109, v109, v5
    v_mul_f32 v110, v110, v5
    v_mfma_f32_16x16x32_bf16 a[12:15], a[4:7], v[16:19], a[12:15]
    v_mul_f32 v111, v111, v5
    v_cvt_pk_bf16_f32 v104, v104, v105
    v_cvt_pk_bf16_f32 v105, v106, v107
    v_cvt_pk_bf16_f32 v106, v108, v109
    v_mfma_f32_16x16x32_bf16 v[32:35], a[216:219], a[56:59], v[32:35]
    v_exp_f32 v23, v23
    v_cvt_pk_bf16_f32 v107, v110, v111
    v_mfma_f32_16x16x32_bf16 v[32:35], a[192:195], a[60:63], v[32:35]
    v_cvt_pk_bf16_f32 v12, v20, v21
    v_mfma_f32_16x16x32_bf16 a[0:3], v[96:99], v[104:107], a[0:3]
    v_mfma_f32_16x16x32_bf16 a[160:163], a[112:115], v[16:19], a[160:163]
    v_exp_f32 v24, v24
    v_mfma_f32_16x16x32_bf16 a[164:167], a[100:103], v[16:19], a[164:167]
    ds_read_b64_tr_b16 a[112:113], v1 offset:8792
    ds_read_b64_tr_b16 a[114:115], v1 offset:9304
    v_mfma_f32_16x16x32_bf16 a[168:171], a[204:207], v[16:19], a[168:171]
    v_exp_f32 v25, v25
    v_mul_f32 v112, v112, v5
    v_mfma_f32_16x16x32_bf16 a[172:175], a[20:23], v[16:19], a[172:175]
    ds_read_b64_tr_b16 a[100:101], v1 offset:8848
    v_cvt_pk_bf16_f32 v13, v22, v23
    v_mul_f32 v113, v113, v5
    v_mfma_f32_16x16x32_bf16 a[176:179], a[24:27], v[16:19], a[176:179]
    v_exp_f32 v26, v26
    v_mul_f32 v114, v114, v5
    v_mfma_f32_16x16x32_bf16 a[180:183], a[28:31], v[16:19], a[180:183]
    ds_read_b64_tr_b16 a[102:103], v1 offset:9360
    ds_read_b64_tr_b16 v[96:97], v1 offset:8856
    v_mul_f32 v115, v115, v5
    v_mfma_f32_16x16x32_bf16 a[184:187], a[120:123], v[16:19], a[184:187]
    v_exp_f32 v27, v27
    v_mul_f32 v116, v116, v5
    v_mfma_f32_16x16x32_bf16 a[188:191], a[224:227], v[16:19], a[188:191]
    ds_read_b64_tr_b16 v[98:99], v1 offset:9368
    v_cvt_pk_bf16_f32 v14, v24, v25
    v_mul_f32 v117, v117, v5
    v_mfma_f32_16x16x32_bf16 v[20:23], a[228:231], a[32:35], 0
    s_waitcnt lgkmcnt(6)
    v_exp_f32 v28, v28
    v_mul_f32 v118, v118, v5
    v_mfma_f32_16x16x32_bf16 v[20:23], a[108:111], a[36:39], v[20:23]
    ds_read_b64_tr_b16 a[204:205], v1 offset:8912
    ds_read_b64_tr_b16 a[206:207], v1 offset:9424
    v_mul_f32 v119, v119, v5
    v_mfma_f32_16x16x32_bf16 v[20:23], a[116:119], a[40:43], v[20:23]
    buffer_store_dwordx4 v[104:107], v2, s[16:19], s24 offen offset:64 sc1
    v_exp_f32 v29, v29
    v_cvt_pk_bf16_f32 v112, v112, v113
    v_mfma_f32_16x16x32_bf16 v[20:23], a[104:107], a[44:47], v[20:23]
    ds_read_b64_tr_b16 a[20:21], v1 offset:8920
    v_cvt_pk_bf16_f32 v15, v26, v27
    v_cvt_pk_bf16_f32 v113, v114, v115
    v_mfma_f32_16x16x32_bf16 v[24:27], a[248:251], a[32:35], 0
    v_exp_f32 v30, v30
    v_cvt_pk_bf16_f32 v114, v116, v117
    v_mfma_f32_16x16x32_bf16 v[24:27], a[240:243], a[36:39], v[24:27]
    ds_read_b64_tr_b16 a[22:23], v1 offset:9432
    ds_read_b64_tr_b16 a[24:25], v1 offset:0
    v_mfma_f32_16x16x32_bf16 a[8:11], a[4:7], v[12:15], a[8:11]
    ds_read_b64_tr_b16 a[26:27], v1 offset:512
    ds_read_b64_tr_b16 a[28:29], v1 offset:8
    ds_read_b64_tr_b16 a[30:31], v1 offset:520
    v_cvt_pk_bf16_f32 v115, v118, v119
    v_mfma_f32_16x16x32_bf16 v[24:27], a[212:215], a[40:43], v[24:27]
    v_exp_f32 v31, v31
    v_mul_f32 v120, v120, v5
    v_mfma_f32_16x16x32_bf16 v[24:27], a[200:203], a[44:47], v[24:27]
    ds_read_b64_tr_b16 a[120:121], v1 offset:64
    v_cvt_pk_bf16_f32 v16, v28, v29
    v_mul_f32 v121, v121, v5
    v_mfma_f32_16x16x32_bf16 a[128:131], a[196:199], v[12:15], a[128:131]
    v_exp_f32 v32, v32
    v_mul_f32 v122, v122, v5
    v_mfma_f32_16x16x32_bf16 a[132:135], a[124:127], v[12:15], a[132:135]
    ds_read_b64_tr_b16 a[122:123], v1 offset:576
    ds_read_b64_tr_b16 a[224:225], v1 offset:72
    v_mul_f32 v123, v123, v5
    v_mfma_f32_16x16x32_bf16 a[136:139], a[16:19], v[12:15], a[136:139]
    s_waitcnt lgkmcnt(8)
    v_exp_f32 v33, v33
    v_mul_f32 v124, v124, v5
    v_mfma_f32_16x16x32_bf16 a[140:143], a[112:115], v[12:15], a[140:143]
    ds_read_b64_tr_b16 a[226:227], v1 offset:584
    v_cvt_pk_bf16_f32 v17, v30, v31
    v_mul_f32 v125, v125, v5
    v_mfma_f32_16x16x32_bf16 a[144:147], a[100:103], v[12:15], a[144:147]
    v_exp_f32 v34, v34
    v_mul_f32 v126, v126, v5
    v_mfma_f32_16x16x32_bf16 a[148:151], v[96:99], v[12:15], a[148:151]
    ds_read_b64_tr_b16 a[32:33], v1 offset:128
    ds_read_b64_tr_b16 a[34:35], v1 offset:640
    v_mul_f32 v127, v127, v5
    v_mfma_f32_16x16x32_bf16 a[152:155], a[204:207], v[12:15], a[152:155]
    s_waitcnt lgkmcnt(6)
    v_exp_f32 v35, v35
    v_cvt_pk_bf16_f32 v120, v120, v121
    v_mfma_f32_16x16x32_bf16 a[156:159], a[20:23], v[12:15], a[156:159]
    ds_read_b64_tr_b16 v[104:105], v1 offset:136
    v_cvt_pk_bf16_f32 v18, v32, v33
    v_cvt_pk_bf16_f32 v121, v122, v123
    v_mfma_f32_16x16x32_bf16 v[28:31], a[228:231], a[48:51], 0
    v_exp_f32 v20, v20
    v_cvt_pk_bf16_f32 v122, v124, v125
    v_mfma_f32_16x16x32_bf16 v[28:31], a[108:111], a[52:55], v[28:31]
    ds_read_b64_tr_b16 v[106:107], v1 offset:648
    ds_read_b64_tr_b16 a[36:37], v1 offset:192
    buffer_store_dwordx4 v[112:115], v2, s[16:19], s24 offen offset:128 sc1
    v_cvt_pk_bf16_f32 v123, v126, v127
    v_mfma_f32_16x16x32_bf16 v[28:31], a[116:119], a[56:59], v[28:31]
    v_exp_f32 v21, v21
    v_mfma_f32_16x16x32_bf16 a[0:3], v[112:115], v[120:123], a[0:3]
    v_mfma_f32_16x16x32_bf16 v[28:31], a[104:107], a[60:63], v[28:31]
    ds_read_b64_tr_b16 a[38:39], v1 offset:704
    v_cvt_pk_bf16_f32 v19, v34, v35
    v_mfma_f32_16x16x32_bf16 v[32:35], a[248:251], a[48:51], 0
    v_exp_f32 v22, v22
    v_mfma_f32_16x16x32_bf16 v[32:35], a[240:243], a[52:55], v[32:35]
    ds_read_b64_tr_b16 a[40:41], v1 offset:200
    ds_read_b64_tr_b16 a[42:43], v1 offset:712
    v_mfma_f32_16x16x32_bf16 a[12:15], a[4:7], v[16:19], a[12:15]
    ds_read_b128 a[44:47], v0 offset:16896
    ds_read_b128 v[112:115], v0 offset:16960
    ds_read_b128 a[52:55], v0 offset:17024
    v_mfma_f32_16x16x32_bf16 v[32:35], a[212:215], a[56:59], v[32:35]
    v_exp_f32 v23, v23
    v_mov_b32 v3, v6
    v_mfma_f32_16x16x32_bf16 v[32:35], a[200:203], a[60:63], v[32:35]
    ds_read_b128 a[56:59], v0 offset:17088
    v_cvt_pk_bf16_f32 v12, v20, v21
    v_permlane32_swap_b32 v3, v6
    v_mfma_f32_16x16x32_bf16 a[160:163], a[196:199], v[16:19], a[160:163]
    v_exp_f32 v24, v24
    v_mfma_f32_16x16x32_bf16 a[164:167], a[124:127], v[16:19], a[164:167]
    ds_read_b128 a[60:63], v0 offset:17408
    v_add_f32 v6, v6, v3
    v_mov_b32 v3, v6
    v_mfma_f32_16x16x32_bf16 a[168:171], a[16:19], v[16:19], a[168:171]
    v_exp_f32 v25, v25
    v_permlane16_swap_b32 v3, v6
    v_mfma_f32_16x16x32_bf16 a[172:175], a[112:115], v[16:19], a[172:175]
    v_cvt_pk_bf16_f32 v13, v22, v23
    v_add_f32 v6, v6, v3
    v_mfma_f32_16x16x32_bf16 a[176:179], a[100:103], v[16:19], a[176:179]
    v_exp_f32 v26, v26
    v_mfma_f32_16x16x32_bf16 a[180:183], v[96:99], v[16:19], a[180:183]
    buffer_store_dwordx4 v[120:123], v2, s[16:19], s24 offen offset:192 sc1
    v_mfma_f32_16x16x32_bf16 a[184:187], a[204:207], v[16:19], a[184:187]
    v_exp_f32 v27, v27
    v_mfma_f32_16x16x32_bf16 a[188:191], a[20:23], v[16:19], a[188:191]
    ds_read_b128 v[120:123], v0 offset:17472
    v_cvt_pk_bf16_f32 v14, v24, v25
    v_mfma_f32_16x16x32_bf16 v[20:23], a[228:231], a[64:67], 0
    v_exp_f32 v28, v28
    v_mfma_f32_16x16x32_bf16 v[20:23], a[108:111], a[68:71], v[20:23]
    v_mfma_f32_16x16x32_bf16 v[20:23], a[116:119], a[72:75], v[20:23]
    v_exp_f32 v29, v29
    v_mfma_f32_16x16x32_bf16 v[20:23], a[104:107], a[76:79], v[20:23]
    v_cvt_pk_bf16_f32 v15, v26, v27
    v_mfma_f32_16x16x32_bf16 v[24:27], a[248:251], a[64:67], 0
    v_exp_f32 v30, v30
    v_mfma_f32_16x16x32_bf16 v[24:27], a[240:243], a[68:71], v[24:27]
    v_mfma_f32_16x16x32_bf16 a[8:11], a[4:7], v[12:15], a[8:11]
    v_mfma_f32_16x16x32_bf16 v[24:27], a[212:215], a[72:75], v[24:27]
    v_exp_f32 v31, v31
    v_mfma_f32_16x16x32_bf16 v[24:27], a[200:203], a[76:79], v[24:27]
    v_cvt_pk_bf16_f32 v16, v28, v29
    s_nop 3
    v_accvgpr_read_b32 v3, a8
    v_add_f32 v6, v6, v3
    v_subrev_u32 v3, s36, v6
    v_mfma_f32_16x16x32_bf16 a[128:131], a[24:27], v[12:15], a[128:131]
    s_waitcnt lgkmcnt(0)
    v_exp_f32 v32, v32
    v_rcp_f32 v6, v6
    v_mfma_f32_16x16x32_bf16 a[132:135], a[28:31], v[12:15], a[132:135]
    ds_read_b128 a[8:11], v0 offset:17536
    v_cmp_le_u32 vcc, s37, v3
    s_nop 1
    s_or_b64 s[26:27], s[26:27], vcc
    v_mfma_f32_16x16x32_bf16 a[136:139], a[120:123], v[12:15], a[136:139]
    v_exp_f32 v33, v33
    v_mfma_f32_16x16x32_bf16 a[140:143], a[224:227], v[12:15], a[140:143]
    v_cvt_pk_bf16_f32 v17, v30, v31
    v_accvgpr_read_b32 v64, a128
    v_accvgpr_read_b32 v65, a129
    v_accvgpr_read_b32 v66, a130
    v_accvgpr_read_b32 v67, a131
    v_accvgpr_read_b32 v72, a132
    v_mfma_f32_16x16x32_bf16 a[144:147], a[32:35], v[12:15], a[144:147]
    v_exp_f32 v34, v34
    v_accvgpr_read_b32 v73, a133
    v_accvgpr_read_b32 v74, a134
    v_mfma_f32_16x16x32_bf16 a[148:151], v[104:107], v[12:15], a[148:151]
    ds_read_b128 a[128:131], v0 offset:17600
    v_accvgpr_read_b32 v75, a135
    v_mul_f32 v64, v64, v6
    v_mul_f32 v65, v65, v6
    v_mfma_f32_16x16x32_bf16 a[152:155], a[36:39], v[12:15], a[152:155]
    v_exp_f32 v35, v35
    v_mul_f32 v66, v66, v6
    v_mul_f32 v67, v67, v6
    v_mfma_f32_16x16x32_bf16 a[156:159], a[40:43], v[12:15], a[156:159]
    ds_read_b128 a[132:135], v0 offset:25344
    v_cvt_pk_bf16_f32 v18, v32, v33
    v_mul_f32 v72, v72, v6
    v_mul_f32 v73, v73, v6
    v_mfma_f32_16x16x32_bf16 v[28:31], a[232:235], a[64:67], 0
    v_exp_f32 v20, v20
    v_mul_f32 v74, v74, v6
    v_mul_f32 v75, v75, v6
    v_mfma_f32_16x16x32_bf16 v[28:31], a[244:247], a[68:71], v[28:31]
    v_cvt_pk_bf16_f32 v68, v64, v65
    v_cvt_pk_bf16_f32 v69, v66, v67
    v_cvt_pk_bf16_f32 v70, v72, v73
    v_cvt_pk_bf16_f32 v71, v74, v75
    v_mfma_f32_16x16x32_bf16 v[28:31], a[252:255], a[72:75], v[28:31]
    s_add_u32 s24, s43, 8192
    s_and_b32 s24, s24, 0x7fff
    v_exp_f32 v21, v21
    v_accvgpr_read_b32 v80, a136
    v_accvgpr_read_b32 v81, a137
    v_mfma_f32_16x16x32_bf16 v[28:31], a[220:223], a[76:79], v[28:31]
    buffer_store_dwordx4 v[68:71], v2, s[16:19], s24 offen offset:0 sc1
    v_cvt_pk_bf16_f32 v19, v34, v35
    v_accvgpr_read_b32 v82, a138
    v_accvgpr_read_b32 v83, a139
    v_mfma_f32_16x16x32_bf16 v[32:35], a[208:211], a[64:67], 0
    v_exp_f32 v22, v22
    v_accvgpr_read_b32 v88, a140
    v_accvgpr_read_b32 v89, a141
    v_mfma_f32_16x16x32_bf16 v[32:35], a[236:239], a[68:71], v[32:35]
    ds_read_b128 a[136:139], v0 offset:25408
    v_accvgpr_read_b32 v90, a142
    v_mfma_f32_16x16x32_bf16 a[12:15], a[4:7], v[16:19], a[12:15]
    v_accvgpr_read_b32 v91, a143
    v_mul_f32 v80, v80, v6
    v_mul_f32 v81, v81, v6
    v_mul_f32 v82, v82, v6
    v_mul_f32 v83, v83, v6
    v_mfma_f32_16x16x32_bf16 v[32:35], a[216:219], a[72:75], v[32:35]
    v_exp_f32 v23, v23
    v_mul_f32 v88, v88, v6
    v_mul_f32 v89, v89, v6
    v_mfma_f32_16x16x32_bf16 v[32:35], a[192:195], a[76:79], v[32:35]
    ds_read_b128 a[140:143], v0 offset:25472
    v_cvt_pk_bf16_f32 v12, v20, v21
    v_mul_f32 v90, v90, v6
    v_mul_f32 v91, v91, v6
    v_mfma_f32_16x16x32_bf16 a[160:163], a[24:27], v[16:19], a[160:163]
    v_exp_f32 v24, v24
    v_cvt_pk_bf16_f32 v76, v80, v81
    v_cvt_pk_bf16_f32 v77, v82, v83
    v_mfma_f32_16x16x32_bf16 a[164:167], a[28:31], v[16:19], a[164:167]
    v_cvt_pk_bf16_f32 v78, v88, v89
    v_cvt_pk_bf16_f32 v79, v90, v91
    s_nop 1
    v_mfma_f32_16x16x32_bf16 a[0:3], v[68:71], v[76:79], a[0:3]
    v_mfma_f32_16x16x32_bf16 a[168:171], a[120:123], v[16:19], a[168:171]
    v_exp_f32 v25, v25
    v_mfma_f32_16x16x32_bf16 a[172:175], a[224:227], v[16:19], a[172:175]
    ds_read_b128 v[68:71], v0 offset:25536
    v_cvt_pk_bf16_f32 v13, v22, v23
    v_accvgpr_read_b32 v64, a144
    v_accvgpr_read_b32 v65, a145
    v_mfma_f32_16x16x32_bf16 a[176:179], a[32:35], v[16:19], a[176:179]
    v_exp_f32 v26, v26
    v_accvgpr_read_b32 v66, a146
    v_accvgpr_read_b32 v67, a147
    v_mfma_f32_16x16x32_bf16 a[180:183], v[104:107], v[16:19], a[180:183]
    ds_read_b128 a[144:147], v0 offset:25856
    v_accvgpr_read_b32 v72, a148
    v_accvgpr_read_b32 v73, a149
    v_accvgpr_read_b32 v74, a150
    v_mfma_f32_16x16x32_bf16 a[184:187], a[36:39], v[16:19], a[184:187]
    v_exp_f32 v27, v27
    v_accvgpr_read_b32 v75, a151
    v_mul_f32 v64, v64, v6
    v_mfma_f32_16x16x32_bf16 a[188:191], a[40:43], v[16:19], a[188:191]
    ds_read_b128 a[148:151], v0 offset:25920
    v_cvt_pk_bf16_f32 v14, v24, v25
    v_mul_f32 v65, v65, v6
    v_mul_f32 v66, v66, v6
    v_mfma_f32_16x16x32_bf16 v[20:23], a[44:47], a[64:67], 0
    v_exp_f32 v28, v28
    v_mul_f32 v67, v67, v6
    v_mul_f32 v72, v72, v6
    v_mfma_f32_16x16x32_bf16 v[20:23], v[112:115], a[68:71], v[20:23]
    buffer_store_dwordx4 v[76:79], v2, s[16:19], s24 offen offset:64 sc1
    v_mul_f32 v73, v73, v6
    v_mul_f32 v74, v74, v6
    v_mul_f32 v75, v75, v6
    v_mfma_f32_16x16x32_bf16 v[20:23], a[52:55], a[72:75], v[20:23]
    v_exp_f32 v29, v29
    v_cvt_pk_bf16_f32 v84, v64, v65
    v_cvt_pk_bf16_f32 v85, v66, v67
    v_mfma_f32_16x16x32_bf16 v[20:23], a[56:59], a[76:79], v[20:23]
    ds_read_b128 v[76:79], v0 offset:25984
    v_cvt_pk_bf16_f32 v15, v26, v27
    v_cvt_pk_bf16_f32 v86, v72, v73
    v_cvt_pk_bf16_f32 v87, v74, v75
    v_mfma_f32_16x16x32_bf16 v[24:27], a[60:63], a[64:67], 0
    v_exp_f32 v30, v30
    v_accvgpr_read_b32 v80, a152
    v_accvgpr_read_b32 v81, a153
    v_mfma_f32_16x16x32_bf16 v[24:27], v[120:123], a[68:71], v[24:27]
    v_accvgpr_read_b32 v82, a154
    v_accvgpr_read_b32 v83, a155
    v_mfma_f32_16x16x32_bf16 a[48:51], a[4:7], v[12:15], 0
    s_waitcnt lgkmcnt(2)
    v_accvgpr_read_b32 v88, a156
    v_accvgpr_read_b32 v89, a157
    v_accvgpr_read_b32 v90, a158
    v_accvgpr_read_b32 v91, a159
    v_mul_f32 v80, v80, v6
    v_mfma_f32_16x16x32_bf16 v[24:27], a[8:11], a[72:75], v[24:27]
    v_exp_f32 v31, v31
    v_mul_f32 v81, v81, v6
    v_mul_f32 v82, v82, v6
    v_mfma_f32_16x16x32_bf16 v[24:27], a[128:131], a[76:79], v[24:27]
    ds_read_b128 a[152:155], v0 offset:26048
    v_cvt_pk_bf16_f32 v16, v28, v29
    v_mul_f32 v83, v83, v6
    v_mul_f32 v88, v88, v6
    v_mfma_f32_16x16x32_bf16 v[128:131], a[24:27], v[12:15], v[128:131]
    v_exp_f32 v32, v32
    v_mul_f32 v89, v89, v6
    v_mul_f32 v90, v90, v6
    v_mfma_f32_16x16x32_bf16 v[132:135], a[28:31], v[12:15], v[132:135]
    ds_read_b64_tr_b16 a[156:157], v1 offset:17440
    ds_read_b64_tr_b16 a[158:159], v1 offset:17952
    v_mul_f32 v91, v91, v6
    v_cvt_pk_bf16_f32 v92, v80, v81
    v_mfma_f32_16x16x32_bf16 v[136:139], a[120:123], v[12:15], v[136:139]
    v_exp_f32 v33, v33
    v_cvt_pk_bf16_f32 v93, v82, v83
    v_cvt_pk_bf16_f32 v94, v88, v89
    v_mfma_f32_16x16x32_bf16 v[140:143], a[224:227], v[12:15], v[140:143]
    v_cvt_pk_bf16_f32 v17, v30, v31
    v_cvt_pk_bf16_f32 v95, v90, v91
    s_nop 1
    v_mfma_f32_16x16x32_bf16 a[0:3], v[84:87], v[92:95], a[0:3]
    v_mfma_f32_16x16x32_bf16 v[144:147], a[32:35], v[12:15], v[144:147]
    v_exp_f32 v34, v34
    v_mfma_f32_16x16x32_bf16 v[148:151], v[104:107], v[12:15], v[148:151]
    buffer_store_dwordx4 v[84:87], v2, s[16:19], s24 offen offset:128 sc1
    v_mov_b32 v3, v7
    s_nop 1
    v_permlane32_swap_b32 v3, v7
    v_mfma_f32_16x16x32_bf16 v[152:155], a[36:39], v[12:15], v[152:155]
    v_exp_f32 v35, v35
    v_add_f32 v7, v7, v3
    v_mov_b32 v3, v7
    v_mfma_f32_16x16x32_bf16 v[156:159], a[40:43], v[12:15], v[156:159]
    ds_read_b64_tr_b16 v[84:85], v1 offset:17448
    v_cvt_pk_bf16_f32 v18, v32, v33
    v_permlane16_swap_b32 v3, v7
    v_mfma_f32_16x16x32_bf16 v[28:31], a[132:135], a[64:67], 0
    v_exp_f32 v20, v20
    v_add_f32 v7, v7, v3
    v_accvgpr_read_b32 v3, a12
    v_mfma_f32_16x16x32_bf16 v[28:31], a[136:139], a[68:71], v[28:31]
    ds_read_b64_tr_b16 v[86:87], v1 offset:17960
    ds_read_b64_tr_b16 a[12:13], v1 offset:17504
    v_add_f32 v7, v7, v3
    v_subrev_u32 v3, s36, v7
    v_mfma_f32_16x16x32_bf16 v[28:31], a[140:143], a[72:75], v[28:31]
    v_exp_f32 v21, v21
    v_rcp_f32 v7, v7
    v_mfma_f32_16x16x32_bf16 v[28:31], v[68:71], a[76:79], v[28:31]
    ds_read_b64_tr_b16 a[14:15], v1 offset:18016
    v_cvt_pk_bf16_f32 v19, v34, v35
    v_cmp_le_u32 vcc, s37, v3
    s_nop 1
    s_or_b64 s[26:27], s[26:27], vcc
    v_accvgpr_read_b32 v64, a160
    v_mfma_f32_16x16x32_bf16 v[32:35], a[144:147], a[64:67], 0
    s_waitcnt lgkmcnt(4)
    v_exp_f32 v22, v22
    v_accvgpr_read_b32 v65, a161
    v_accvgpr_read_b32 v66, a162
    v_mfma_f32_16x16x32_bf16 v[32:35], a[148:151], a[68:71], v[32:35]
    ds_read_b64_tr_b16 a[68:69], v1 offset:17512
    ds_read_b64_tr_b16 a[70:71], v1 offset:18024
    v_mfma_f32_16x16x32_bf16 a[48:51], a[4:7], v[16:19], a[48:51]
    v_accvgpr_read_b32 v67, a163
    v_accvgpr_read_b32 v72, a164
    v_accvgpr_read_b32 v73, a165
    v_accvgpr_read_b32 v74, a166
    v_accvgpr_read_b32 v75, a167
    v_mfma_f32_16x16x32_bf16 v[32:35], v[76:79], a[72:75], v[32:35]
    v_exp_f32 v23, v23
    v_mul_f32 v64, v64, v7
    v_mul_f32 v65, v65, v7
    v_mfma_f32_16x16x32_bf16 v[32:35], a[152:155], a[76:79], v[32:35]
    ds_read_b64_tr_b16 a[72:73], v1 offset:17568
    v_cvt_pk_bf16_f32 v12, v20, v21
    v_mul_f32 v66, v66, v7
    v_mul_f32 v67, v67, v7
    v_mfma_f32_16x16x32_bf16 v[128:131], a[196:199], v[16:19], v[128:131]
    v_exp_f32 v24, v24
    v_mul_f32 v72, v72, v7
    v_mul_f32 v73, v73, v7
    v_mfma_f32_16x16x32_bf16 v[132:135], a[124:127], v[16:19], v[132:135]
    ds_read_b64_tr_b16 a[74:75], v1 offset:18080
    ds_read_b64_tr_b16 a[160:161], v1 offset:17576
    v_mul_f32 v74, v74, v7
    v_mul_f32 v75, v75, v7
    v_mfma_f32_16x16x32_bf16 v[136:139], a[16:19], v[16:19], v[136:139]
    v_exp_f32 v25, v25
    v_cvt_pk_bf16_f32 v100, v64, v65
    v_cvt_pk_bf16_f32 v101, v66, v67
    v_mfma_f32_16x16x32_bf16 v[140:143], a[112:115], v[16:19], v[140:143]
    ds_read_b64_tr_b16 a[162:163], v1 offset:18088
    v_cvt_pk_bf16_f32 v13, v22, v23
    v_cvt_pk_bf16_f32 v102, v72, v73
    v_cvt_pk_bf16_f32 v103, v74, v75
    v_mfma_f32_16x16x32_bf16 v[144:147], a[100:103], v[16:19], v[144:147]
    buffer_store_dwordx4 v[92:95], v2, s[16:19], s24 offen offset:192 sc1
    v_exp_f32 v26, v26
    v_accvgpr_read_b32 v80, a168
    v_accvgpr_read_b32 v81, a169
    v_mfma_f32_16x16x32_bf16 v[148:151], v[96:99], v[16:19], v[148:151]
    ds_read_b64_tr_b16 a[164:165], v1 offset:17632
    ds_read_b64_tr_b16 a[166:167], v1 offset:18144
    v_accvgpr_read_b32 v82, a170
    v_accvgpr_read_b32 v83, a171
    v_mfma_f32_16x16x32_bf16 v[152:155], a[204:207], v[16:19], v[152:155]
    v_exp_f32 v27, v27
    v_accvgpr_read_b32 v88, a172
    v_accvgpr_read_b32 v89, a173
    v_mfma_f32_16x16x32_bf16 v[156:159], a[20:23], v[16:19], v[156:159]
    ds_read_b64_tr_b16 a[76:77], v1 offset:17640
    v_cvt_pk_bf16_f32 v14, v24, v25
    v_accvgpr_read_b32 v90, a174
    v_accvgpr_read_b32 v91, a175
    v_mfma_f32_16x16x32_bf16 v[20:23], a[132:135], a[80:83], 0
    v_exp_f32 v28, v28
    v_mul_f32 v80, v80, v7
    v_mul_f32 v81, v81, v7
    v_mfma_f32_16x16x32_bf16 v[20:23], a[136:139], a[84:87], v[20:23]
    ds_read_b64_tr_b16 a[78:79], v1 offset:18152
    ds_read_b64_tr_b16 v[92:93], v1 offset:26160
    v_mul_f32 v82, v82, v7
    v_mul_f32 v83, v83, v7
    v_mfma_f32_16x16x32_bf16 v[20:23], a[140:143], a[88:91], v[20:23]
    v_exp_f32 v29, v29
    v_mul_f32 v88, v88, v7
    v_mul_f32 v89, v89, v7
    v_mfma_f32_16x16x32_bf16 v[20:23], v[68:71], a[92:95], v[20:23]
    ds_read_b64_tr_b16 v[94:95], v1 offset:26672
    v_cvt_pk_bf16_f32 v15, v26, v27
    v_mul_f32 v90, v90, v7
    v_mul_f32 v91, v91, v7
    v_mfma_f32_16x16x32_bf16 v[24:27], a[144:147], a[80:83], 0
    v_exp_f32 v30, v30
    v_cvt_pk_bf16_f32 v108, v80, v81
    v_cvt_pk_bf16_f32 v109, v82, v83
    v_mfma_f32_16x16x32_bf16 v[24:27], a[148:151], a[84:87], v[24:27]
    ds_read_b64_tr_b16 a[168:169], v1 offset:26168
    ds_read_b64_tr_b16 a[170:171], v1 offset:26680
    v_mfma_f32_16x16x32_bf16 a[48:51], a[4:7], v[12:15], a[48:51]
    ds_read_b64_tr_b16 a[172:173], v1 offset:26224
    ds_read_b64_tr_b16 a[174:175], v1 offset:26736
    v_cvt_pk_bf16_f32 v110, v88, v89
    v_cvt_pk_bf16_f32 v111, v90, v91
    s_nop 1
    v_mfma_f32_16x16x32_bf16 a[0:3], v[100:103], v[108:111], a[0:3]
    v_mfma_f32_16x16x32_bf16 v[24:27], v[76:79], a[88:91], v[24:27]
    v_exp_f32 v31, v31
    v_mfma_f32_16x16x32_bf16 v[24:27], a[152:155], a[92:95], v[24:27]
    v_cvt_pk_bf16_f32 v16, v28, v29
    v_accvgpr_read_b32 v64, a176
    v_accvgpr_read_b32 v65, a177
    v_mfma_f32_16x16x32_bf16 v[128:131], a[156:159], v[12:15], v[128:131]
    s_waitcnt lgkmcnt(5)
    v_exp_f32 v32, v32
    v_accvgpr_read_b32 v66, a178
    v_accvgpr_read_b32 v67, a179
    v_mfma_f32_16x16x32_bf16 v[132:135], v[84:87], v[12:15], v[132:135]
    ds_read_b64_tr_b16 a[176:177], v1 offset:26232
    ds_read_b64_tr_b16 a[178:179], v1 offset:26744
    v_accvgpr_read_b32 v72, a180
    v_accvgpr_read_b32 v73, a181
    v_mfma_f32_16x16x32_bf16 v[136:139], a[12:15], v[12:15], v[136:139]
    s_add_u32 s24, s43, 12288
    s_and_b32 s24, s24, 0x7fff
    v_exp_f32 v33, v33
    v_accvgpr_read_b32 v74, a182
    v_accvgpr_read_b32 v75, a183
    v_mfma_f32_16x16x32_bf16 v[140:143], a[68:71], v[12:15], v[140:143]
    ds_read_b64_tr_b16 a[180:181], v1 offset:26288
    buffer_store_dwordx4 v[100:103], v2, s[16:19], s24 offen offset:0 sc1
    v_cvt_pk_bf16_f32 v17, v30, v31
    v_mul_f32 v64, v64, v7
    v_mul_f32 v65, v65, v7
    v_mfma_f32_16x16x32_bf16 v[144:147], a[72:75], v[12:15], v[144:147]
    v_exp_f32 v34, v34
    v_mul_f32 v66, v66, v7
    v_mul_f32 v67, v67, v7
    v_mfma_f32_16x16x32_bf16 v[148:151], a[160:163], v[12:15], v[148:151]
    ds_read_b64_tr_b16 a[182:183], v1 offset:26800
    ds_read_b64_tr_b16 v[100:101], v1 offset:26296
    v_mul_f32 v72, v72, v7
    v_mul_f32 v73, v73, v7
    v_mfma_f32_16x16x32_bf16 v[152:155], a[164:167], v[12:15], v[152:155]
    v_exp_f32 v35, v35
    v_mul_f32 v74, v74, v7
    v_mul_f32 v75, v75, v7
    v_mfma_f32_16x16x32_bf16 v[156:159], a[76:79], v[12:15], v[156:159]
    ds_read_b64_tr_b16 v[102:103], v1 offset:26808
    v_cvt_pk_bf16_f32 v18, v32, v33
    v_cvt_pk_bf16_f32 v116, v64, v65
    v_cvt_pk_bf16_f32 v117, v66, v67
    v_mfma_f32_16x16x32_bf16 v[28:31], a[44:47], a[80:83], 0
    v_exp_f32 v20, v20
    v_cvt_pk_bf16_f32 v118, v72, v73
    v_cvt_pk_bf16_f32 v119, v74, v75
    v_mfma_f32_16x16x32_bf16 v[28:31], v[112:115], a[84:87], v[28:31]
    ds_read_b64_tr_b16 v[64:65], v1 offset:26352
    ds_read_b64_tr_b16 v[66:67], v1 offset:26864
    v_accvgpr_read_b32 v80, a184
    v_accvgpr_read_b32 v81, a185
    v_mfma_f32_16x16x32_bf16 v[28:31], a[52:55], a[88:91], v[28:31]
    v_exp_f32 v21, v21
    v_accvgpr_read_b32 v82, a186
    v_accvgpr_read_b32 v83, a187
    v_mfma_f32_16x16x32_bf16 v[28:31], a[56:59], a[92:95], v[28:31]
    ds_read_b64_tr_b16 v[72:73], v1 offset:26360
    v_cvt_pk_bf16_f32 v19, v34, v35
    v_accvgpr_read_b32 v88, a188
    v_accvgpr_read_b32 v89, a189
    v_mfma_f32_16x16x32_bf16 v[32:35], a[60:63], a[80:83], 0
    v_exp_f32 v22, v22
    v_accvgpr_read_b32 v90, a190
    v_accvgpr_read_b32 v91, a191
    v_mfma_f32_16x16x32_bf16 v[32:35], v[120:123], a[84:87], v[32:35]
    ds_read_b64_tr_b16 v[74:75], v1 offset:26872
    v_mul_f32 v80, v80, v7
    v_mfma_f32_16x16x32_bf16 a[48:51], a[4:7], v[16:19], a[48:51]
    v_mul_f32 v81, v81, v7
    v_mul_f32 v82, v82, v7
    v_mul_f32 v83, v83, v7
    v_mul_f32 v88, v88, v7
    v_mul_f32 v89, v89, v7
    v_mfma_f32_16x16x32_bf16 v[32:35], a[8:11], a[88:91], v[32:35]
    s_waitcnt lgkmcnt(4)
    v_exp_f32 v23, v23
    v_mul_f32 v90, v90, v7
    v_mul_f32 v91, v91, v7
    v_mfma_f32_16x16x32_bf16 v[32:35], a[128:131], a[92:95], v[32:35]
    buffer_store_dwordx4 v[108:111], v2, s[16:19], s24 offen offset:64 sc1
    v_cvt_pk_bf16_f32 v12, v20, v21
    v_cvt_pk_bf16_f32 v124, v80, v81
    v_cvt_pk_bf16_f32 v125, v82, v83
    v_mfma_f32_16x16x32_bf16 v[128:131], v[92:95], v[16:19], v[128:131]
    v_exp_f32 v24, v24
    v_cvt_pk_bf16_f32 v126, v88, v89
    v_cvt_pk_bf16_f32 v127, v90, v91
    v_mfma_f32_16x16x32_bf16 v[132:135], a[168:171], v[16:19], v[132:135]
    s_nop 0
    v_mfma_f32_16x16x32_bf16 a[0:3], v[116:119], v[124:127], a[0:3]
    v_mfma_f32_16x16x32_bf16 v[136:139], a[172:175], v[16:19], v[136:139]
    v_exp_f32 v25, v25
    s_mul_i32 s29, s3, 1280
    s_add_u32 s29, s29, 137344
    v_mbcnt_lo_u32_b32 v3, -1, 0
    v_mbcnt_hi_u32_b32 v3, -1, v3
    v_mfma_f32_16x16x32_bf16 v[140:143], a[176:179], v[16:19], v[140:143]
    v_cvt_pk_bf16_f32 v13, v22, v23
    v_and_b32 v4, 48, v3
    v_lshl_add_u32 v4, v4, 2, s29
    v_lshl_add_u32 v4, v3, 4, v4
    v_mfma_f32_16x16x32_bf16 v[144:147], a[180:183], v[16:19], v[144:147]
    v_exp_f32 v26, v26
    v_and_b32 v6, 3, v3
    v_lshrrev_b32 v3, 2, v3
    v_mfma_f32_16x16x32_bf16 v[148:151], v[100:103], v[16:19], v[148:151]
    s_waitcnt lgkmcnt(0)
    v_mul_u32_u24 v5, 320, v6
    v_lshl_add_u32 v5, v3, 4, v5
    v_add_u32 v5, s29, v5
    v_lshlrev_b32 v6, 4, v6
    v_mfma_f32_16x16x32_bf16 v[152:155], v[64:67], v[16:19], v[152:155]
    v_exp_f32 v27, v27
    v_lshl_add_u32 v6, v3, 8, v6
    s_lshl_b32 s30, s3, 15
    v_mov_b32 v3, v8
    v_mfma_f32_16x16x32_bf16 v[156:159], v[72:75], v[16:19], v[156:159]
    v_cvt_pk_bf16_f32 v14, v24, v25
    v_permlane32_swap_b32 v3, v8
    v_add_f32 v8, v8, v3
    v_mfma_f32_16x16x32_bf16 v[20:23], a[232:235], a[80:83], 0
    v_exp_f32 v28, v28
    v_mov_b32 v3, v8
    v_mfma_f32_16x16x32_bf16 v[20:23], a[244:247], a[84:87], v[20:23]
    s_nop 0
    v_permlane16_swap_b32 v3, v8
    v_mfma_f32_16x16x32_bf16 v[20:23], a[252:255], a[88:91], v[20:23]
    v_exp_f32 v29, v29
    v_add_f32 v8, v8, v3
    v_mfma_f32_16x16x32_bf16 v[20:23], a[220:223], a[92:95], v[20:23]
    buffer_store_dwordx4 v[116:119], v2, s[16:19], s24 offen offset:128 sc1
    v_cvt_pk_bf16_f32 v15, v26, v27
    v_mfma_f32_16x16x32_bf16 v[24:27], a[208:211], a[80:83], 0
    v_exp_f32 v30, v30
    v_accvgpr_read_b32 v3, a48
    v_mfma_f32_16x16x32_bf16 v[24:27], a[236:239], a[84:87], v[24:27]
    v_add_f32 v8, v8, v3
    v_subrev_u32 v3, s36, v8
    v_mfma_f32_16x16x32_bf16 a[64:67], a[4:7], v[12:15], 0
    v_rcp_f32 v8, v8
    v_cmp_le_u32 vcc, s37, v3
    v_mfma_f32_16x16x32_bf16 v[24:27], a[216:219], a[88:91], v[24:27]
    v_exp_f32 v31, v31
    s_or_b64 s[26:27], s[26:27], vcc
    v_mul_f32 v128, v128, v8
    v_mfma_f32_16x16x32_bf16 v[24:27], a[192:195], a[92:95], v[24:27]
    v_cvt_pk_bf16_f32 v16, v28, v29
    v_mul_f32 v129, v129, v8
    v_mfma_f32_16x16x32_bf16 v[160:163], v[92:95], v[12:15], v[160:163]
    v_exp_f32 v32, v32
    v_mul_f32 v130, v130, v8
    v_mfma_f32_16x16x32_bf16 v[164:167], a[168:171], v[12:15], v[164:167]
    v_mul_f32 v131, v131, v8
    v_mul_f32 v132, v132, v8
    v_mfma_f32_16x16x32_bf16 v[168:171], a[172:175], v[12:15], v[168:171]
    v_exp_f32 v33, v33
    v_mul_f32 v133, v133, v8
    v_mfma_f32_16x16x32_bf16 v[172:175], a[176:179], v[12:15], v[172:175]
    v_cvt_pk_bf16_f32 v17, v30, v31
    v_mul_f32 v134, v134, v8
    v_mfma_f32_16x16x32_bf16 v[176:179], a[180:183], v[12:15], v[176:179]
    v_exp_f32 v34, v34
    v_mul_f32 v135, v135, v8
    v_mfma_f32_16x16x32_bf16 v[180:183], v[100:103], v[12:15], v[180:183]
    v_cvt_pk_bf16_f32 v128, v128, v129
    v_cvt_pk_bf16_f32 v129, v130, v131
    v_mfma_f32_16x16x32_bf16 v[184:187], v[64:67], v[12:15], v[184:187]
    v_exp_f32 v35, v35
    v_cvt_pk_bf16_f32 v130, v132, v133
    v_mfma_f32_16x16x32_bf16 v[188:191], v[72:75], v[12:15], v[188:191]
    buffer_store_dwordx4 v[124:127], v2, s[16:19], s24 offen offset:192 sc1
    v_cvt_pk_bf16_f32 v18, v32, v33
    v_mfma_f32_16x16x32_bf16 v[28:31], a[228:231], a[80:83], 0
    v_exp_f32 v20, v20
    v_cvt_pk_bf16_f32 v131, v134, v135
    v_mfma_f32_16x16x32_bf16 v[28:31], a[108:111], a[84:87], v[28:31]
    v_mul_f32 v136, v136, v8
    v_mul_f32 v137, v137, v8
    v_mfma_f32_16x16x32_bf16 v[28:31], a[116:119], a[88:91], v[28:31]
    v_exp_f32 v21, v21
    v_mul_f32 v138, v138, v8
    v_mfma_f32_16x16x32_bf16 v[28:31], a[104:107], a[92:95], v[28:31]
    v_cvt_pk_bf16_f32 v19, v34, v35
    v_mul_f32 v139, v139, v8
    v_mfma_f32_16x16x32_bf16 v[32:35], a[248:251], a[80:83], 0
    v_exp_f32 v22, v22
    v_mul_f32 v140, v140, v8
    v_mfma_f32_16x16x32_bf16 v[32:35], a[240:243], a[84:87], v[32:35]
    v_mul_f32 v141, v141, v8
    v_mul_f32 v142, v142, v8
    v_mfma_f32_16x16x32_bf16 a[64:67], a[4:7], v[16:19], a[64:67]
    v_mul_f32 v143, v143, v8
    v_cvt_pk_bf16_f32 v136, v136, v137
    v_cvt_pk_bf16_f32 v137, v138, v139
    v_mfma_f32_16x16x32_bf16 v[32:35], a[212:215], a[88:91], v[32:35]
    v_exp_f32 v23, v23
    v_cvt_pk_bf16_f32 v138, v140, v141
    v_mfma_f32_16x16x32_bf16 v[32:35], a[200:203], a[92:95], v[32:35]
    v_cvt_pk_bf16_f32 v12, v20, v21
    v_cvt_pk_bf16_f32 v139, v142, v143
    v_mfma_f32_16x16x32_bf16 v[160:163], a[156:159], v[16:19], v[160:163]
    v_exp_f32 v24, v24
    v_mfma_f32_16x16x32_bf16 a[0:3], v[128:131], v[136:139], a[0:3]
    v_mfma_f32_16x16x32_bf16 v[164:167], v[84:87], v[16:19], v[164:167]
    v_mfma_f32_16x16x32_bf16 v[168:171], a[12:15], v[16:19], v[168:171]
    s_add_u32 s24, s43, 16384
    s_and_b32 s24, s24, 0x7fff
    v_exp_f32 v25, v25
    v_mfma_f32_16x16x32_bf16 v[172:175], a[68:71], v[16:19], v[172:175]
    buffer_store_dwordx4 v[128:131], v2, s[16:19], s24 offen offset:0 sc1
    v_cvt_pk_bf16_f32 v13, v22, v23
    v_mfma_f32_16x16x32_bf16 v[176:179], a[72:75], v[16:19], v[176:179]
    v_exp_f32 v26, v26
    v_mul_f32 v144, v144, v8
    v_mfma_f32_16x16x32_bf16 v[180:183], a[160:163], v[16:19], v[180:183]
    v_mul_f32 v145, v145, v8
    v_mul_f32 v146, v146, v8
    v_mfma_f32_16x16x32_bf16 v[184:187], a[164:167], v[16:19], v[184:187]
    v_exp_f32 v27, v27
    v_mul_f32 v147, v147, v8
    v_mfma_f32_16x16x32_bf16 v[188:191], a[76:79], v[16:19], v[188:191]
    v_cvt_pk_bf16_f32 v14, v24, v25
    v_mul_f32 v148, v148, v8
    v_mfma_f32_16x16x32_bf16 v[20:23], a[228:231], a[96:99], 0
    v_exp_f32 v28, v28
    v_mul_f32 v149, v149, v8
    v_mfma_f32_16x16x32_bf16 v[20:23], a[108:111], v[36:39], v[20:23]
    v_mul_f32 v150, v150, v8
    v_mul_f32 v151, v151, v8
    v_mfma_f32_16x16x32_bf16 v[20:23], a[116:119], v[40:43], v[20:23]
    v_exp_f32 v29, v29
    v_cvt_pk_bf16_f32 v144, v144, v145
    v_mfma_f32_16x16x32_bf16 v[20:23], a[104:107], v[44:47], v[20:23]
    v_cvt_pk_bf16_f32 v15, v26, v27
    v_cvt_pk_bf16_f32 v145, v146, v147
    v_mfma_f32_16x16x32_bf16 v[24:27], a[248:251], a[96:99], 0
    v_exp_f32 v30, v30
    v_cvt_pk_bf16_f32 v146, v148, v149
    v_mfma_f32_16x16x32_bf16 v[24:27], a[240:243], v[36:39], v[24:27]
    v_cvt_pk_bf16_f32 v147, v150, v151
    v_mul_f32 v152, v152, v8
    v_mfma_f32_16x16x32_bf16 a[64:67], a[4:7], v[12:15], a[64:67]
    v_mul_f32 v153, v153, v8
    v_mul_f32 v154, v154, v8
    v_mul_f32 v155, v155, v8
    v_mfma_f32_16x16x32_bf16 v[24:27], a[212:215], v[40:43], v[24:27]
    v_exp_f32 v31, v31
    v_mul_f32 v156, v156, v8
    v_mfma_f32_16x16x32_bf16 v[24:27], a[200:203], v[44:47], v[24:27]
    buffer_store_dwordx4 v[136:139], v2, s[16:19], s24 offen offset:64 sc1
    v_cvt_pk_bf16_f32 v16, v28, v29
    v_mfma_f32_16x16x32_bf16 v[160:163], a[196:199], v[12:15], v[160:163]
    v_exp_f32 v32, v32
    v_mul_f32 v157, v157, v8
    v_mfma_f32_16x16x32_bf16 v[164:167], a[124:127], v[12:15], v[164:167]
    v_mul_f32 v158, v158, v8
    v_mul_f32 v159, v159, v8
    v_mfma_f32_16x16x32_bf16 v[168:171], a[16:19], v[12:15], v[168:171]
    v_exp_f32 v33, v33
    v_cvt_pk_bf16_f32 v152, v152, v153
    v_mfma_f32_16x16x32_bf16 v[172:175], a[112:115], v[12:15], v[172:175]
    v_cvt_pk_bf16_f32 v17, v30, v31
    v_cvt_pk_bf16_f32 v153, v154, v155
    v_mfma_f32_16x16x32_bf16 v[176:179], a[100:103], v[12:15], v[176:179]
    v_exp_f32 v34, v34
    v_cvt_pk_bf16_f32 v154, v156, v157
    v_mfma_f32_16x16x32_bf16 v[180:183], v[96:99], v[12:15], v[180:183]
    v_cvt_pk_bf16_f32 v155, v158, v159
    s_nop 1
    v_mfma_f32_16x16x32_bf16 a[0:3], v[144:147], v[152:155], a[0:3]
    v_mfma_f32_16x16x32_bf16 v[184:187], a[204:207], v[12:15], v[184:187]
    v_exp_f32 v35, v35
    v_mfma_f32_16x16x32_bf16 v[188:191], a[20:23], v[12:15], v[188:191]
    v_cvt_pk_bf16_f32 v18, v32, v33
    v_mfma_f32_16x16x32_bf16 v[28:31], a[232:235], a[96:99], 0
    v_exp_f32 v20, v20
    v_mfma_f32_16x16x32_bf16 v[28:31], a[244:247], v[36:39], v[28:31]
    v_mov_b32 v3, v9
    s_nop 1
    v_permlane32_swap_b32 v3, v9
    v_mfma_f32_16x16x32_bf16 v[28:31], a[252:255], v[40:43], v[28:31]
    v_exp_f32 v21, v21
    v_mfma_f32_16x16x32_bf16 v[28:31], a[220:223], v[44:47], v[28:31]
    buffer_store_dwordx4 v[144:147], v2, s[16:19], s24 offen offset:128 sc1
    v_cvt_pk_bf16_f32 v19, v34, v35
    v_mfma_f32_16x16x32_bf16 v[32:35], a[208:211], a[96:99], 0
    v_exp_f32 v22, v22
    v_add_f32 v9, v9, v3
    v_mfma_f32_16x16x32_bf16 v[32:35], a[236:239], v[36:39], v[32:35]
    v_mov_b32 v3, v9
    s_nop 1
    v_permlane16_swap_b32 v3, v9
    v_mfma_f32_16x16x32_bf16 a[64:67], a[4:7], v[16:19], a[64:67]
    v_add_f32 v9, v9, v3
    v_mfma_f32_16x16x32_bf16 v[32:35], a[216:219], v[40:43], v[32:35]
    v_exp_f32 v23, v23
    v_mfma_f32_16x16x32_bf16 v[32:35], a[192:195], v[44:47], v[32:35]
    v_cvt_pk_bf16_f32 v12, v20, v21
    s_nop 2
    v_accvgpr_read_b32 v3, a64
    v_add_f32 v9, v9, v3
    v_subrev_u32 v3, s36, v9
    v_mfma_f32_16x16x32_bf16 v[160:163], a[24:27], v[16:19], v[160:163]
    v_exp_f32 v24, v24
    v_mfma_f32_16x16x32_bf16 v[164:167], a[28:31], v[16:19], v[164:167]
    v_rcp_f32 v9, v9
    v_cmp_le_u32 vcc, s37, v3
    v_mfma_f32_16x16x32_bf16 v[168:171], a[120:123], v[16:19], v[168:171]
    v_exp_f32 v25, v25
    v_mfma_f32_16x16x32_bf16 v[172:175], a[224:227], v[16:19], v[172:175]
    v_cvt_pk_bf16_f32 v13, v22, v23
    s_or_b64 s[26:27], s[26:27], vcc
    v_mul_f32 v160, v160, v9
    v_mul_f32 v161, v161, v9
    v_mfma_f32_16x16x32_bf16 v[176:179], a[32:35], v[16:19], v[176:179]
    v_exp_f32 v26, v26
    v_mfma_f32_16x16x32_bf16 v[180:183], v[104:107], v[16:19], v[180:183]
    v_mul_f32 v162, v162, v9
    v_mul_f32 v163, v163, v9
    v_mul_f32 v164, v164, v9
    v_mfma_f32_16x16x32_bf16 v[184:187], a[36:39], v[16:19], v[184:187]
    v_exp_f32 v27, v27
    v_mfma_f32_16x16x32_bf16 v[188:191], a[40:43], v[16:19], v[188:191]
    buffer_store_dwordx4 v[152:155], v2, s[16:19], s24 offen offset:192 sc1
    v_cvt_pk_bf16_f32 v14, v24, v25
    v_mul_f32 v165, v165, v9
    v_mfma_f32_16x16x32_bf16 v[20:23], a[44:47], a[96:99], 0
    v_exp_f32 v28, v28
    v_mfma_f32_16x16x32_bf16 v[20:23], v[112:115], v[36:39], v[20:23]
    v_mul_f32 v166, v166, v9
    v_mul_f32 v167, v167, v9
    v_cvt_pk_bf16_f32 v160, v160, v161
    v_mfma_f32_16x16x32_bf16 v[20:23], a[52:55], v[40:43], v[20:23]
    v_exp_f32 v29, v29
    v_mfma_f32_16x16x32_bf16 v[20:23], a[56:59], v[44:47], v[20:23]
    v_cvt_pk_bf16_f32 v15, v26, v27
    v_cvt_pk_bf16_f32 v161, v162, v163
    v_cvt_pk_bf16_f32 v162, v164, v165
    v_mfma_f32_16x16x32_bf16 v[24:27], a[60:63], a[96:99], 0
    v_exp_f32 v30, v30
    v_mfma_f32_16x16x32_bf16 v[24:27], v[120:123], v[36:39], v[24:27]
    v_cvt_pk_bf16_f32 v163, v166, v167
    v_mul_f32 v168, v168, v9
    v_mfma_f32_16x16x32_bf16 a[80:83], a[4:7], v[12:15], 0
    v_mul_f32 v169, v169, v9
    v_mul_f32 v170, v170, v9
    v_mul_f32 v171, v171, v9
    v_mul_f32 v172, v172, v9
    v_mfma_f32_16x16x32_bf16 v[24:27], a[8:11], v[40:43], v[24:27]
    v_exp_f32 v31, v31
    v_mfma_f32_16x16x32_bf16 v[24:27], a[128:131], v[44:47], v[24:27]
    v_cvt_pk_bf16_f32 v16, v28, v29
    v_mul_f32 v173, v173, v9
    v_mul_f32 v174, v174, v9
    v_mfma_f32_16x16x32_bf16 v[192:195], a[24:27], v[12:15], v[192:195]
    v_exp_f32 v32, v32
    v_mfma_f32_16x16x32_bf16 v[196:199], a[28:31], v[12:15], v[196:199]
    v_mul_f32 v175, v175, v9
    v_cvt_pk_bf16_f32 v168, v168, v169
    v_cvt_pk_bf16_f32 v169, v170, v171
    v_mfma_f32_16x16x32_bf16 v[200:203], a[120:123], v[12:15], v[200:203]
    s_add_u32 s24, s43, 20480
    s_and_b32 s24, s24, 0x7fff
    v_exp_f32 v33, v33
    v_mfma_f32_16x16x32_bf16 v[204:207], a[224:227], v[12:15], v[204:207]
    buffer_store_dwordx4 v[160:163], v2, s[16:19], s24 offen offset:0 sc1
    v_cvt_pk_bf16_f32 v17, v30, v31
    v_cvt_pk_bf16_f32 v170, v172, v173
    v_mfma_f32_16x16x32_bf16 v[208:211], a[32:35], v[12:15], v[208:211]
    v_exp_f32 v34, v34
    v_mfma_f32_16x16x32_bf16 v[212:215], v[104:107], v[12:15], v[212:215]
    v_cvt_pk_bf16_f32 v171, v174, v175
    s_nop 1
    v_mfma_f32_16x16x32_bf16 a[0:3], v[160:163], v[168:171], a[0:3]
    v_mfma_f32_16x16x32_bf16 v[216:219], a[36:39], v[12:15], v[216:219]
    v_exp_f32 v35, v35
    v_mfma_f32_16x16x32_bf16 v[220:223], a[40:43], v[12:15], v[220:223]
    v_cvt_pk_bf16_f32 v18, v32, v33
    v_mfma_f32_16x16x32_bf16 v[28:31], a[132:135], a[96:99], 0
    v_exp_f32 v20, v20
    v_mfma_f32_16x16x32_bf16 v[28:31], a[136:139], v[36:39], v[28:31]
    v_mul_f32 v176, v176, v9
    v_mul_f32 v177, v177, v9
    v_mul_f32 v178, v178, v9
    v_mfma_f32_16x16x32_bf16 v[28:31], a[140:143], v[40:43], v[28:31]
    v_exp_f32 v21, v21
    v_mfma_f32_16x16x32_bf16 v[28:31], v[68:71], v[44:47], v[28:31]
    v_cvt_pk_bf16_f32 v19, v34, v35
    v_mul_f32 v179, v179, v9
    v_mul_f32 v180, v180, v9
    v_mfma_f32_16x16x32_bf16 v[32:35], a[144:147], a[96:99], 0
    v_exp_f32 v22, v22
    v_mfma_f32_16x16x32_bf16 v[32:35], a[148:151], v[36:39], v[32:35]
    v_mul_f32 v181, v181, v9
    v_mul_f32 v182, v182, v9
    v_mfma_f32_16x16x32_bf16 a[80:83], a[4:7], v[16:19], a[80:83]
    v_mul_f32 v183, v183, v9
    v_cvt_pk_bf16_f32 v176, v176, v177
    v_cvt_pk_bf16_f32 v177, v178, v179
    v_cvt_pk_bf16_f32 v178, v180, v181
    v_mfma_f32_16x16x32_bf16 v[32:35], v[76:79], v[40:43], v[32:35]
    v_exp_f32 v23, v23
    v_mfma_f32_16x16x32_bf16 v[32:35], a[152:155], v[44:47], v[32:35]
    buffer_store_dwordx4 v[168:171], v2, s[16:19], s24 offen offset:64 sc1
    v_cvt_pk_bf16_f32 v12, v20, v21
    v_cvt_pk_bf16_f32 v179, v182, v183
    v_mfma_f32_16x16x32_bf16 v[192:195], a[196:199], v[16:19], v[192:195]
    v_exp_f32 v24, v24
    v_mfma_f32_16x16x32_bf16 v[196:199], a[124:127], v[16:19], v[196:199]
    v_mul_f32 v184, v184, v9
    v_mul_f32 v185, v185, v9
    v_mul_f32 v186, v186, v9
    v_mfma_f32_16x16x32_bf16 v[200:203], a[16:19], v[16:19], v[200:203]
    v_exp_f32 v25, v25
    v_mfma_f32_16x16x32_bf16 v[204:207], a[112:115], v[16:19], v[204:207]
    v_cvt_pk_bf16_f32 v13, v22, v23
    v_mul_f32 v187, v187, v9
    v_mul_f32 v188, v188, v9
    v_mfma_f32_16x16x32_bf16 v[208:211], a[100:103], v[16:19], v[208:211]
    v_exp_f32 v26, v26
    v_mfma_f32_16x16x32_bf16 v[212:215], v[96:99], v[16:19], v[212:215]
    v_mul_f32 v189, v189, v9
    v_mul_f32 v190, v190, v9
    v_mul_f32 v191, v191, v9
    v_mfma_f32_16x16x32_bf16 v[216:219], a[204:207], v[16:19], v[216:219]
    v_exp_f32 v27, v27
    v_mfma_f32_16x16x32_bf16 v[220:223], a[20:23], v[16:19], v[220:223]
    v_cvt_pk_bf16_f32 v14, v24, v25
    v_cvt_pk_bf16_f32 v184, v184, v185
    v_cvt_pk_bf16_f32 v185, v186, v187
    v_mfma_f32_16x16x32_bf16 v[20:23], a[132:135], v[48:51], 0
    v_exp_f32 v28, v28
    v_mfma_f32_16x16x32_bf16 v[20:23], a[136:139], v[52:55], v[20:23]
    v_cvt_pk_bf16_f32 v186, v188, v189
    v_cvt_pk_bf16_f32 v187, v190, v191
    s_nop 1
    v_mfma_f32_16x16x32_bf16 a[0:3], v[176:179], v[184:187], a[0:3]
    v_mfma_f32_16x16x32_bf16 v[20:23], a[140:143], v[56:59], v[20:23]
    v_exp_f32 v29, v29
    v_mfma_f32_16x16x32_bf16 v[20:23], v[68:71], v[60:63], v[20:23]
    buffer_store_dwordx4 v[176:179], v2, s[16:19], s24 offen offset:128 sc1
    v_cvt_pk_bf16_f32 v15, v26, v27
    v_mfma_f32_16x16x32_bf16 v[24:27], a[144:147], v[48:51], 0
    v_exp_f32 v30, v30
    v_mfma_f32_16x16x32_bf16 v[24:27], a[148:151], v[52:55], v[24:27]
    v_mov_b32 v3, v10
    s_nop 1
    v_permlane32_swap_b32 v3, v10
    v_mfma_f32_16x16x32_bf16 a[80:83], a[4:7], v[12:15], a[80:83]
    v_add_f32 v10, v10, v3
    v_mfma_f32_16x16x32_bf16 v[24:27], v[76:79], v[56:59], v[24:27]
    v_exp_f32 v31, v31
    v_mfma_f32_16x16x32_bf16 v[24:27], a[152:155], v[60:63], v[24:27]
    v_cvt_pk_bf16_f32 v16, v28, v29
    v_mov_b32 v3, v10
    s_nop 1
    v_permlane16_swap_b32 v3, v10
    v_mfma_f32_16x16x32_bf16 v[192:195], a[156:159], v[12:15], v[192:195]
    v_exp_f32 v32, v32
    v_mfma_f32_16x16x32_bf16 v[196:199], v[84:87], v[12:15], v[196:199]
    v_add_f32 v10, v10, v3
    v_mfma_f32_16x16x32_bf16 v[200:203], a[12:15], v[12:15], v[200:203]
    v_exp_f32 v33, v33
    v_mfma_f32_16x16x32_bf16 v[204:207], a[68:71], v[12:15], v[204:207]
    v_cvt_pk_bf16_f32 v17, v30, v31
    v_mfma_f32_16x16x32_bf16 v[208:211], a[72:75], v[12:15], v[208:211]
    v_exp_f32 v34, v34
    v_mfma_f32_16x16x32_bf16 v[212:215], a[160:163], v[12:15], v[212:215]
    v_mfma_f32_16x16x32_bf16 v[216:219], a[164:167], v[12:15], v[216:219]
    v_exp_f32 v35, v35
    v_mfma_f32_16x16x32_bf16 v[220:223], a[76:79], v[12:15], v[220:223]
    buffer_store_dwordx4 v[184:187], v2, s[16:19], s24 offen offset:192 sc1
    v_cvt_pk_bf16_f32 v18, v32, v33
    v_mfma_f32_16x16x32_bf16 v[28:31], a[44:47], v[48:51], 0
    v_exp_f32 v20, v20
    v_mfma_f32_16x16x32_bf16 v[28:31], v[112:115], v[52:55], v[28:31]
    v_mfma_f32_16x16x32_bf16 v[28:31], a[52:55], v[56:59], v[28:31]
    v_exp_f32 v21, v21
    v_mfma_f32_16x16x32_bf16 v[28:31], a[56:59], v[60:63], v[28:31]
    v_cvt_pk_bf16_f32 v19, v34, v35
    v_mfma_f32_16x16x32_bf16 v[32:35], a[60:63], v[48:51], 0
    v_exp_f32 v22, v22
    v_mfma_f32_16x16x32_bf16 v[32:35], v[120:123], v[52:55], v[32:35]
    v_mfma_f32_16x16x32_bf16 a[80:83], a[4:7], v[16:19], a[80:83]
    v_mfma_f32_16x16x32_bf16 v[32:35], a[8:11], v[56:59], v[32:35]
    v_exp_f32 v23, v23
    v_mfma_f32_16x16x32_bf16 v[32:35], a[128:131], v[60:63], v[32:35]
    v_cvt_pk_bf16_f32 v12, v20, v21
    s_nop 3
    v_accvgpr_read_b32 v3, a80
    v_add_f32 v10, v10, v3
    v_mfma_f32_16x16x32_bf16 v[192:195], v[92:95], v[16:19], v[192:195]
    v_exp_f32 v24, v24
    v_subrev_u32 v3, s36, v10
    v_mfma_f32_16x16x32_bf16 v[196:199], a[168:171], v[16:19], v[196:199]
    v_rcp_f32 v10, v10
    v_mfma_f32_16x16x32_bf16 v[200:203], a[172:175], v[16:19], v[200:203]
    v_exp_f32 v25, v25
    v_cmp_le_u32 vcc, s37, v3
    v_mfma_f32_16x16x32_bf16 v[204:207], a[176:179], v[16:19], v[204:207]
    v_cvt_pk_bf16_f32 v13, v22, v23
    s_or_b64 s[26:27], s[26:27], vcc
    v_mul_f32 v192, v192, v10
    v_mfma_f32_16x16x32_bf16 v[208:211], a[180:183], v[16:19], v[208:211]
    v_exp_f32 v26, v26
    v_mul_f32 v193, v193, v10
    v_mfma_f32_16x16x32_bf16 v[212:215], v[100:103], v[16:19], v[212:215]
    v_mul_f32 v194, v194, v10
    v_mul_f32 v195, v195, v10
    v_mfma_f32_16x16x32_bf16 v[216:219], v[64:67], v[16:19], v[216:219]
    v_exp_f32 v27, v27
    v_mul_f32 v196, v196, v10
    v_mfma_f32_16x16x32_bf16 v[220:223], v[72:75], v[16:19], v[220:223]
    v_cvt_pk_bf16_f32 v14, v24, v25
    v_mul_f32 v197, v197, v10
    v_mfma_f32_16x16x32_bf16 v[20:23], a[232:235], v[48:51], 0
    v_exp_f32 v28, v28
    v_mul_f32 v198, v198, v10
    v_mfma_f32_16x16x32_bf16 v[20:23], a[244:247], v[52:55], v[20:23]
    v_mul_f32 v199, v199, v10
    v_cvt_pk_bf16_f32 v192, v192, v193
    v_mfma_f32_16x16x32_bf16 v[20:23], a[252:255], v[56:59], v[20:23]
    v_exp_f32 v29, v29
    v_cvt_pk_bf16_f32 v193, v194, v195
    v_mfma_f32_16x16x32_bf16 v[20:23], a[220:223], v[60:63], v[20:23]
    v_cvt_pk_bf16_f32 v15, v26, v27
    v_cvt_pk_bf16_f32 v194, v196, v197
    v_mfma_f32_16x16x32_bf16 v[24:27], a[208:211], v[48:51], 0
    v_exp_f32 v30, v30
    v_cvt_pk_bf16_f32 v195, v198, v199
    v_mfma_f32_16x16x32_bf16 v[24:27], a[236:239], v[52:55], v[24:27]
    v_mul_f32 v200, v200, v10
    v_mul_f32 v201, v201, v10
    v_mfma_f32_16x16x32_bf16 a[96:99], a[4:7], v[12:15], 0
    v_mul_f32 v202, v202, v10
    v_mul_f32 v203, v203, v10
    v_mul_f32 v204, v204, v10
    v_mfma_f32_16x16x32_bf16 v[24:27], a[216:219], v[56:59], v[24:27]
    s_add_u32 s24, s43, 24576
    s_and_b32 s24, s24, 0x7fff
    v_exp_f32 v31, v31
    v_mul_f32 v205, v205, v10
    v_mfma_f32_16x16x32_bf16 v[24:27], a[192:195], v[60:63], v[24:27]
    buffer_store_dwordx4 v[192:195], v2, s[16:19], s24 offen offset:0 sc1
    v_cvt_pk_bf16_f32 v16, v28, v29
    v_mfma_f32_16x16x32_bf16 v[224:227], v[92:95], v[12:15], v[224:227]
    v_exp_f32 v32, v32
    v_mul_f32 v206, v206, v10
    v_mfma_f32_16x16x32_bf16 v[228:231], a[168:171], v[12:15], v[228:231]
    v_mul_f32 v207, v207, v10
    v_cvt_pk_bf16_f32 v200, v200, v201
    v_mfma_f32_16x16x32_bf16 v[232:235], a[172:175], v[12:15], v[232:235]
    v_exp_f32 v33, v33
    v_cvt_pk_bf16_f32 v201, v202, v203
    v_mfma_f32_16x16x32_bf16 v[236:239], a[176:179], v[12:15], v[236:239]
    v_cvt_pk_bf16_f32 v17, v30, v31
    v_cvt_pk_bf16_f32 v202, v204, v205
    v_mfma_f32_16x16x32_bf16 v[240:243], a[180:183], v[12:15], v[240:243]
    v_exp_f32 v34, v34
    v_cvt_pk_bf16_f32 v203, v206, v207
    v_mfma_f32_16x16x32_bf16 v[244:247], v[100:103], v[12:15], v[244:247]
    s_nop 0
    v_mfma_f32_16x16x32_bf16 a[0:3], v[192:195], v[200:203], a[0:3]
    v_mfma_f32_16x16x32_bf16 v[248:251], v[64:67], v[12:15], v[248:251]
    v_exp_f32 v35, v35
    v_mfma_f32_16x16x32_bf16 v[252:255], v[72:75], v[12:15], v[252:255]
    v_cvt_pk_bf16_f32 v18, v32, v33
    v_mfma_f32_16x16x32_bf16 v[28:31], a[228:231], v[48:51], 0
    v_exp_f32 v20, v20
    v_mul_f32 v208, v208, v10
    v_mfma_f32_16x16x32_bf16 v[28:31], a[108:111], v[52:55], v[28:31]
    v_mul_f32 v209, v209, v10
    v_mul_f32 v210, v210, v10
    v_mfma_f32_16x16x32_bf16 v[28:31], a[116:119], v[56:59], v[28:31]
    v_exp_f32 v21, v21
    v_mul_f32 v211, v211, v10
    v_mfma_f32_16x16x32_bf16 v[28:31], a[104:107], v[60:63], v[28:31]
    buffer_store_dwordx4 v[200:203], v2, s[16:19], s24 offen offset:64 sc1
    v_cvt_pk_bf16_f32 v19, v34, v35
    v_mfma_f32_16x16x32_bf16 v[32:35], a[248:251], v[48:51], 0
    v_exp_f32 v22, v22
    v_mul_f32 v212, v212, v10
    v_mfma_f32_16x16x32_bf16 v[32:35], a[240:243], v[52:55], v[32:35]
    v_mul_f32 v213, v213, v10
    v_mul_f32 v214, v214, v10
    v_mfma_f32_16x16x32_bf16 a[96:99], a[4:7], v[16:19], a[96:99]
    v_mul_f32 v215, v215, v10
    v_cvt_pk_bf16_f32 v208, v208, v209
    v_cvt_pk_bf16_f32 v209, v210, v211
    v_mfma_f32_16x16x32_bf16 v[32:35], a[212:215], v[56:59], v[32:35]
    v_exp_f32 v23, v23
    v_cvt_pk_bf16_f32 v210, v212, v213
    v_mfma_f32_16x16x32_bf16 v[32:35], a[200:203], v[60:63], v[32:35]
    v_cvt_pk_bf16_f32 v12, v20, v21
    v_cvt_pk_bf16_f32 v211, v214, v215
    v_mfma_f32_16x16x32_bf16 v[224:227], a[156:159], v[16:19], v[224:227]
    v_exp_f32 v24, v24
    v_mul_f32 v216, v216, v10
    v_mfma_f32_16x16x32_bf16 v[228:231], v[84:87], v[16:19], v[228:231]
    v_mul_f32 v217, v217, v10
    v_mul_f32 v218, v218, v10
    v_mfma_f32_16x16x32_bf16 v[232:235], a[12:15], v[16:19], v[232:235]
    v_exp_f32 v25, v25
    v_mul_f32 v219, v219, v10
    v_mfma_f32_16x16x32_bf16 v[236:239], a[68:71], v[16:19], v[236:239]
    v_cvt_pk_bf16_f32 v13, v22, v23
    v_mul_f32 v220, v220, v10
    v_mfma_f32_16x16x32_bf16 v[240:243], a[72:75], v[16:19], v[240:243]
    v_exp_f32 v26, v26
    v_mul_f32 v221, v221, v10
    v_mfma_f32_16x16x32_bf16 v[244:247], a[160:163], v[16:19], v[244:247]
    v_mul_f32 v222, v222, v10
    v_mul_f32 v223, v223, v10
    v_mfma_f32_16x16x32_bf16 v[248:251], a[164:167], v[16:19], v[248:251]
    v_exp_f32 v27, v27
    v_cvt_pk_bf16_f32 v216, v216, v217
    v_mfma_f32_16x16x32_bf16 v[252:255], a[76:79], v[16:19], v[252:255]
    buffer_store_dwordx4 v[208:211], v2, s[16:19], s24 offen offset:128 sc1
    v_cvt_pk_bf16_f32 v14, v24, v25
    v_exp_f32 v28, v28
    v_exp_f32 v29, v29
    v_cvt_pk_bf16_f32 v15, v26, v27
    v_exp_f32 v30, v30
    s_nop 0
    v_mfma_f32_16x16x32_bf16 a[96:99], a[4:7], v[12:15], a[96:99]
    v_exp_f32 v31, v31
    v_cvt_pk_bf16_f32 v16, v28, v29
    v_mfma_f32_16x16x32_bf16 v[224:227], a[196:199], v[12:15], v[224:227]
    v_exp_f32 v32, v32
    v_cvt_pk_bf16_f32 v217, v218, v219
    v_cvt_pk_bf16_f32 v218, v220, v221
    v_cvt_pk_bf16_f32 v219, v222, v223
    v_mfma_f32_16x16x32_bf16 v[228:231], a[124:127], v[12:15], v[228:231]
    s_nop 0
    v_mfma_f32_16x16x32_bf16 a[0:3], v[208:211], v[216:219], a[0:3]
    v_mov_b32 v3, v11
    v_mfma_f32_16x16x32_bf16 v[232:235], a[16:19], v[12:15], v[232:235]
    v_exp_f32 v33, v33
    v_permlane32_swap_b32 v3, v11
    v_add_f32 v11, v11, v3
    v_mfma_f32_16x16x32_bf16 v[236:239], a[112:115], v[12:15], v[236:239]
    buffer_store_dwordx4 v[216:219], v2, s[16:19], s24 offen offset:192 sc1
    v_cvt_pk_bf16_f32 v17, v30, v31
    v_mov_b32 v3, v11
    s_nop 1
    v_permlane16_swap_b32 v3, v11
    v_mfma_f32_16x16x32_bf16 v[240:243], a[100:103], v[12:15], v[240:243]
    v_exp_f32 v34, v34
    v_add_f32 v11, v11, v3
    v_mfma_f32_16x16x32_bf16 v[244:247], v[96:99], v[12:15], v[244:247]
    v_mfma_f32_16x16x32_bf16 v[248:251], a[204:207], v[12:15], v[248:251]
    v_exp_f32 v35, v35
    v_mfma_f32_16x16x32_bf16 v[252:255], a[20:23], v[12:15], v[252:255]
    v_cvt_pk_bf16_f32 v18, v32, v33
    v_cvt_pk_bf16_f32 v19, v34, v35
    s_nop 1
    v_mfma_f32_16x16x32_bf16 a[96:99], a[4:7], v[16:19], a[96:99]
    v_mfma_f32_16x16x32_bf16 v[224:227], a[24:27], v[16:19], v[224:227]
    v_mfma_f32_16x16x32_bf16 v[228:231], a[28:31], v[16:19], v[228:231]
    s_nop 5
    v_accvgpr_read_b32 v3, a96
    v_add_f32 v11, v11, v3
    v_subrev_u32 v3, s36, v11
    v_rcp_f32 v11, v11
    v_cmp_le_u32 vcc, s37, v3
    s_nop 1
    s_or_b64 s[26:27], s[26:27], vcc
    v_mfma_f32_16x16x32_bf16 v[232:235], a[120:123], v[16:19], v[232:235]
    v_mfma_f32_16x16x32_bf16 v[236:239], a[224:227], v[16:19], v[236:239]
    v_pk_mul_f32 v[224:225], v[224:225], v[10:11] op_sel:[0,1] op_sel_hi:[1,1]
    v_pk_mul_f32 v[226:227], v[226:227], v[10:11] op_sel:[0,1] op_sel_hi:[1,1]
    v_pk_mul_f32 v[228:229], v[228:229], v[10:11] op_sel:[0,1] op_sel_hi:[1,1]
    v_pk_mul_f32 v[230:231], v[230:231], v[10:11] op_sel:[0,1] op_sel_hi:[1,1]
    v_cvt_pk_bf16_f32 v224, v224, v225
    v_cvt_pk_bf16_f32 v225, v226, v227
    v_mfma_f32_16x16x32_bf16 v[240:243], a[32:35], v[16:19], v[240:243]
    v_cvt_pk_bf16_f32 v226, v228, v229
    v_cvt_pk_bf16_f32 v227, v230, v231
    ds_write_b128 v4, v[224:227]
    ds_read_b128 v[228:231], v5
    v_mfma_f32_16x16x32_bf16 v[244:247], v[104:107], v[16:19], v[244:247]
    v_pk_mul_f32 v[232:233], v[232:233], v[10:11] op_sel:[0,1] op_sel_hi:[1,1]
    v_pk_mul_f32 v[234:235], v[234:235], v[10:11] op_sel:[0,1] op_sel_hi:[1,1]
    v_pk_mul_f32 v[236:237], v[236:237], v[10:11] op_sel:[0,1] op_sel_hi:[1,1]
    v_pk_mul_f32 v[238:239], v[238:239], v[10:11] op_sel:[0,1] op_sel_hi:[1,1]
    v_cvt_pk_bf16_f32 v232, v232, v233
    v_cvt_pk_bf16_f32 v233, v234, v235
    v_mfma_f32_16x16x32_bf16 v[248:251], a[36:39], v[16:19], v[248:251]
    v_cvt_pk_bf16_f32 v234, v236, v237
    v_cvt_pk_bf16_f32 v235, v238, v239
    ds_write_b128 v4, v[232:235]
    ds_read_b128 v[236:239], v5
    v_mfma_f32_16x16x32_bf16 a[0:3], v[224:227], v[232:235], a[0:3]
    v_mfma_f32_16x16x32_bf16 v[252:255], a[40:43], v[16:19], v[252:255]
    v_pk_mul_f32 v[240:241], v[240:241], v[10:11] op_sel:[0,1] op_sel_hi:[1,1]
    v_pk_mul_f32 v[242:243], v[242:243], v[10:11] op_sel:[0,1] op_sel_hi:[1,1]
    v_pk_mul_f32 v[244:245], v[244:245], v[10:11] op_sel:[0,1] op_sel_hi:[1,1]
    v_pk_mul_f32 v[246:247], v[246:247], v[10:11] op_sel:[0,1] op_sel_hi:[1,1]
    v_cvt_pk_bf16_f32 v240, v240, v241
    v_cvt_pk_bf16_f32 v241, v242, v243
    v_cvt_pk_bf16_f32 v242, v244, v245
    v_cvt_pk_bf16_f32 v243, v246, v247
    ds_write_b128 v4, v[240:243]
    ds_read_b128 v[244:247], v5
    v_pk_mul_f32 v[248:249], v[248:249], v[10:11] op_sel:[0,1] op_sel_hi:[1,1]
    v_pk_mul_f32 v[250:251], v[250:251], v[10:11] op_sel:[0,1] op_sel_hi:[1,1]
    v_pk_mul_f32 v[252:253], v[252:253], v[10:11] op_sel:[0,1] op_sel_hi:[1,1]
    v_pk_mul_f32 v[254:255], v[254:255], v[10:11] op_sel:[0,1] op_sel_hi:[1,1]
    v_cvt_pk_bf16_f32 v248, v248, v249
    v_cvt_pk_bf16_f32 v249, v250, v251
    v_cvt_pk_bf16_f32 v250, v252, v253
    v_cvt_pk_bf16_f32 v251, v254, v255
    ds_write_b128 v4, v[248:251]
    ds_read_b128 v[252:255], v5
    v_mfma_f32_16x16x32_bf16 a[0:3], v[240:243], v[248:251], a[0:3]
    s_add_u32 s24, s43, 28672
    s_and_b32 s24, s24, 0x7fff
    s_add_u32 s24, s24, s30
    s_waitcnt lgkmcnt(6)
    buffer_store_dwordx4 v[228:231], v6, s[16:19], s24 offen offset:0
    s_waitcnt lgkmcnt(4)
    buffer_store_dwordx4 v[236:239], v6, s[16:19], s24 offen offset:64
    s_waitcnt lgkmcnt(2)
    buffer_store_dwordx4 v[244:247], v6, s[16:19], s24 offen offset:128
    s_waitcnt lgkmcnt(0)
    buffer_store_dwordx4 v[252:255], v6, s[16:19], s24 offen offset:192
    v_accvgpr_read_b32 v20, a0
    v_accvgpr_read_b32 v21, a1
    v_accvgpr_read_b32 v22, a2
    v_accvgpr_read_b32 v23, a3
    v_mov_b32 v24, 0x207
    v_cmp_class_f32 vcc, v20, v24
    s_nop 1
    s_or_b64 s[26:27], s[26:27], vcc
    v_cmp_class_f32 vcc, v21, v24
    s_nop 1
    s_or_b64 s[26:27], s[26:27], vcc
    v_cmp_class_f32 vcc, v22, v24
    s_nop 1
    s_or_b64 s[26:27], s[26:27], vcc
    v_cmp_class_f32 vcc, v23, v24
    s_nop 1
    s_or_b64 s[26:27], s[26:27], vcc
    s_cmp_eq_u64 s[26:27], 0
    s_cbranch_scc0 L_slow
    s_endpgm
L_slow:
    s_waitcnt vmcnt(0) lgkmcnt(0)
    v_mbcnt_lo_u32_b32 v12, -1, 0
    v_mbcnt_hi_u32_b32 v12, -1, v12
    v_and_b32 v14, 15, v12
    v_lshrrev_b32 v15, 4, v12
    v_lshlrev_b32 v16, 8, v14
    v_lshl_add_u32 v1, v15, 4, v16
    v_add_u32 v2, 4096, v1
    v_lshlrev_b32 v16, 11, v15
    v_lshl_add_u32 v3, v14, 4, v16
    s_mov_b32 s30, 0
    s_cmp_eq_u32 s3, 1
    s_cselect_b32 s30, 67584, s30
    s_cmp_eq_u32 s3, 2
    s_cselect_b32 s30, 8448, s30
    s_cmp_eq_u32 s3, 3
    s_cselect_b32 s30, 76304, s30
    v_and_b32 v16, 1, v15
    v_lshrrev_b32 v17, 2, v14
    v_lshl_add_u32 v16, v16, 2, v17
    v_mul_u32_u24 v16, 1056, v16
    v_lshrrev_b32 v17, 1, v15
    v_lshl_add_u32 v16, v17, 8, v16
    v_and_b32 v17, 3, v14
    v_lshl_add_u32 v16, v17, 4, v16
    v_add_u32 v5, s30, v16
    s_mov_b32 s28, 0
L_sq:
    s_lshl_b32 s24, s3, 15
    s_add_u32 s24, s24, s28
    buffer_load_dwordx4 v[128:131], v1, s[4:7], s24 offen offset:0
    buffer_load_dwordx4 v[132:135], v1, s[4:7], s24 offen offset:64
    buffer_load_dwordx4 v[136:139], v1, s[4:7], s24 offen offset:128
    buffer_load_dwordx4 v[140:143], v1, s[4:7], s24 offen offset:192
    v_mov_b32 v4, 0xff800000
    s_mov_b32 s29, 0
L_sp1:
    buffer_load_dwordx4 v[144:147], v1, s[8:11], s29 offen offset:0
    buffer_load_dwordx4 v[148:151], v1, s[8:11], s29 offen offset:64
    buffer_load_dwordx4 v[152:155], v1, s[8:11], s29 offen offset:128
    buffer_load_dwordx4 v[156:159], v1, s[8:11], s29 offen offset:192
    buffer_load_dwordx4 v[160:163], v2, s[8:11], s29 offen offset:0
    buffer_load_dwordx4 v[164:167], v2, s[8:11], s29 offen offset:64
    buffer_load_dwordx4 v[168:171], v2, s[8:11], s29 offen offset:128
    buffer_load_dwordx4 v[172:175], v2, s[8:11], s29 offen offset:192
    s_waitcnt vmcnt(0)
    v_mfma_f32_16x16x32_bf16 v[20:23], v[144:147], v[128:131], 0
    v_mfma_f32_16x16x32_bf16 v[20:23], v[148:151], v[132:135], v[20:23]
    v_mfma_f32_16x16x32_bf16 v[20:23], v[152:155], v[136:139], v[20:23]
    v_mfma_f32_16x16x32_bf16 v[20:23], v[156:159], v[140:143], v[20:23]
    v_mfma_f32_16x16x32_bf16 v[24:27], v[160:163], v[128:131], 0
    v_mfma_f32_16x16x32_bf16 v[24:27], v[164:167], v[132:135], v[24:27]
    v_mfma_f32_16x16x32_bf16 v[24:27], v[168:171], v[136:139], v[24:27]
    v_mfma_f32_16x16x32_bf16 v[24:27], v[172:175], v[140:143], v[24:27]
    s_nop 3
    v_max3_f32 v4, v4, v20, v21
    v_max3_f32 v4, v4, v22, v23
    s_nop 1
    v_max3_f32 v4, v4, v24, v25
    v_max3_f32 v4, v4, v26, v27
    s_add_u32 s29, s29, 8192
    s_cmp_lt_u32 s29, 262144
    s_cbranch_scc1 L_sp1
    v_mov_b32 v20, v4
    s_nop 1
    v_permlane32_swap_b32 v20, v4
    v_max_f32 v4, v4, v20
    v_mov_b32 v20, v4
    s_nop 1
    v_permlane16_swap_b32 v20, v4
    v_max_f32 v4, v4, v20
    v_mov_b32 v6, 0
    v_mov_b32 v208, 0
    v_mov_b32 v209, 0
    v_mov_b32 v210, 0
    v_mov_b32 v211, 0
    v_mov_b32 v212, 0
    v_mov_b32 v213, 0
    v_mov_b32 v214, 0
    v_mov_b32 v215, 0
    v_mov_b32 v216, 0
    v_mov_b32 v217, 0
    v_mov_b32 v218, 0
    v_mov_b32 v219, 0
    v_mov_b32 v220, 0
    v_mov_b32 v221, 0
    v_mov_b32 v222, 0
    v_mov_b32 v223, 0
    v_mov_b32 v224, 0
    v_mov_b32 v225, 0
    v_mov_b32 v226, 0
    v_mov_b32 v227, 0
    v_mov_b32 v228, 0
    v_mov_b32 v229, 0
    v_mov_b32 v230, 0
    v_mov_b32 v231, 0
    v_mov_b32 v232, 0
    v_mov_b32 v233, 0
    v_mov_b32 v234, 0
    v_mov_b32 v235, 0
    v_mov_b32 v236, 0
    v_mov_b32 v237, 0
    v_mov_b32 v238, 0
    v_mov_b32 v239, 0
    s_mov_b32 s29, 0
L_sp2:
    s_add_u32 m0, s30, 0
    s_nop 0
    buffer_load_dwordx4 v3, s[12:15], s29 offen offset:0 lds
    s_add_u32 m0, s30, 800
    s_nop 0
    buffer_load_dwordx4 v3, s[12:15], s29 offen offset:256 lds
    s_add_u32 m0, s30, 1600
    s_nop 0
    buffer_load_dwordx4 v3, s[12:15], s29 offen offset:512 lds
    s_add_u32 m0, s30, 2400
    s_nop 0
    buffer_load_dwordx4 v3, s[12:15], s29 offen offset:768 lds
    s_add_u32 m0, s30, 3200
    s_nop 0
    buffer_load_dwordx4 v3, s[12:15], s29 offen offset:1024 lds
    s_add_u32 m0, s30, 4000
    s_nop 0
    buffer_load_dwordx4 v3, s[12:15], s29 offen offset:1280 lds
    s_add_u32 m0, s30, 4800
    s_nop 0
    buffer_load_dwordx4 v3, s[12:15], s29 offen offset:1536 lds
    s_add_u32 m0, s30, 5600
    s_nop 0
    buffer_load_dwordx4 v3, s[12:15], s29 offen offset:1792 lds
    buffer_load_dwordx4 v[144:147], v1, s[8:11], s29 offen offset:0
    buffer_load_dwordx4 v[148:151], v1, s[8:11], s29 offen offset:64
    buffer_load_dwordx4 v[152:155], v1, s[8:11], s29 offen offset:128
    buffer_load_dwordx4 v[156:159], v1, s[8:11], s29 offen offset:192
    buffer_load_dwordx4 v[160:163], v2, s[8:11], s29 offen offset:0
    buffer_load_dwordx4 v[164:167], v2, s[8:11], s29 offen offset:64
    buffer_load_dwordx4 v[168:171], v2, s[8:11], s29 offen offset:128
    buffer_load_dwordx4 v[172:175], v2, s[8:11], s29 offen offset:192
    s_waitcnt vmcnt(0)
    v_mfma_f32_16x16x32_bf16 v[20:23], v[144:147], v[128:131], 0
    v_mfma_f32_16x16x32_bf16 v[20:23], v[148:151], v[132:135], v[20:23]
    v_mfma_f32_16x16x32_bf16 v[20:23], v[152:155], v[136:139], v[20:23]
    v_mfma_f32_16x16x32_bf16 v[20:23], v[156:159], v[140:143], v[20:23]
    v_mfma_f32_16x16x32_bf16 v[24:27], v[160:163], v[128:131], 0
    v_mfma_f32_16x16x32_bf16 v[24:27], v[164:167], v[132:135], v[24:27]
    v_mfma_f32_16x16x32_bf16 v[24:27], v[168:171], v[136:139], v[24:27]
    v_mfma_f32_16x16x32_bf16 v[24:27], v[172:175], v[140:143], v[24:27]
    ds_read_b64_tr_b16 v[176:177], v5 offset:0
    ds_read_b64_tr_b16 v[178:179], v5 offset:512
    ds_read_b64_tr_b16 v[180:181], v5 offset:8
    ds_read_b64_tr_b16 v[182:183], v5 offset:520
    ds_read_b64_tr_b16 v[184:185], v5 offset:64
    ds_read_b64_tr_b16 v[186:187], v5 offset:576
    ds_read_b64_tr_b16 v[188:189], v5 offset:72
    ds_read_b64_tr_b16 v[190:191], v5 offset:584
    ds_read_b64_tr_b16 v[192:193], v5 offset:128
    ds_read_b64_tr_b16 v[194:195], v5 offset:640
    ds_read_b64_tr_b16 v[196:197], v5 offset:136
    ds_read_b64_tr_b16 v[198:199], v5 offset:648
    ds_read_b64_tr_b16 v[200:201], v5 offset:192
    ds_read_b64_tr_b16 v[202:203], v5 offset:704
    ds_read_b64_tr_b16 v[204:205], v5 offset:200
    ds_read_b64_tr_b16 v[206:207], v5 offset:712
    v_sub_f32 v20, v20, v4
    v_sub_f32 v21, v21, v4
    v_sub_f32 v22, v22, v4
    v_sub_f32 v23, v23, v4
    v_sub_f32 v24, v24, v4
    v_sub_f32 v25, v25, v4
    v_sub_f32 v26, v26, v4
    v_sub_f32 v27, v27, v4
    v_mul_f32 v20, s22, v20
    v_mul_f32 v21, s22, v21
    v_mul_f32 v22, s22, v22
    v_mul_f32 v23, s22, v23
    v_mul_f32 v24, s22, v24
    v_mul_f32 v25, s22, v25
    v_mul_f32 v26, s22, v26
    v_mul_f32 v27, s22, v27
    v_exp_f32 v20, v20
    v_exp_f32 v21, v21
    v_exp_f32 v22, v22
    v_exp_f32 v23, v23
    v_exp_f32 v24, v24
    v_exp_f32 v25, v25
    v_exp_f32 v26, v26
    v_exp_f32 v27, v27
    v_add_f32 v6, v6, v20
    v_add_f32 v6, v6, v21
    v_add_f32 v6, v6, v22
    v_add_f32 v6, v6, v23
    v_add_f32 v6, v6, v24
    v_add_f32 v6, v6, v25
    v_add_f32 v6, v6, v26
    v_add_f32 v6, v6, v27
    v_cvt_pk_bf16_f32 v12, v20, v21
    v_cvt_pk_bf16_f32 v13, v22, v23
    v_cvt_pk_bf16_f32 v14, v24, v25
    v_cvt_pk_bf16_f32 v15, v26, v27
    s_waitcnt lgkmcnt(0)
    s_nop 0
    v_mfma_f32_16x16x32_bf16 v[208:211], v[176:179], v[12:15], v[208:211]
    v_mfma_f32_16x16x32_bf16 v[212:215], v[180:183], v[12:15], v[212:215]
    v_mfma_f32_16x16x32_bf16 v[216:219], v[184:187], v[12:15], v[216:219]
    v_mfma_f32_16x16x32_bf16 v[220:223], v[188:191], v[12:15], v[220:223]
    v_mfma_f32_16x16x32_bf16 v[224:227], v[192:195], v[12:15], v[224:227]
    v_mfma_f32_16x16x32_bf16 v[228:231], v[196:199], v[12:15], v[228:231]
    v_mfma_f32_16x16x32_bf16 v[232:235], v[200:203], v[12:15], v[232:235]
    v_mfma_f32_16x16x32_bf16 v[236:239], v[204:207], v[12:15], v[236:239]
    s_nop 7
    s_add_u32 s29, s29, 8192
    s_cmp_lt_u32 s29, 262144
    s_cbranch_scc1 L_sp2
    v_mov_b32 v20, v6
    s_nop 1
    v_permlane32_swap_b32 v20, v6
    v_add_f32 v6, v6, v20
    v_mov_b32 v20, v6
    s_nop 1
    v_permlane16_swap_b32 v20, v6
    v_add_f32 v6, v6, v20
    v_rcp_f32 v6, v6
    s_nop 0
    v_mul_f32 v208, v208, v6
    v_mul_f32 v209, v209, v6
    v_mul_f32 v210, v210, v6
    v_mul_f32 v211, v211, v6
    v_mul_f32 v212, v212, v6
    v_mul_f32 v213, v213, v6
    v_mul_f32 v214, v214, v6
    v_mul_f32 v215, v215, v6
    v_mul_f32 v216, v216, v6
    v_mul_f32 v217, v217, v6
    v_mul_f32 v218, v218, v6
    v_mul_f32 v219, v219, v6
    v_mul_f32 v220, v220, v6
    v_mul_f32 v221, v221, v6
    v_mul_f32 v222, v222, v6
    v_mul_f32 v223, v223, v6
    v_mul_f32 v224, v224, v6
    v_mul_f32 v225, v225, v6
    v_mul_f32 v226, v226, v6
    v_mul_f32 v227, v227, v6
    v_mul_f32 v228, v228, v6
    v_mul_f32 v229, v229, v6
    v_mul_f32 v230, v230, v6
    v_mul_f32 v231, v231, v6
    v_mul_f32 v232, v232, v6
    v_mul_f32 v233, v233, v6
    v_mul_f32 v234, v234, v6
    v_mul_f32 v235, v235, v6
    v_mul_f32 v236, v236, v6
    v_mul_f32 v237, v237, v6
    v_mul_f32 v238, v238, v6
    v_mul_f32 v239, v239, v6
    v_cvt_pk_bf16_f32 v144, v208, v209
    v_cvt_pk_bf16_f32 v145, v210, v211
    v_cvt_pk_bf16_f32 v146, v212, v213
    v_cvt_pk_bf16_f32 v147, v214, v215
    buffer_store_dwordx4 v[144:147], v1, s[16:19], s24 offen offset:0
    v_cvt_pk_bf16_f32 v148, v216, v217
    v_cvt_pk_bf16_f32 v149, v218, v219
    v_cvt_pk_bf16_f32 v150, v220, v221
    v_cvt_pk_bf16_f32 v151, v222, v223
    buffer_store_dwordx4 v[148:151], v1, s[16:19], s24 offen offset:64
    v_cvt_pk_bf16_f32 v152, v224, v225
    v_cvt_pk_bf16_f32 v153, v226, v227
    v_cvt_pk_bf16_f32 v154, v228, v229
    v_cvt_pk_bf16_f32 v155, v230, v231
    buffer_store_dwordx4 v[152:155], v1, s[16:19], s24 offen offset:128
    v_cvt_pk_bf16_f32 v156, v232, v233
    v_cvt_pk_bf16_f32 v157, v234, v235
    v_cvt_pk_bf16_f32 v158, v236, v237
    v_cvt_pk_bf16_f32 v159, v238, v239
    buffer_store_dwordx4 v[156:159], v1, s[16:19], s24 offen offset:192
    s_waitcnt vmcnt(0)
    s_add_u32 s28, s28, 4096
    s_cmp_lt_u32 s28, 32768
    s_cbranch_scc1 L_sq
L_end:
    s_endpgm
L_fin:
.section .rodata,"a"
.p2align 6
.amdhsa_kernel standalone__gqa_softmax__near_ridge_kernel
  .amdhsa_next_free_vgpr 512
  .amdhsa_next_free_sgpr 102
  .amdhsa_accum_offset 256
  .amdhsa_group_segment_fixed_size 0
  .amdhsa_kernarg_size 48
  .amdhsa_user_sgpr_count 2
  .amdhsa_user_sgpr_kernarg_segment_ptr 1
  .amdhsa_system_sgpr_workgroup_id_x 1
.end_amdhsa_kernel
```
